```python
import torch

def _softmax(x, axis=-1):
    return torch.softmax(x, dim=axis)

def _gelu(x):
    return torch.nn.functional.gelu(x, approximate='tanh')

def _silu(x):
    return torch.nn.functional.silu(x)

def _sigmoid(x):
    return torch.sigmoid(x)

def _layernorm(x, axis=-1, eps=1e-05):
    m = x.mean(dim=axis, keepdim=True)
    v = x.var(dim=axis, keepdim=True, unbiased=False)
    return (x - m) / torch.sqrt(v + eps)

def _scatter_add(tgt, idx, src, axis=0):
    return tgt.clone().index_add_(axis, idx, src)

def _segment_sum(src, seg, n):
    out = torch.zeros((n,) + src.shape[1:], dtype=src.dtype)
    return out.index_add_(0, seg, src)

def _pad(x, pw):
    flat = tuple((v for pair in reversed(pw) for v in pair))
    return torch.nn.functional.pad(x, flat)
kernel_name = 'parallel_sum__memory_aug_recurrent_mem_tr__geglu_ffn__prompt'

def setup_inputs():

    _w = lambda a: (lambda t: t.to(torch.bfloat16) if t.is_floating_point() else t)(torch.as_tensor(a))

    def _A_setup():
        B, S, Dm = (1, 2048, 512)
        H, Dh = (32, 128)
        M, seg = (8, 32)
        seg = min(seg, S)
        S = S // seg * seg
        return {'x': _w((lambda *s: torch.randn(*s, dtype=torch.bfloat16) * 0.05)(B, S, Dm)), 'mem0': _w((lambda *s: torch.randn(*s, dtype=torch.bfloat16) * 1.6)(B, M, Dm)), 'Wq': _w((lambda *s: torch.randn(*s, dtype=torch.bfloat16) * 0.8)(Dm, H, Dh) * Dm ** (-0.5)), 'Wk': _w((lambda *s: torch.randn(*s, dtype=torch.bfloat16) * 0.8)(Dm, H, Dh) * Dm ** (-0.5)), 'Wv': _w((lambda *s: torch.randn(*s, dtype=torch.bfloat16) * 1.6)(Dm, H, Dh) * Dm ** (-0.5)), 'Wo': _w((lambda *s: torch.randn(*s, dtype=torch.bfloat16) * 1.6)(H, Dh, Dm) * (H * Dh) ** (-0.5)), 'seg_len': seg}
    _A_in = _A_setup()

    def _B_setup():
        B, S, D, F = (1, 2048, 512, 1792)
        return {'x': _w((lambda *s: torch.randn(*s, dtype=torch.bfloat16) * 0.05)(B, S, D)), 'w_gate': _w((lambda *s: torch.randn(*s, dtype=torch.bfloat16) * 0.05)(D, F)), 'w_up': _w((lambda *s: torch.randn(*s, dtype=torch.bfloat16) * 0.05)(D, F)), 'w_down': _w((lambda *s: torch.randn(*s, dtype=torch.bfloat16) * 0.05)(F, D))}
    _B_in = _B_setup()
    return {'A_x': _A_in['x'], 'A_mem0': _A_in['mem0'], 'A_Wq': _A_in['Wq'], 'A_Wk': _A_in['Wk'], 'A_Wv': _A_in['Wv'], 'A_Wo': _A_in['Wo'], 'A_seg_len': _A_in['seg_len'], 'B_x': _B_in['x'], 'B_w_gate': _B_in['w_gate'], 'B_w_up': _B_in['w_up'], 'B_w_down': _B_in['w_down']}

def reference(A_x, A_mem0, A_Wq, A_Wk, A_Wv, A_Wo, A_seg_len, B_x, B_w_gate, B_w_up, B_w_down):

    def _A_ref(x, mem0, Wq, Wk, Wv, Wo, seg_len):
        B, S, Dm = x.shape
        H, Dh = (Wq.shape[1], Wq.shape[2])
        M = mem0.shape[1]
        scale = Dh ** (-0.5)
        n_seg = S // seg_len
        L = M + seg_len
        idx = torch.arange(L)
        mask = (idx[:, None] < M) | (idx[:, None] >= idx[None, :])
        mem = mem0
        outs = []
        for s in range(n_seg):
            xs = x[:, s * seg_len:(s + 1) * seg_len, :].clone()
            h = torch.concatenate([mem, xs], axis=1)
            q = torch.einsum('btd,dhe->bhte', h, Wq)
            k = torch.einsum('btd,dhe->bhte', h, Wk)
            v = torch.einsum('btd,dhe->bhte', h, Wv)
            scores = torch.einsum('bhqe,bhke->bhqk', q, k) * scale
            scores = torch.where(mask[None, None], scores, -1000000000.0)
            p = _softmax(scores, axis=-1)
            o = torch.einsum('bhqk,bhke->bhqe', p, v)
            o = torch.einsum('bhte,hed->btd', o, Wo)
            mem = o[:, :M, :].clone()
            outs.append(o[:, M:, :])
        return torch.concatenate(outs, axis=1)

    def _B_ref(x, w_gate, w_up, w_down):
        return _gelu(x @ w_gate) * (x @ w_up) @ w_down
    x = A_x
    xn = _layernorm(x, axis=-1)
    return x + _A_ref(xn, A_mem0, A_Wq, A_Wk, A_Wv, A_Wo, A_seg_len) + _B_ref(xn, B_w_gate, B_w_up, B_w_down)
```

```asm
; @launch grid=(256,1,1) block=(256,1,1) lds=163840
.amdgcn_target "amdgcn-amd-amdhsa--gfx950"
.text
.globl parallel_sum__memory_aug_recurrent_mem_tr__geglu_ffn__prompt_kernel
.p2align 8
.type parallel_sum__memory_aug_recurrent_mem_tr__geglu_ffn__prompt_kernel,@function
parallel_sum__memory_aug_recurrent_mem_tr__geglu_ffn__prompt_kernel:
    s_cmp_ge_u32 s2, 256
    s_cbranch_scc1 K_EXIT
    s_load_dwordx16 s[8:23], s[0:1], 0
    s_load_dwordx8 s[24:31], s[0:1], 64
    s_load_dwordx4 s[32:35], s[0:1], 96
    s_getreg_b32 s5, hwreg(HW_REG_XCC_ID, 0, 4)
    v_lshrrev_b32 v1, 6, v0
    v_and_b32 v0, 63, v0
    s_mov_b32 s56, 0x05040100
    v_readfirstlane_b32 s3, v1
    s_mov_b32 s57, 0x07060302
    s_mov_b32 s4, 0
    s_waitcnt lgkmcnt(0)
    s_mov_b32 s36, s34
    s_mov_b32 s37, s35
    s_mov_b32 s38, 268435456
    s_mov_b32 s39, 0x00020000
    s_mov_b32 s52, s8
    s_mov_b32 s53, s9
    s_mov_b32 s54, 2097152
    s_mov_b32 s55, 0x00020000
    s_mov_b32 s48, s30
    s_mov_b32 s49, s31
    s_mov_b32 s50, 2097152
    s_mov_b32 s51, 0x00020000
    s_mov_b32 s40, s12
    s_mov_b32 s41, s13
    s_mov_b32 s42, 4194304
    s_mov_b32 s43, 0x00020000
    s_mov_b32 s44, s14
    s_mov_b32 s45, s15
    s_mov_b32 s46, 4194304
    s_mov_b32 s47, 0x00020000
    v_mov_b32 v40, 0
    s_cmp_lg_u32 s3, 0
    s_cbranch_scc1 P0_NOTICKET
    s_lshl_b32 s6, s5, 2
    v_mov_b32 v41, s6
    v_mov_b32 v42, 1
    s_mov_b64 exec, 1
    global_atomic_add v40, v41, v42, s[32:33] sc0 sc1
    s_mov_b64 exec, -1
P0_NOTICKET:
    s_lshl_b32 s6, s2, 2
    s_add_u32 s6, s6, s3
    s_lshl_b32 s6, s6, 11
    v_lshlrev_b32 v1, 4, v0
    buffer_load_dwordx4 v[4:7], v1, s[52:55], s6 offen
    buffer_load_dwordx4 v[8:11], v1, s[52:55], s6 offen offset:1024
    s_lshl_b32 s7, s2, 2
    s_add_u32 s7, s7, s3
    s_lshl_b32 s7, s7, 7
    s_add_u32 s7, s7, 87031808
    v_lshlrev_b32 v2, 2, v0
    v_mov_b32 v3, 0
    s_mov_b32 exec_hi, 0
    buffer_store_dword v3, v2, s[36:39], s7 offen sc1
    s_mov_b64 exec, -1
    s_cmp_lg_u32 s5, 0
    s_cbranch_scc1 P0_NOT
    s_lshr_b32 s7, s2, 3
    v_lshlrev_b32 v44, 6, v0
    s_lshr_b32 s60, s7, 3
    s_lshl_b32 s60, s60, 8
    s_and_b32 s6, s7, 7
    s_lshl_b32 s6, s6, 4
    s_add_u32 s6, s6, s60
    s_add_u32 s6, s6, s3
    s_lshl_b32 s6, s6, 12
    s_add_u32 s7, s6, 0
    buffer_load_dword v45, v44, s[40:43], s7 offen
    s_add_u32 s7, s6, 16384
    buffer_load_dword v45, v44, s[40:43], s7 offen
    s_add_u32 s7, s6, 524288
    buffer_load_dword v45, v44, s[40:43], s7 offen
    s_add_u32 s7, s6, 540672
    buffer_load_dword v45, v44, s[40:43], s7 offen
    s_waitcnt vmcnt(5)
    s_branch P0_T
P0_NOT:
    s_waitcnt vmcnt(1)
P0_T:
    v_lshlrev_b32 v12, 16, v4
    v_and_b32 v13, 0xffff0000, v4
    v_lshlrev_b32 v14, 16, v5
    v_and_b32 v15, 0xffff0000, v5
    v_lshlrev_b32 v16, 16, v6
    v_and_b32 v17, 0xffff0000, v6
    v_lshlrev_b32 v18, 16, v7
    v_and_b32 v19, 0xffff0000, v7
    v_lshlrev_b32 v20, 16, v8
    v_and_b32 v21, 0xffff0000, v8
    v_lshlrev_b32 v22, 16, v9
    v_and_b32 v23, 0xffff0000, v9
    v_lshlrev_b32 v24, 16, v10
    v_and_b32 v25, 0xffff0000, v10
    v_lshlrev_b32 v26, 16, v11
    v_and_b32 v27, 0xffff0000, v11
    v_add_f32 v28, v12, v13
    v_add_f32 v28, v28, v14
    v_add_f32 v28, v28, v15
    v_add_f32 v28, v28, v16
    v_add_f32 v28, v28, v17
    v_add_f32 v28, v28, v18
    v_add_f32 v28, v28, v19
    v_add_f32 v29, v20, v21
    v_add_f32 v29, v29, v22
    v_add_f32 v29, v29, v23
    v_add_f32 v29, v29, v24
    v_add_f32 v29, v29, v25
    v_add_f32 v29, v29, v26
    v_add_f32 v29, v29, v27
    s_nop 1
    v_add_f32_dpp v28, v28, v28 row_ror:8 row_mask:0xf bank_mask:0xf
    v_add_f32_dpp v29, v29, v29 row_ror:8 row_mask:0xf bank_mask:0xf
    s_nop 1
    v_add_f32_dpp v28, v28, v28 row_ror:4 row_mask:0xf bank_mask:0xf
    v_add_f32_dpp v29, v29, v29 row_ror:4 row_mask:0xf bank_mask:0xf
    s_nop 1
    v_add_f32_dpp v28, v28, v28 row_ror:2 row_mask:0xf bank_mask:0xf
    v_add_f32_dpp v29, v29, v29 row_ror:2 row_mask:0xf bank_mask:0xf
    s_nop 1
    v_add_f32_dpp v28, v28, v28 row_ror:1 row_mask:0xf bank_mask:0xf
    v_add_f32_dpp v29, v29, v29 row_ror:1 row_mask:0xf bank_mask:0xf
    v_mov_b32 v30, v28
    v_mov_b32 v31, v29
    s_nop 1
    v_permlane16_swap_b32 v28, v30
    v_permlane16_swap_b32 v29, v31
    s_nop 1
    v_add_f32 v28, v28, v30
    v_add_f32 v29, v29, v31
    v_mov_b32 v30, v28
    v_mov_b32 v31, v29
    s_nop 1
    v_permlane32_swap_b32 v28, v30
    v_permlane32_swap_b32 v29, v31
    s_nop 1
    v_add_f32 v28, v28, v30
    v_add_f32 v29, v29, v31
    v_mul_f32 v28, 0x3b000000, v28
    v_mul_f32 v29, 0x3b000000, v29
    v_sub_f32 v34, v12, v28
    v_mul_f32 v32, v34, v34
    v_sub_f32 v34, v13, v28
    v_fma_f32 v32, v34, v34, v32
    v_sub_f32 v34, v14, v28
    v_fma_f32 v32, v34, v34, v32
    v_sub_f32 v34, v15, v28
    v_fma_f32 v32, v34, v34, v32
    v_sub_f32 v34, v16, v28
    v_fma_f32 v32, v34, v34, v32
    v_sub_f32 v34, v17, v28
    v_fma_f32 v32, v34, v34, v32
    v_sub_f32 v34, v18, v28
    v_fma_f32 v32, v34, v34, v32
    v_sub_f32 v34, v19, v28
    v_fma_f32 v32, v34, v34, v32
    v_sub_f32 v34, v20, v29
    v_mul_f32 v33, v34, v34
    v_sub_f32 v34, v21, v29
    v_fma_f32 v33, v34, v34, v33
    v_sub_f32 v34, v22, v29
    v_fma_f32 v33, v34, v34, v33
    v_sub_f32 v34, v23, v29
    v_fma_f32 v33, v34, v34, v33
    v_sub_f32 v34, v24, v29
    v_fma_f32 v33, v34, v34, v33
    v_sub_f32 v34, v25, v29
    v_fma_f32 v33, v34, v34, v33
    v_sub_f32 v34, v26, v29
    v_fma_f32 v33, v34, v34, v33
    v_sub_f32 v34, v27, v29
    v_fma_f32 v33, v34, v34, v33
    s_nop 1
    v_add_f32_dpp v32, v32, v32 row_ror:8 row_mask:0xf bank_mask:0xf
    v_add_f32_dpp v33, v33, v33 row_ror:8 row_mask:0xf bank_mask:0xf
    s_nop 1
    v_add_f32_dpp v32, v32, v32 row_ror:4 row_mask:0xf bank_mask:0xf
    v_add_f32_dpp v33, v33, v33 row_ror:4 row_mask:0xf bank_mask:0xf
    s_nop 1
    v_add_f32_dpp v32, v32, v32 row_ror:2 row_mask:0xf bank_mask:0xf
    v_add_f32_dpp v33, v33, v33 row_ror:2 row_mask:0xf bank_mask:0xf
    s_nop 1
    v_add_f32_dpp v32, v32, v32 row_ror:1 row_mask:0xf bank_mask:0xf
    v_add_f32_dpp v33, v33, v33 row_ror:1 row_mask:0xf bank_mask:0xf
    v_mov_b32 v30, v32
    v_mov_b32 v31, v33
    s_nop 1
    v_permlane16_swap_b32 v32, v30
    v_permlane16_swap_b32 v33, v31
    s_nop 1
    v_add_f32 v32, v32, v30
    v_add_f32 v33, v33, v31
    v_mov_b32 v30, v32
    v_mov_b32 v31, v33
    s_nop 1
    v_permlane32_swap_b32 v32, v30
    v_permlane32_swap_b32 v33, v31
    s_nop 1
    v_add_f32 v32, v32, v30
    v_add_f32 v33, v33, v31
    v_mul_f32 v32, 0x3b000000, v32
    v_mul_f32 v33, 0x3b000000, v33
    v_cvt_pk_bf16_f32 v34, v28, v29
    v_lshlrev_b32 v28, 16, v34
    v_and_b32 v29, 0xffff0000, v34
    v_cvt_pk_bf16_f32 v34, v32, v33
    v_lshlrev_b32 v32, 16, v34
    v_and_b32 v33, 0xffff0000, v34
    v_add_f32 v32, 0x3727c5ac, v32
    v_add_f32 v33, 0x3727c5ac, v33
    v_cvt_pk_bf16_f32 v34, v32, v33
    v_lshlrev_b32 v32, 16, v34
    v_and_b32 v33, 0xffff0000, v34
    v_sqrt_f32 v32, v32
    v_sqrt_f32 v33, v33
    s_nop 0
    v_cvt_pk_bf16_f32 v34, v32, v33
    v_lshlrev_b32 v32, 16, v34
    v_and_b32 v33, 0xffff0000, v34
    v_rcp_f32 v32, v32
    v_rcp_f32 v33, v33
    s_nop 0
    v_sub_f32 v12, v12, v28
    v_sub_f32 v13, v13, v28
    v_cvt_pk_bf16_f32 v34, v12, v13
    v_lshlrev_b32 v12, 16, v34
    v_and_b32 v13, 0xffff0000, v34
    v_mul_f32 v12, v12, v32
    v_mul_f32 v13, v13, v32
    v_cvt_pk_bf16_f32 v4, v12, v13
    v_sub_f32 v14, v14, v28
    v_sub_f32 v15, v15, v28
    v_cvt_pk_bf16_f32 v34, v14, v15
    v_lshlrev_b32 v14, 16, v34
    v_and_b32 v15, 0xffff0000, v34
    v_mul_f32 v14, v14, v32
    v_mul_f32 v15, v15, v32
    v_cvt_pk_bf16_f32 v5, v14, v15
    v_sub_f32 v16, v16, v28
    v_sub_f32 v17, v17, v28
    v_cvt_pk_bf16_f32 v34, v16, v17
    v_lshlrev_b32 v16, 16, v34
    v_and_b32 v17, 0xffff0000, v34
    v_mul_f32 v16, v16, v32
    v_mul_f32 v17, v17, v32
    v_cvt_pk_bf16_f32 v6, v16, v17
    v_sub_f32 v18, v18, v28
    v_sub_f32 v19, v19, v28
    v_cvt_pk_bf16_f32 v34, v18, v19
    v_lshlrev_b32 v18, 16, v34
    v_and_b32 v19, 0xffff0000, v34
    v_mul_f32 v18, v18, v32
    v_mul_f32 v19, v19, v32
    v_cvt_pk_bf16_f32 v7, v18, v19
    v_sub_f32 v20, v20, v29
    v_sub_f32 v21, v21, v29
    v_cvt_pk_bf16_f32 v34, v20, v21
    v_lshlrev_b32 v20, 16, v34
    v_and_b32 v21, 0xffff0000, v34
    v_mul_f32 v20, v20, v33
    v_mul_f32 v21, v21, v33
    v_cvt_pk_bf16_f32 v8, v20, v21
    v_sub_f32 v22, v22, v29
    v_sub_f32 v23, v23, v29
    v_cvt_pk_bf16_f32 v34, v22, v23
    v_lshlrev_b32 v22, 16, v34
    v_and_b32 v23, 0xffff0000, v34
    v_mul_f32 v22, v22, v33
    v_mul_f32 v23, v23, v33
    v_cvt_pk_bf16_f32 v9, v22, v23
    v_sub_f32 v24, v24, v29
    v_sub_f32 v25, v25, v29
    v_cvt_pk_bf16_f32 v34, v24, v25
    v_lshlrev_b32 v24, 16, v34
    v_and_b32 v25, 0xffff0000, v34
    v_mul_f32 v24, v24, v33
    v_mul_f32 v25, v25, v33
    v_cvt_pk_bf16_f32 v10, v24, v25
    v_sub_f32 v26, v26, v29
    v_sub_f32 v27, v27, v29
    v_cvt_pk_bf16_f32 v34, v26, v27
    v_lshlrev_b32 v26, 16, v34
    v_and_b32 v27, 0xffff0000, v34
    v_mul_f32 v26, v26, v33
    v_mul_f32 v27, v27, v33
    v_cvt_pk_bf16_f32 v11, v26, v27
    v_mul_u32_u24 v2, 144, v0
    s_lshl_b32 s6, s3, 5
    v_add_u32 v2, s6, v2
    ds_write_b128 v2, v[4:7]
    ds_write_b128 v2, v[8:11] offset:16
    s_cmp_lg_u32 s3, 0
    s_cbranch_scc1 P0_NOW
    v_mov_b32 v3, 9216
    s_mov_b64 exec, 1
    ds_write_b32 v3, v40
    s_mov_b64 exec, -1
P0_NOW:
    s_waitcnt lgkmcnt(0)
    s_barrier
    v_lshrrev_b32 v2, 3, v0
    v_and_b32 v3, 7, v0
    s_lshl_b32 s6, s3, 4
    v_add_u32 v2, s6, v2
    v_mul_u32_u24 v12, 144, v2
    v_lshl_add_u32 v12, v3, 4, v12
    ds_read_b128 v[4:7], v12
    ds_read_b128 v[8:11], v12 offset:1152
    v_mov_b32 v13, 9216
    ds_read_b32 v14, v13
    v_lshlrev_b32 v2, 8, v2
    v_lshl_add_u32 v2, v3, 4, v2
    s_lshr_b32 s6, s2, 1
    s_lshl_b32 s6, s6, 14
    s_and_b32 s7, s2, 1
    s_lshl_b32 s7, s7, 7
    s_add_u32 s6, s6, s7
    s_waitcnt lgkmcnt(0)
    buffer_store_dwordx4 v[4:7], v2, s[36:39], s6 offen sc1
    buffer_store_dwordx4 v[8:11], v2, s[36:39], s6 offen offset:2048 sc1
    v_readfirstlane_b32 s6, v14
    s_mov_b32 s20, 1
    s_lshl_b32 s4, s5, 5
    s_add_u32 s4, s4, s6
    s_cmp_ge_u32 s6, 32
    s_cbranch_scc1 P0_OVF
    s_cmp_lt_u32 s5, 8
    s_cbranch_scc1 P0_ROLE
P0_OVF:
    s_waitcnt vmcnt(0)
    s_barrier
    s_cmp_lg_u32 s3, 0
    s_cbranch_scc1 AR_1
    v_mov_b32 v3, 128
    v_mov_b32 v2, 1
    s_mov_b64 exec, 1
    global_atomic_add v3, v2, s[32:33] sc1
    s_mov_b64 exec, -1
AR_1:
    s_mov_b32 s20, 0
    s_cmp_lg_u32 s3, 0
    s_cbranch_scc1 WDD_3
    v_mov_b32 v3, 128
    s_mov_b32 s60, 0
WD_2:
    global_load_dword v2, v3, s[32:33] sc1
    s_waitcnt vmcnt(0)
WD_2_F:
    v_readfirstlane_b32 s61, v2
    s_and_b32 s61, s61, 0xffff
    s_cmp_ge_u32 s61, 256
    s_cbranch_scc1 WDD_3
    s_add_u32 s60, s60, 1
    s_cmp_lt_u32 s60, 200000
    s_cbranch_scc1 WD_2
    v_mov_b32 v1, 1
    v_mov_b32 v2, 224
    global_atomic_or v2, v1, s[32:33] sc1
    s_waitcnt vmcnt(0)
    s_endpgm
WDD_3:
    s_barrier
    s_cmp_lg_u32 s3, 0
    s_cbranch_scc1 P0_OV2
    v_mov_b32 v3, 64
    v_mov_b32 v2, 1
    s_mov_b64 exec, 1
    global_atomic_add v4, v3, v2, s[32:33] sc0 sc1
    s_waitcnt vmcnt(0)
    v_mov_b32 v3, 9216
    ds_write_b32 v3, v4
    s_mov_b64 exec, -1
    s_waitcnt lgkmcnt(0)
P0_OV2:
    s_barrier
    v_mov_b32 v3, 9216
    ds_read_b32 v4, v3
    v_lshlrev_b32 v3, 2, v0
    v_and_b32 v3, 31, v3
    global_load_dword v5, v3, s[32:33] sc1
    s_waitcnt vmcnt(0) lgkmcnt(0)
    v_readfirstlane_b32 s6, v4
    s_mov_b32 s7, 0
P0_OV3:
    v_readlane_b32 s58, v5, s7
    s_min_u32 s58, s58, 32
    s_sub_u32 s59, 32, s58
    s_cmp_lt_u32 s6, s59
    s_cbranch_scc1 P0_OV4
    s_sub_u32 s6, s6, s59
    s_add_u32 s7, s7, 1
    s_cmp_lt_u32 s7, 8
    s_cbranch_scc1 P0_OV3
    s_endpgm
P0_OV4:
    s_lshl_b32 s4, s7, 5
    s_add_u32 s4, s4, s58
    s_add_u32 s4, s4, s6
P0_ROLE:
    s_cmp_lt_u32 s4, 32
    s_cbranch_scc1 REC_ENTRY
    s_sub_u32 s71, s4, 32
    s_mul_i32 s67, s71, 9363
    s_lshr_b32 s67, s67, 16
    s_mul_i32 s60, s67, 7
    s_sub_u32 s65, s71, s60
    s_mov_b32 s40, s14
    s_mov_b32 s41, s15
    s_mov_b32 s42, 4194304
    s_mov_b32 s43, 0x00020000
    s_mov_b32 s44, s16
    s_mov_b32 s45, s17
    s_mov_b32 s46, 4194304
    s_mov_b32 s47, 0x00020000
    s_lshl_b32 s60, s67, 8
    s_lshl_b32 s61, s3, 6
    s_add_u32 s61, s60, s61
    v_lshrrev_b32 v4, 4, v0
    v_and_b32 v5, 15, v0
    v_mul_u32_u24 v4, 65536, v4
    v_lshl_add_u32 v4, v5, 2, v4
    v_add_u32 v2, s61, v4
    v_add_u32 v3, s61, v4
    v_lshrrev_b32 v4, 1, v0
    v_and_b32 v5, 1, v0
    v_mul_u32_u24 v4, 8192, v4
    v_lshl_add_u32 v4, v5, 7, v4
    s_add_u32 s58, s65, 1
    s_and_b32 s59, s58, 3
    s_lshl_b32 s59, s59, 2
    s_add_u32 s59, s59, s3
    s_mul_i32 s59, s59, 262144
    s_cmp_ge_u32 s58, 4
    s_cbranch_scc1 TB_4
    s_add_u32 s59, s59, s60
    buffer_load_dword v6, v4, s[40:43], s59 offen
    s_branch TE_5
TB_4:
    s_add_u32 s59, s59, s60
    buffer_load_dword v6, v4, s[44:47], s59 offen
TE_5:
    s_add_u32 s58, s58, 4
    s_cmp_gt_u32 s58, 7
    s_cselect_b32 s59, 7, 0
    s_sub_u32 s58, s58, s59
    s_and_b32 s59, s58, 3
    s_lshl_b32 s59, s59, 2
    s_add_u32 s59, s59, s3
    s_mul_i32 s59, s59, 262144
    s_cmp_ge_u32 s58, 4
    s_cbranch_scc1 TB_6
    s_add_u32 s59, s59, s60
    buffer_load_dword v7, v4, s[40:43], s59 offen
    s_branch TE_7
TB_6:
    s_add_u32 s59, s59, s60
    buffer_load_dword v7, v4, s[44:47], s59 offen
TE_7:
    s_mov_b32 s60, 0
    buffer_load_dword v128, v2, s[40:43], s60 offen
    s_mov_b32 s60, 8192
    buffer_load_dword v129, v2, s[40:43], s60 offen
    s_mov_b32 s60, 16384
    buffer_load_dword v130, v2, s[40:43], s60 offen
    s_mov_b32 s60, 24576
    buffer_load_dword v131, v2, s[40:43], s60 offen
    s_mov_b32 s60, 32768
    buffer_load_dword v132, v2, s[40:43], s60 offen
    s_mov_b32 s60, 40960
    buffer_load_dword v133, v2, s[40:43], s60 offen
    s_mov_b32 s60, 49152
    buffer_load_dword v134, v2, s[40:43], s60 offen
    s_mov_b32 s60, 57344
    buffer_load_dword v135, v2, s[40:43], s60 offen
    s_mov_b32 s60, 262144
    buffer_load_dword v136, v2, s[40:43], s60 offen
    s_mov_b32 s60, 270336
    buffer_load_dword v137, v2, s[40:43], s60 offen
    s_mov_b32 s60, 278528
    buffer_load_dword v138, v2, s[40:43], s60 offen
    s_mov_b32 s60, 286720
    buffer_load_dword v139, v2, s[40:43], s60 offen
    s_mov_b32 s60, 294912
    buffer_load_dword v140, v2, s[40:43], s60 offen
    s_mov_b32 s60, 303104
    buffer_load_dword v141, v2, s[40:43], s60 offen
    s_mov_b32 s60, 311296
    buffer_load_dword v142, v2, s[40:43], s60 offen
    s_mov_b32 s60, 319488
    buffer_load_dword v143, v2, s[40:43], s60 offen
    s_mov_b32 s60, 524288
    buffer_load_dword v144, v2, s[40:43], s60 offen
    s_mov_b32 s60, 532480
    buffer_load_dword v145, v2, s[40:43], s60 offen
    s_mov_b32 s60, 540672
    buffer_load_dword v146, v2, s[40:43], s60 offen
    s_mov_b32 s60, 548864
    buffer_load_dword v147, v2, s[40:43], s60 offen
    s_mov_b32 s60, 557056
    buffer_load_dword v148, v2, s[40:43], s60 offen
    s_mov_b32 s60, 565248
    buffer_load_dword v149, v2, s[40:43], s60 offen
    s_mov_b32 s60, 573440
    buffer_load_dword v150, v2, s[40:43], s60 offen
    s_mov_b32 s60, 581632
    buffer_load_dword v151, v2, s[40:43], s60 offen
    s_mov_b32 s60, 786432
    buffer_load_dword v152, v2, s[40:43], s60 offen
    s_mov_b32 s60, 794624
    buffer_load_dword v153, v2, s[40:43], s60 offen
    s_mov_b32 s60, 802816
    buffer_load_dword v154, v2, s[40:43], s60 offen
    s_mov_b32 s60, 811008
    buffer_load_dword v155, v2, s[40:43], s60 offen
    s_mov_b32 s60, 819200
    buffer_load_dword v156, v2, s[40:43], s60 offen
    s_mov_b32 s60, 827392
    buffer_load_dword v157, v2, s[40:43], s60 offen
    s_mov_b32 s60, 835584
    buffer_load_dword v158, v2, s[40:43], s60 offen
    s_mov_b32 s60, 843776
    buffer_load_dword v159, v2, s[40:43], s60 offen
    s_mov_b32 s60, 1048576
    buffer_load_dword v160, v2, s[40:43], s60 offen
    s_mov_b32 s60, 1056768
    buffer_load_dword v161, v2, s[40:43], s60 offen
    s_mov_b32 s60, 1064960
    buffer_load_dword v162, v2, s[40:43], s60 offen
    s_mov_b32 s60, 1073152
    buffer_load_dword v163, v2, s[40:43], s60 offen
    s_mov_b32 s60, 1081344
    buffer_load_dword v164, v2, s[40:43], s60 offen
    s_mov_b32 s60, 1089536
    buffer_load_dword v165, v2, s[40:43], s60 offen
    s_mov_b32 s60, 1097728
    buffer_load_dword v166, v2, s[40:43], s60 offen
    s_mov_b32 s60, 1105920
    buffer_load_dword v167, v2, s[40:43], s60 offen
    s_mov_b32 s60, 1310720
    buffer_load_dword v168, v2, s[40:43], s60 offen
    s_mov_b32 s60, 1318912
    buffer_load_dword v169, v2, s[40:43], s60 offen
    s_mov_b32 s60, 1327104
    buffer_load_dword v170, v2, s[40:43], s60 offen
    s_mov_b32 s60, 1335296
    buffer_load_dword v171, v2, s[40:43], s60 offen
    s_mov_b32 s60, 1343488
    buffer_load_dword v172, v2, s[40:43], s60 offen
    s_mov_b32 s60, 1351680
    buffer_load_dword v173, v2, s[40:43], s60 offen
    s_mov_b32 s60, 1359872
    buffer_load_dword v174, v2, s[40:43], s60 offen
    s_mov_b32 s60, 1368064
    buffer_load_dword v175, v2, s[40:43], s60 offen
    s_mov_b32 s60, 1572864
    buffer_load_dword v176, v2, s[40:43], s60 offen
    s_mov_b32 s60, 1581056
    buffer_load_dword v177, v2, s[40:43], s60 offen
    s_mov_b32 s60, 1589248
    buffer_load_dword v178, v2, s[40:43], s60 offen
    s_mov_b32 s60, 1597440
    buffer_load_dword v179, v2, s[40:43], s60 offen
    s_mov_b32 s60, 1605632
    buffer_load_dword v180, v2, s[40:43], s60 offen
    s_mov_b32 s60, 1613824
    buffer_load_dword v181, v2, s[40:43], s60 offen
    s_mov_b32 s60, 1622016
    buffer_load_dword v182, v2, s[40:43], s60 offen
    s_mov_b32 s60, 1630208
    buffer_load_dword v183, v2, s[40:43], s60 offen
    s_waitcnt vmcnt(48)
    s_barrier
    s_cmp_lg_u32 s3, 0
    s_cbranch_scc1 AR_8
    s_add_u32 s60, s20, 0
    v_mov_b32 v21, 128
    v_mov_b32 v20, s60
    s_mov_b64 exec, 1
    global_atomic_add v21, v20, s[32:33] sc1
    s_mov_b64 exec, -1
AR_8:
    v_perm_b32 v4, v129, v128, s56
    v_perm_b32 v8, v129, v128, s57
    v_perm_b32 v5, v131, v130, s56
    v_perm_b32 v9, v131, v130, s57
    v_perm_b32 v6, v133, v132, s56
    v_perm_b32 v10, v133, v132, s57
    v_perm_b32 v7, v135, v134, s56
    v_perm_b32 v11, v135, v134, s57
    v_accvgpr_write_b32 a0, v4
    v_accvgpr_write_b32 a64, v8
    v_accvgpr_write_b32 a1, v5
    v_accvgpr_write_b32 a65, v9
    v_accvgpr_write_b32 a2, v6
    v_accvgpr_write_b32 a66, v10
    v_accvgpr_write_b32 a3, v7
    v_accvgpr_write_b32 a67, v11
    s_mov_b32 s60, 1835008
    buffer_load_dword v184, v2, s[40:43], s60 offen
    s_mov_b32 s60, 1843200
    buffer_load_dword v185, v2, s[40:43], s60 offen
    s_mov_b32 s60, 1851392
    buffer_load_dword v186, v2, s[40:43], s60 offen
    s_mov_b32 s60, 1859584
    buffer_load_dword v187, v2, s[40:43], s60 offen
    s_mov_b32 s60, 1867776
    buffer_load_dword v188, v2, s[40:43], s60 offen
    s_mov_b32 s60, 1875968
    buffer_load_dword v189, v2, s[40:43], s60 offen
    s_mov_b32 s60, 1884160
    buffer_load_dword v190, v2, s[40:43], s60 offen
    s_mov_b32 s60, 1892352
    buffer_load_dword v191, v2, s[40:43], s60 offen
    s_waitcnt vmcnt(48)
    v_perm_b32 v4, v137, v136, s56
    v_perm_b32 v8, v137, v136, s57
    v_perm_b32 v5, v139, v138, s56
    v_perm_b32 v9, v139, v138, s57
    v_perm_b32 v6, v141, v140, s56
    v_perm_b32 v10, v141, v140, s57
    v_perm_b32 v7, v143, v142, s56
    v_perm_b32 v11, v143, v142, s57
    v_accvgpr_write_b32 a4, v4
    v_accvgpr_write_b32 a68, v8
    v_accvgpr_write_b32 a5, v5
    v_accvgpr_write_b32 a69, v9
    v_accvgpr_write_b32 a6, v6
    v_accvgpr_write_b32 a70, v10
    v_accvgpr_write_b32 a7, v7
    v_accvgpr_write_b32 a71, v11
    s_mov_b32 s60, 2097152
    buffer_load_dword v128, v2, s[40:43], s60 offen
    s_mov_b32 s60, 2105344
    buffer_load_dword v129, v2, s[40:43], s60 offen
    s_mov_b32 s60, 2113536
    buffer_load_dword v130, v2, s[40:43], s60 offen
    s_mov_b32 s60, 2121728
    buffer_load_dword v131, v2, s[40:43], s60 offen
    s_mov_b32 s60, 2129920
    buffer_load_dword v132, v2, s[40:43], s60 offen
    s_mov_b32 s60, 2138112
    buffer_load_dword v133, v2, s[40:43], s60 offen
    s_mov_b32 s60, 2146304
    buffer_load_dword v134, v2, s[40:43], s60 offen
    s_mov_b32 s60, 2154496
    buffer_load_dword v135, v2, s[40:43], s60 offen
    s_waitcnt vmcnt(48)
    v_perm_b32 v4, v145, v144, s56
    v_perm_b32 v8, v145, v144, s57
    v_perm_b32 v5, v147, v146, s56
    v_perm_b32 v9, v147, v146, s57
    v_perm_b32 v6, v149, v148, s56
    v_perm_b32 v10, v149, v148, s57
    v_perm_b32 v7, v151, v150, s56
    v_perm_b32 v11, v151, v150, s57
    v_accvgpr_write_b32 a8, v4
    v_accvgpr_write_b32 a72, v8
    v_accvgpr_write_b32 a9, v5
    v_accvgpr_write_b32 a73, v9
    v_accvgpr_write_b32 a10, v6
    v_accvgpr_write_b32 a74, v10
    v_accvgpr_write_b32 a11, v7
    v_accvgpr_write_b32 a75, v11
    s_mov_b32 s60, 2359296
    buffer_load_dword v136, v2, s[40:43], s60 offen
    s_mov_b32 s60, 2367488
    buffer_load_dword v137, v2, s[40:43], s60 offen
    s_mov_b32 s60, 2375680
    buffer_load_dword v138, v2, s[40:43], s60 offen
    s_mov_b32 s60, 2383872
    buffer_load_dword v139, v2, s[40:43], s60 offen
    s_mov_b32 s60, 2392064
    buffer_load_dword v140, v2, s[40:43], s60 offen
    s_mov_b32 s60, 2400256
    buffer_load_dword v141, v2, s[40:43], s60 offen
    s_mov_b32 s60, 2408448
    buffer_load_dword v142, v2, s[40:43], s60 offen
    s_mov_b32 s60, 2416640
    buffer_load_dword v143, v2, s[40:43], s60 offen
    s_waitcnt vmcnt(48)
    v_perm_b32 v4, v153, v152, s56
    v_perm_b32 v8, v153, v152, s57
    v_perm_b32 v5, v155, v154, s56
    v_perm_b32 v9, v155, v154, s57
    v_perm_b32 v6, v157, v156, s56
    v_perm_b32 v10, v157, v156, s57
    v_perm_b32 v7, v159, v158, s56
    v_perm_b32 v11, v159, v158, s57
    v_accvgpr_write_b32 a12, v4
    v_accvgpr_write_b32 a76, v8
    v_accvgpr_write_b32 a13, v5
    v_accvgpr_write_b32 a77, v9
    v_accvgpr_write_b32 a14, v6
    v_accvgpr_write_b32 a78, v10
    v_accvgpr_write_b32 a15, v7
    v_accvgpr_write_b32 a79, v11
    s_mov_b32 s60, 2621440
    buffer_load_dword v144, v2, s[40:43], s60 offen
    s_mov_b32 s60, 2629632
    buffer_load_dword v145, v2, s[40:43], s60 offen
    s_mov_b32 s60, 2637824
    buffer_load_dword v146, v2, s[40:43], s60 offen
    s_mov_b32 s60, 2646016
    buffer_load_dword v147, v2, s[40:43], s60 offen
    s_mov_b32 s60, 2654208
    buffer_load_dword v148, v2, s[40:43], s60 offen
    s_mov_b32 s60, 2662400
    buffer_load_dword v149, v2, s[40:43], s60 offen
    s_mov_b32 s60, 2670592
    buffer_load_dword v150, v2, s[40:43], s60 offen
    s_mov_b32 s60, 2678784
    buffer_load_dword v151, v2, s[40:43], s60 offen
    s_waitcnt vmcnt(48)
    v_perm_b32 v4, v161, v160, s56
    v_perm_b32 v8, v161, v160, s57
    v_perm_b32 v5, v163, v162, s56
    v_perm_b32 v9, v163, v162, s57
    v_perm_b32 v6, v165, v164, s56
    v_perm_b32 v10, v165, v164, s57
    v_perm_b32 v7, v167, v166, s56
    v_perm_b32 v11, v167, v166, s57
    v_accvgpr_write_b32 a16, v4
    v_accvgpr_write_b32 a80, v8
    v_accvgpr_write_b32 a17, v5
    v_accvgpr_write_b32 a81, v9
    v_accvgpr_write_b32 a18, v6
    v_accvgpr_write_b32 a82, v10
    v_accvgpr_write_b32 a19, v7
    v_accvgpr_write_b32 a83, v11
    s_mov_b32 s60, 2883584
    buffer_load_dword v152, v2, s[40:43], s60 offen
    s_mov_b32 s60, 2891776
    buffer_load_dword v153, v2, s[40:43], s60 offen
    s_mov_b32 s60, 2899968
    buffer_load_dword v154, v2, s[40:43], s60 offen
    s_mov_b32 s60, 2908160
    buffer_load_dword v155, v2, s[40:43], s60 offen
    s_mov_b32 s60, 2916352
    buffer_load_dword v156, v2, s[40:43], s60 offen
    s_mov_b32 s60, 2924544
    buffer_load_dword v157, v2, s[40:43], s60 offen
    s_mov_b32 s60, 2932736
    buffer_load_dword v158, v2, s[40:43], s60 offen
    s_mov_b32 s60, 2940928
    buffer_load_dword v159, v2, s[40:43], s60 offen
    s_waitcnt vmcnt(48)
    v_perm_b32 v4, v169, v168, s56
    v_perm_b32 v8, v169, v168, s57
    v_perm_b32 v5, v171, v170, s56
    v_perm_b32 v9, v171, v170, s57
    v_perm_b32 v6, v173, v172, s56
    v_perm_b32 v10, v173, v172, s57
    v_perm_b32 v7, v175, v174, s56
    v_perm_b32 v11, v175, v174, s57
    v_accvgpr_write_b32 a20, v4
    v_accvgpr_write_b32 a84, v8
    v_accvgpr_write_b32 a21, v5
    v_accvgpr_write_b32 a85, v9
    v_accvgpr_write_b32 a22, v6
    v_accvgpr_write_b32 a86, v10
    v_accvgpr_write_b32 a23, v7
    v_accvgpr_write_b32 a87, v11
    s_mov_b32 s60, 3145728
    buffer_load_dword v160, v2, s[40:43], s60 offen
    s_mov_b32 s60, 3153920
    buffer_load_dword v161, v2, s[40:43], s60 offen
    s_mov_b32 s60, 3162112
    buffer_load_dword v162, v2, s[40:43], s60 offen
    s_mov_b32 s60, 3170304
    buffer_load_dword v163, v2, s[40:43], s60 offen
    s_mov_b32 s60, 3178496
    buffer_load_dword v164, v2, s[40:43], s60 offen
    s_mov_b32 s60, 3186688
    buffer_load_dword v165, v2, s[40:43], s60 offen
    s_mov_b32 s60, 3194880
    buffer_load_dword v166, v2, s[40:43], s60 offen
    s_mov_b32 s60, 3203072
    buffer_load_dword v167, v2, s[40:43], s60 offen
    s_waitcnt vmcnt(48)
    v_perm_b32 v4, v177, v176, s56
    v_perm_b32 v8, v177, v176, s57
    v_perm_b32 v5, v179, v178, s56
    v_perm_b32 v9, v179, v178, s57
    v_perm_b32 v6, v181, v180, s56
    v_perm_b32 v10, v181, v180, s57
    v_perm_b32 v7, v183, v182, s56
    v_perm_b32 v11, v183, v182, s57
    v_accvgpr_write_b32 a24, v4
    v_accvgpr_write_b32 a88, v8
    v_accvgpr_write_b32 a25, v5
    v_accvgpr_write_b32 a89, v9
    v_accvgpr_write_b32 a26, v6
    v_accvgpr_write_b32 a90, v10
    v_accvgpr_write_b32 a27, v7
    v_accvgpr_write_b32 a91, v11
    s_mov_b32 s60, 3407872
    buffer_load_dword v168, v2, s[40:43], s60 offen
    s_mov_b32 s60, 3416064
    buffer_load_dword v169, v2, s[40:43], s60 offen
    s_mov_b32 s60, 3424256
    buffer_load_dword v170, v2, s[40:43], s60 offen
    s_mov_b32 s60, 3432448
    buffer_load_dword v171, v2, s[40:43], s60 offen
    s_mov_b32 s60, 3440640
    buffer_load_dword v172, v2, s[40:43], s60 offen
    s_mov_b32 s60, 3448832
    buffer_load_dword v173, v2, s[40:43], s60 offen
    s_mov_b32 s60, 3457024
    buffer_load_dword v174, v2, s[40:43], s60 offen
    s_mov_b32 s60, 3465216
    buffer_load_dword v175, v2, s[40:43], s60 offen
    s_waitcnt vmcnt(48)
    v_perm_b32 v4, v185, v184, s56
    v_perm_b32 v8, v185, v184, s57
    v_perm_b32 v5, v187, v186, s56
    v_perm_b32 v9, v187, v186, s57
    v_perm_b32 v6, v189, v188, s56
    v_perm_b32 v10, v189, v188, s57
    v_perm_b32 v7, v191, v190, s56
    v_perm_b32 v11, v191, v190, s57
    v_accvgpr_write_b32 a28, v4
    v_accvgpr_write_b32 a92, v8
    v_accvgpr_write_b32 a29, v5
    v_accvgpr_write_b32 a93, v9
    v_accvgpr_write_b32 a30, v6
    v_accvgpr_write_b32 a94, v10
    v_accvgpr_write_b32 a31, v7
    v_accvgpr_write_b32 a95, v11
    s_mov_b32 s60, 3670016
    buffer_load_dword v176, v2, s[40:43], s60 offen
    s_mov_b32 s60, 3678208
    buffer_load_dword v177, v2, s[40:43], s60 offen
    s_mov_b32 s60, 3686400
    buffer_load_dword v178, v2, s[40:43], s60 offen
    s_mov_b32 s60, 3694592
    buffer_load_dword v179, v2, s[40:43], s60 offen
    s_mov_b32 s60, 3702784
    buffer_load_dword v180, v2, s[40:43], s60 offen
    s_mov_b32 s60, 3710976
    buffer_load_dword v181, v2, s[40:43], s60 offen
    s_mov_b32 s60, 3719168
    buffer_load_dword v182, v2, s[40:43], s60 offen
    s_mov_b32 s60, 3727360
    buffer_load_dword v183, v2, s[40:43], s60 offen
    s_waitcnt vmcnt(48)
    v_perm_b32 v4, v129, v128, s56
    v_perm_b32 v8, v129, v128, s57
    v_perm_b32 v5, v131, v130, s56
    v_perm_b32 v9, v131, v130, s57
    v_perm_b32 v6, v133, v132, s56
    v_perm_b32 v10, v133, v132, s57
    v_perm_b32 v7, v135, v134, s56
    v_perm_b32 v11, v135, v134, s57
    v_accvgpr_write_b32 a32, v4
    v_accvgpr_write_b32 a96, v8
    v_accvgpr_write_b32 a33, v5
    v_accvgpr_write_b32 a97, v9
    v_accvgpr_write_b32 a34, v6
    v_accvgpr_write_b32 a98, v10
    v_accvgpr_write_b32 a35, v7
    v_accvgpr_write_b32 a99, v11
    s_mov_b32 s60, 3932160
    buffer_load_dword v184, v2, s[40:43], s60 offen
    s_mov_b32 s60, 3940352
    buffer_load_dword v185, v2, s[40:43], s60 offen
    s_mov_b32 s60, 3948544
    buffer_load_dword v186, v2, s[40:43], s60 offen
    s_mov_b32 s60, 3956736
    buffer_load_dword v187, v2, s[40:43], s60 offen
    s_mov_b32 s60, 3964928
    buffer_load_dword v188, v2, s[40:43], s60 offen
    s_mov_b32 s60, 3973120
    buffer_load_dword v189, v2, s[40:43], s60 offen
    s_mov_b32 s60, 3981312
    buffer_load_dword v190, v2, s[40:43], s60 offen
    s_mov_b32 s60, 3989504
    buffer_load_dword v191, v2, s[40:43], s60 offen
    s_waitcnt vmcnt(48)
    v_perm_b32 v4, v137, v136, s56
    v_perm_b32 v8, v137, v136, s57
    v_perm_b32 v5, v139, v138, s56
    v_perm_b32 v9, v139, v138, s57
    v_perm_b32 v6, v141, v140, s56
    v_perm_b32 v10, v141, v140, s57
    v_perm_b32 v7, v143, v142, s56
    v_perm_b32 v11, v143, v142, s57
    v_accvgpr_write_b32 a36, v4
    v_accvgpr_write_b32 a100, v8
    v_accvgpr_write_b32 a37, v5
    v_accvgpr_write_b32 a101, v9
    v_accvgpr_write_b32 a38, v6
    v_accvgpr_write_b32 a102, v10
    v_accvgpr_write_b32 a39, v7
    v_accvgpr_write_b32 a103, v11
    s_mov_b32 s60, 0
    buffer_load_dword v128, v3, s[44:47], s60 offen
    s_mov_b32 s60, 8192
    buffer_load_dword v129, v3, s[44:47], s60 offen
    s_mov_b32 s60, 16384
    buffer_load_dword v130, v3, s[44:47], s60 offen
    s_mov_b32 s60, 24576
    buffer_load_dword v131, v3, s[44:47], s60 offen
    s_mov_b32 s60, 32768
    buffer_load_dword v132, v3, s[44:47], s60 offen
    s_mov_b32 s60, 40960
    buffer_load_dword v133, v3, s[44:47], s60 offen
    s_mov_b32 s60, 49152
    buffer_load_dword v134, v3, s[44:47], s60 offen
    s_mov_b32 s60, 57344
    buffer_load_dword v135, v3, s[44:47], s60 offen
    s_waitcnt vmcnt(48)
    v_perm_b32 v4, v145, v144, s56
    v_perm_b32 v8, v145, v144, s57
    v_perm_b32 v5, v147, v146, s56
    v_perm_b32 v9, v147, v146, s57
    v_perm_b32 v6, v149, v148, s56
    v_perm_b32 v10, v149, v148, s57
    v_perm_b32 v7, v151, v150, s56
    v_perm_b32 v11, v151, v150, s57
    v_accvgpr_write_b32 a40, v4
    v_accvgpr_write_b32 a104, v8
    v_accvgpr_write_b32 a41, v5
    v_accvgpr_write_b32 a105, v9
    v_accvgpr_write_b32 a42, v6
    v_accvgpr_write_b32 a106, v10
    v_accvgpr_write_b32 a43, v7
    v_accvgpr_write_b32 a107, v11
    s_mov_b32 s60, 262144
    buffer_load_dword v136, v3, s[44:47], s60 offen
    s_mov_b32 s60, 270336
    buffer_load_dword v137, v3, s[44:47], s60 offen
    s_mov_b32 s60, 278528
    buffer_load_dword v138, v3, s[44:47], s60 offen
    s_mov_b32 s60, 286720
    buffer_load_dword v139, v3, s[44:47], s60 offen
    s_mov_b32 s60, 294912
    buffer_load_dword v140, v3, s[44:47], s60 offen
    s_mov_b32 s60, 303104
    buffer_load_dword v141, v3, s[44:47], s60 offen
    s_mov_b32 s60, 311296
    buffer_load_dword v142, v3, s[44:47], s60 offen
    s_mov_b32 s60, 319488
    buffer_load_dword v143, v3, s[44:47], s60 offen
    s_waitcnt vmcnt(48)
    v_perm_b32 v4, v153, v152, s56
    v_perm_b32 v8, v153, v152, s57
    v_perm_b32 v5, v155, v154, s56
    v_perm_b32 v9, v155, v154, s57
    v_perm_b32 v6, v157, v156, s56
    v_perm_b32 v10, v157, v156, s57
    v_perm_b32 v7, v159, v158, s56
    v_perm_b32 v11, v159, v158, s57
    v_accvgpr_write_b32 a44, v4
    v_accvgpr_write_b32 a108, v8
    v_accvgpr_write_b32 a45, v5
    v_accvgpr_write_b32 a109, v9
    v_accvgpr_write_b32 a46, v6
    v_accvgpr_write_b32 a110, v10
    v_accvgpr_write_b32 a47, v7
    v_accvgpr_write_b32 a111, v11
    s_mov_b32 s60, 524288
    buffer_load_dword v144, v3, s[44:47], s60 offen
    s_mov_b32 s60, 532480
    buffer_load_dword v145, v3, s[44:47], s60 offen
    s_mov_b32 s60, 540672
    buffer_load_dword v146, v3, s[44:47], s60 offen
    s_mov_b32 s60, 548864
    buffer_load_dword v147, v3, s[44:47], s60 offen
    s_mov_b32 s60, 557056
    buffer_load_dword v148, v3, s[44:47], s60 offen
    s_mov_b32 s60, 565248
    buffer_load_dword v149, v3, s[44:47], s60 offen
    s_mov_b32 s60, 573440
    buffer_load_dword v150, v3, s[44:47], s60 offen
    s_mov_b32 s60, 581632
    buffer_load_dword v151, v3, s[44:47], s60 offen
    s_waitcnt vmcnt(48)
    v_perm_b32 v4, v161, v160, s56
    v_perm_b32 v8, v161, v160, s57
    v_perm_b32 v5, v163, v162, s56
    v_perm_b32 v9, v163, v162, s57
    v_perm_b32 v6, v165, v164, s56
    v_perm_b32 v10, v165, v164, s57
    v_perm_b32 v7, v167, v166, s56
    v_perm_b32 v11, v167, v166, s57
    v_accvgpr_write_b32 a48, v4
    v_accvgpr_write_b32 a112, v8
    v_accvgpr_write_b32 a49, v5
    v_accvgpr_write_b32 a113, v9
    v_accvgpr_write_b32 a50, v6
    v_accvgpr_write_b32 a114, v10
    v_accvgpr_write_b32 a51, v7
    v_accvgpr_write_b32 a115, v11
    s_mov_b32 s60, 786432
    buffer_load_dword v152, v3, s[44:47], s60 offen
    s_mov_b32 s60, 794624
    buffer_load_dword v153, v3, s[44:47], s60 offen
    s_mov_b32 s60, 802816
    buffer_load_dword v154, v3, s[44:47], s60 offen
    s_mov_b32 s60, 811008
    buffer_load_dword v155, v3, s[44:47], s60 offen
    s_mov_b32 s60, 819200
    buffer_load_dword v156, v3, s[44:47], s60 offen
    s_mov_b32 s60, 827392
    buffer_load_dword v157, v3, s[44:47], s60 offen
    s_mov_b32 s60, 835584
    buffer_load_dword v158, v3, s[44:47], s60 offen
    s_mov_b32 s60, 843776
    buffer_load_dword v159, v3, s[44:47], s60 offen
    s_waitcnt vmcnt(48)
    v_perm_b32 v4, v169, v168, s56
    v_perm_b32 v8, v169, v168, s57
    v_perm_b32 v5, v171, v170, s56
    v_perm_b32 v9, v171, v170, s57
    v_perm_b32 v6, v173, v172, s56
    v_perm_b32 v10, v173, v172, s57
    v_perm_b32 v7, v175, v174, s56
    v_perm_b32 v11, v175, v174, s57
    v_accvgpr_write_b32 a52, v4
    v_accvgpr_write_b32 a116, v8
    v_accvgpr_write_b32 a53, v5
    v_accvgpr_write_b32 a117, v9
    v_accvgpr_write_b32 a54, v6
    v_accvgpr_write_b32 a118, v10
    v_accvgpr_write_b32 a55, v7
    v_accvgpr_write_b32 a119, v11
    s_mov_b32 s60, 1048576
    buffer_load_dword v160, v3, s[44:47], s60 offen
    s_mov_b32 s60, 1056768
    buffer_load_dword v161, v3, s[44:47], s60 offen
    s_mov_b32 s60, 1064960
    buffer_load_dword v162, v3, s[44:47], s60 offen
    s_mov_b32 s60, 1073152
    buffer_load_dword v163, v3, s[44:47], s60 offen
    s_mov_b32 s60, 1081344
    buffer_load_dword v164, v3, s[44:47], s60 offen
    s_mov_b32 s60, 1089536
    buffer_load_dword v165, v3, s[44:47], s60 offen
    s_mov_b32 s60, 1097728
    buffer_load_dword v166, v3, s[44:47], s60 offen
    s_mov_b32 s60, 1105920
    buffer_load_dword v167, v3, s[44:47], s60 offen
    s_waitcnt vmcnt(48)
    v_perm_b32 v4, v177, v176, s56
    v_perm_b32 v8, v177, v176, s57
    v_perm_b32 v5, v179, v178, s56
    v_perm_b32 v9, v179, v178, s57
    v_perm_b32 v6, v181, v180, s56
    v_perm_b32 v10, v181, v180, s57
    v_perm_b32 v7, v183, v182, s56
    v_perm_b32 v11, v183, v182, s57
    v_accvgpr_write_b32 a56, v4
    v_accvgpr_write_b32 a120, v8
    v_accvgpr_write_b32 a57, v5
    v_accvgpr_write_b32 a121, v9
    v_accvgpr_write_b32 a58, v6
    v_accvgpr_write_b32 a122, v10
    v_accvgpr_write_b32 a59, v7
    v_accvgpr_write_b32 a123, v11
    s_mov_b32 s60, 1310720
    buffer_load_dword v168, v3, s[44:47], s60 offen
    s_mov_b32 s60, 1318912
    buffer_load_dword v169, v3, s[44:47], s60 offen
    s_mov_b32 s60, 1327104
    buffer_load_dword v170, v3, s[44:47], s60 offen
    s_mov_b32 s60, 1335296
    buffer_load_dword v171, v3, s[44:47], s60 offen
    s_mov_b32 s60, 1343488
    buffer_load_dword v172, v3, s[44:47], s60 offen
    s_mov_b32 s60, 1351680
    buffer_load_dword v173, v3, s[44:47], s60 offen
    s_mov_b32 s60, 1359872
    buffer_load_dword v174, v3, s[44:47], s60 offen
    s_mov_b32 s60, 1368064
    buffer_load_dword v175, v3, s[44:47], s60 offen
    s_waitcnt vmcnt(48)
    v_perm_b32 v4, v185, v184, s56
    v_perm_b32 v8, v185, v184, s57
    v_perm_b32 v5, v187, v186, s56
    v_perm_b32 v9, v187, v186, s57
    v_perm_b32 v6, v189, v188, s56
    v_perm_b32 v10, v189, v188, s57
    v_perm_b32 v7, v191, v190, s56
    v_perm_b32 v11, v191, v190, s57
    v_accvgpr_write_b32 a60, v4
    v_accvgpr_write_b32 a124, v8
    v_accvgpr_write_b32 a61, v5
    v_accvgpr_write_b32 a125, v9
    v_accvgpr_write_b32 a62, v6
    v_accvgpr_write_b32 a126, v10
    v_accvgpr_write_b32 a63, v7
    v_accvgpr_write_b32 a127, v11
    s_mov_b32 s60, 1572864
    buffer_load_dword v176, v3, s[44:47], s60 offen
    s_mov_b32 s60, 1581056
    buffer_load_dword v177, v3, s[44:47], s60 offen
    s_mov_b32 s60, 1589248
    buffer_load_dword v178, v3, s[44:47], s60 offen
    s_mov_b32 s60, 1597440
    buffer_load_dword v179, v3, s[44:47], s60 offen
    s_mov_b32 s60, 1605632
    buffer_load_dword v180, v3, s[44:47], s60 offen
    s_mov_b32 s60, 1613824
    buffer_load_dword v181, v3, s[44:47], s60 offen
    s_mov_b32 s60, 1622016
    buffer_load_dword v182, v3, s[44:47], s60 offen
    s_mov_b32 s60, 1630208
    buffer_load_dword v183, v3, s[44:47], s60 offen
    s_waitcnt vmcnt(48)
    v_perm_b32 v4, v129, v128, s56
    v_perm_b32 v8, v129, v128, s57
    v_perm_b32 v5, v131, v130, s56
    v_perm_b32 v9, v131, v130, s57
    v_perm_b32 v6, v133, v132, s56
    v_perm_b32 v10, v133, v132, s57
    v_perm_b32 v7, v135, v134, s56
    v_perm_b32 v11, v135, v134, s57
    v_accvgpr_write_b32 a128, v4
    v_accvgpr_write_b32 a192, v8
    v_accvgpr_write_b32 a129, v5
    v_accvgpr_write_b32 a193, v9
    v_accvgpr_write_b32 a130, v6
    v_accvgpr_write_b32 a194, v10
    v_accvgpr_write_b32 a131, v7
    v_accvgpr_write_b32 a195, v11
    s_mov_b32 s60, 1835008
    buffer_load_dword v184, v3, s[44:47], s60 offen
    s_mov_b32 s60, 1843200
    buffer_load_dword v185, v3, s[44:47], s60 offen
    s_mov_b32 s60, 1851392
    buffer_load_dword v186, v3, s[44:47], s60 offen
    s_mov_b32 s60, 1859584
    buffer_load_dword v187, v3, s[44:47], s60 offen
    s_mov_b32 s60, 1867776
    buffer_load_dword v188, v3, s[44:47], s60 offen
    s_mov_b32 s60, 1875968
    buffer_load_dword v189, v3, s[44:47], s60 offen
    s_mov_b32 s60, 1884160
    buffer_load_dword v190, v3, s[44:47], s60 offen
    s_mov_b32 s60, 1892352
    buffer_load_dword v191, v3, s[44:47], s60 offen
    s_waitcnt vmcnt(48)
    v_perm_b32 v4, v137, v136, s56
    v_perm_b32 v8, v137, v136, s57
    v_perm_b32 v5, v139, v138, s56
    v_perm_b32 v9, v139, v138, s57
    v_perm_b32 v6, v141, v140, s56
    v_perm_b32 v10, v141, v140, s57
    v_perm_b32 v7, v143, v142, s56
    v_perm_b32 v11, v143, v142, s57
    v_accvgpr_write_b32 a132, v4
    v_accvgpr_write_b32 a196, v8
    v_accvgpr_write_b32 a133, v5
    v_accvgpr_write_b32 a197, v9
    v_accvgpr_write_b32 a134, v6
    v_accvgpr_write_b32 a198, v10
    v_accvgpr_write_b32 a135, v7
    v_accvgpr_write_b32 a199, v11
    s_mov_b32 s60, 2097152
    buffer_load_dword v128, v3, s[44:47], s60 offen
    s_mov_b32 s60, 2105344
    buffer_load_dword v129, v3, s[44:47], s60 offen
    s_mov_b32 s60, 2113536
    buffer_load_dword v130, v3, s[44:47], s60 offen
    s_mov_b32 s60, 2121728
    buffer_load_dword v131, v3, s[44:47], s60 offen
    s_mov_b32 s60, 2129920
    buffer_load_dword v132, v3, s[44:47], s60 offen
    s_mov_b32 s60, 2138112
    buffer_load_dword v133, v3, s[44:47], s60 offen
    s_mov_b32 s60, 2146304
    buffer_load_dword v134, v3, s[44:47], s60 offen
    s_mov_b32 s60, 2154496
    buffer_load_dword v135, v3, s[44:47], s60 offen
    s_waitcnt vmcnt(48)
    s_cmp_lg_u32 s3, 0
    s_cbranch_scc1 WA_9
    v_mov_b32 v21, 128
    global_load_dword v20, v21, s[32:33] sc1
WA_9:
    v_perm_b32 v4, v145, v144, s56
    v_perm_b32 v8, v145, v144, s57
    v_perm_b32 v5, v147, v146, s56
    v_perm_b32 v9, v147, v146, s57
    v_perm_b32 v6, v149, v148, s56
    v_perm_b32 v10, v149, v148, s57
    v_perm_b32 v7, v151, v150, s56
    v_perm_b32 v11, v151, v150, s57
    v_accvgpr_write_b32 a136, v4
    v_accvgpr_write_b32 a200, v8
    v_accvgpr_write_b32 a137, v5
    v_accvgpr_write_b32 a201, v9
    v_accvgpr_write_b32 a138, v6
    v_accvgpr_write_b32 a202, v10
    v_accvgpr_write_b32 a139, v7
    v_accvgpr_write_b32 a203, v11
    s_mov_b32 s60, 2359296
    buffer_load_dword v136, v3, s[44:47], s60 offen
    s_mov_b32 s60, 2367488
    buffer_load_dword v137, v3, s[44:47], s60 offen
    s_mov_b32 s60, 2375680
    buffer_load_dword v138, v3, s[44:47], s60 offen
    s_mov_b32 s60, 2383872
    buffer_load_dword v139, v3, s[44:47], s60 offen
    s_mov_b32 s60, 2392064
    buffer_load_dword v140, v3, s[44:47], s60 offen
    s_mov_b32 s60, 2400256
    buffer_load_dword v141, v3, s[44:47], s60 offen
    s_mov_b32 s60, 2408448
    buffer_load_dword v142, v3, s[44:47], s60 offen
    s_mov_b32 s60, 2416640
    buffer_load_dword v143, v3, s[44:47], s60 offen
    s_waitcnt vmcnt(48)
    v_perm_b32 v4, v153, v152, s56
    v_perm_b32 v8, v153, v152, s57
    v_perm_b32 v5, v155, v154, s56
    v_perm_b32 v9, v155, v154, s57
    v_perm_b32 v6, v157, v156, s56
    v_perm_b32 v10, v157, v156, s57
    v_perm_b32 v7, v159, v158, s56
    v_perm_b32 v11, v159, v158, s57
    v_accvgpr_write_b32 a140, v4
    v_accvgpr_write_b32 a204, v8
    v_accvgpr_write_b32 a141, v5
    v_accvgpr_write_b32 a205, v9
    v_accvgpr_write_b32 a142, v6
    v_accvgpr_write_b32 a206, v10
    v_accvgpr_write_b32 a143, v7
    v_accvgpr_write_b32 a207, v11
    s_mov_b32 s60, 2621440
    buffer_load_dword v144, v3, s[44:47], s60 offen
    s_mov_b32 s60, 2629632
    buffer_load_dword v145, v3, s[44:47], s60 offen
    s_mov_b32 s60, 2637824
    buffer_load_dword v146, v3, s[44:47], s60 offen
    s_mov_b32 s60, 2646016
    buffer_load_dword v147, v3, s[44:47], s60 offen
    s_mov_b32 s60, 2654208
    buffer_load_dword v148, v3, s[44:47], s60 offen
    s_mov_b32 s60, 2662400
    buffer_load_dword v149, v3, s[44:47], s60 offen
    s_mov_b32 s60, 2670592
    buffer_load_dword v150, v3, s[44:47], s60 offen
    s_mov_b32 s60, 2678784
    buffer_load_dword v151, v3, s[44:47], s60 offen
    s_waitcnt vmcnt(48)
    v_perm_b32 v4, v161, v160, s56
    v_perm_b32 v8, v161, v160, s57
    v_perm_b32 v5, v163, v162, s56
    v_perm_b32 v9, v163, v162, s57
    v_perm_b32 v6, v165, v164, s56
    v_perm_b32 v10, v165, v164, s57
    v_perm_b32 v7, v167, v166, s56
    v_perm_b32 v11, v167, v166, s57
    v_accvgpr_write_b32 a144, v4
    v_accvgpr_write_b32 a208, v8
    v_accvgpr_write_b32 a145, v5
    v_accvgpr_write_b32 a209, v9
    v_accvgpr_write_b32 a146, v6
    v_accvgpr_write_b32 a210, v10
    v_accvgpr_write_b32 a147, v7
    v_accvgpr_write_b32 a211, v11
    s_mov_b32 s60, 2883584
    buffer_load_dword v152, v3, s[44:47], s60 offen
    s_mov_b32 s60, 2891776
    buffer_load_dword v153, v3, s[44:47], s60 offen
    s_mov_b32 s60, 2899968
    buffer_load_dword v154, v3, s[44:47], s60 offen
    s_mov_b32 s60, 2908160
    buffer_load_dword v155, v3, s[44:47], s60 offen
    s_mov_b32 s60, 2916352
    buffer_load_dword v156, v3, s[44:47], s60 offen
    s_mov_b32 s60, 2924544
    buffer_load_dword v157, v3, s[44:47], s60 offen
    s_mov_b32 s60, 2932736
    buffer_load_dword v158, v3, s[44:47], s60 offen
    s_mov_b32 s60, 2940928
    buffer_load_dword v159, v3, s[44:47], s60 offen
    s_waitcnt vmcnt(48)
    v_perm_b32 v4, v169, v168, s56
    v_perm_b32 v8, v169, v168, s57
    v_perm_b32 v5, v171, v170, s56
    v_perm_b32 v9, v171, v170, s57
    v_perm_b32 v6, v173, v172, s56
    v_perm_b32 v10, v173, v172, s57
    v_perm_b32 v7, v175, v174, s56
    v_perm_b32 v11, v175, v174, s57
    v_accvgpr_write_b32 a148, v4
    v_accvgpr_write_b32 a212, v8
    v_accvgpr_write_b32 a149, v5
    v_accvgpr_write_b32 a213, v9
    v_accvgpr_write_b32 a150, v6
    v_accvgpr_write_b32 a214, v10
    v_accvgpr_write_b32 a151, v7
    v_accvgpr_write_b32 a215, v11
    s_mov_b32 s60, 3145728
    buffer_load_dword v160, v3, s[44:47], s60 offen
    s_mov_b32 s60, 3153920
    buffer_load_dword v161, v3, s[44:47], s60 offen
    s_mov_b32 s60, 3162112
    buffer_load_dword v162, v3, s[44:47], s60 offen
    s_mov_b32 s60, 3170304
    buffer_load_dword v163, v3, s[44:47], s60 offen
    s_mov_b32 s60, 3178496
    buffer_load_dword v164, v3, s[44:47], s60 offen
    s_mov_b32 s60, 3186688
    buffer_load_dword v165, v3, s[44:47], s60 offen
    s_mov_b32 s60, 3194880
    buffer_load_dword v166, v3, s[44:47], s60 offen
    s_mov_b32 s60, 3203072
    buffer_load_dword v167, v3, s[44:47], s60 offen
    s_waitcnt vmcnt(48)
    v_perm_b32 v4, v177, v176, s56
    v_perm_b32 v8, v177, v176, s57
    v_perm_b32 v5, v179, v178, s56
    v_perm_b32 v9, v179, v178, s57
    v_perm_b32 v6, v181, v180, s56
    v_perm_b32 v10, v181, v180, s57
    v_perm_b32 v7, v183, v182, s56
    v_perm_b32 v11, v183, v182, s57
    v_accvgpr_write_b32 a152, v4
    v_accvgpr_write_b32 a216, v8
    v_accvgpr_write_b32 a153, v5
    v_accvgpr_write_b32 a217, v9
    v_accvgpr_write_b32 a154, v6
    v_accvgpr_write_b32 a218, v10
    v_accvgpr_write_b32 a155, v7
    v_accvgpr_write_b32 a219, v11
    s_mov_b32 s60, 3407872
    buffer_load_dword v168, v3, s[44:47], s60 offen
    s_mov_b32 s60, 3416064
    buffer_load_dword v169, v3, s[44:47], s60 offen
    s_mov_b32 s60, 3424256
    buffer_load_dword v170, v3, s[44:47], s60 offen
    s_mov_b32 s60, 3432448
    buffer_load_dword v171, v3, s[44:47], s60 offen
    s_mov_b32 s60, 3440640
    buffer_load_dword v172, v3, s[44:47], s60 offen
    s_mov_b32 s60, 3448832
    buffer_load_dword v173, v3, s[44:47], s60 offen
    s_mov_b32 s60, 3457024
    buffer_load_dword v174, v3, s[44:47], s60 offen
    s_mov_b32 s60, 3465216
    buffer_load_dword v175, v3, s[44:47], s60 offen
    s_waitcnt vmcnt(48)
    v_perm_b32 v4, v185, v184, s56
    v_perm_b32 v8, v185, v184, s57
    v_perm_b32 v5, v187, v186, s56
    v_perm_b32 v9, v187, v186, s57
    v_perm_b32 v6, v189, v188, s56
    v_perm_b32 v10, v189, v188, s57
    v_perm_b32 v7, v191, v190, s56
    v_perm_b32 v11, v191, v190, s57
    v_accvgpr_write_b32 a156, v4
    v_accvgpr_write_b32 a220, v8
    v_accvgpr_write_b32 a157, v5
    v_accvgpr_write_b32 a221, v9
    v_accvgpr_write_b32 a158, v6
    v_accvgpr_write_b32 a222, v10
    v_accvgpr_write_b32 a159, v7
    v_accvgpr_write_b32 a223, v11
    s_mov_b32 s60, 3670016
    buffer_load_dword v176, v3, s[44:47], s60 offen
    s_mov_b32 s60, 3678208
    buffer_load_dword v177, v3, s[44:47], s60 offen
    s_mov_b32 s60, 3686400
    buffer_load_dword v178, v3, s[44:47], s60 offen
    s_mov_b32 s60, 3694592
    buffer_load_dword v179, v3, s[44:47], s60 offen
    s_mov_b32 s60, 3702784
    buffer_load_dword v180, v3, s[44:47], s60 offen
    s_mov_b32 s60, 3710976
    buffer_load_dword v181, v3, s[44:47], s60 offen
    s_mov_b32 s60, 3719168
    buffer_load_dword v182, v3, s[44:47], s60 offen
    s_mov_b32 s60, 3727360
    buffer_load_dword v183, v3, s[44:47], s60 offen
    s_waitcnt vmcnt(48)
    v_perm_b32 v4, v129, v128, s56
    v_perm_b32 v8, v129, v128, s57
    v_perm_b32 v5, v131, v130, s56
    v_perm_b32 v9, v131, v130, s57
    v_perm_b32 v6, v133, v132, s56
    v_perm_b32 v10, v133, v132, s57
    v_perm_b32 v7, v135, v134, s56
    v_perm_b32 v11, v135, v134, s57
    v_accvgpr_write_b32 a160, v4
    v_accvgpr_write_b32 a224, v8
    v_accvgpr_write_b32 a161, v5
    v_accvgpr_write_b32 a225, v9
    v_accvgpr_write_b32 a162, v6
    v_accvgpr_write_b32 a226, v10
    v_accvgpr_write_b32 a163, v7
    v_accvgpr_write_b32 a227, v11
    s_mov_b32 s60, 3932160
    buffer_load_dword v184, v3, s[44:47], s60 offen
    s_mov_b32 s60, 3940352
    buffer_load_dword v185, v3, s[44:47], s60 offen
    s_mov_b32 s60, 3948544
    buffer_load_dword v186, v3, s[44:47], s60 offen
    s_mov_b32 s60, 3956736
    buffer_load_dword v187, v3, s[44:47], s60 offen
    s_mov_b32 s60, 3964928
    buffer_load_dword v188, v3, s[44:47], s60 offen
    s_mov_b32 s60, 3973120
    buffer_load_dword v189, v3, s[44:47], s60 offen
    s_mov_b32 s60, 3981312
    buffer_load_dword v190, v3, s[44:47], s60 offen
    s_mov_b32 s60, 3989504
    buffer_load_dword v191, v3, s[44:47], s60 offen
    s_waitcnt vmcnt(48)
    s_cmp_lg_u32 s3, 0
    s_cbranch_scc1 WDD_11
    v_mov_b32 v21, 128
    s_mov_b32 s60, 0
    s_branch WD_10_F
WD_10:
    global_load_dword v20, v21, s[32:33] sc1
    s_waitcnt vmcnt(0)
WD_10_F:
    v_readfirstlane_b32 s61, v20
    s_and_b32 s61, s61, 0xffff
    s_cmp_ge_u32 s61, 256
    s_cbranch_scc1 WDD_11
    s_add_u32 s60, s60, 1
    s_cmp_lt_u32 s60, 200000
    s_cbranch_scc1 WD_10
    v_mov_b32 v1, 2
    v_mov_b32 v2, 224
    global_atomic_or v2, v1, s[32:33] sc1
    s_waitcnt vmcnt(0)
    s_endpgm
WDD_11:
    s_barrier
    v_lshlrev_b32 v12, 4, v0
    s_mov_b32 s66, 0
    s_mov_b32 s64, s65
    s_lshl_b32 s60, s64, 15
    s_lshl_b32 s61, s3, 13
    s_add_u32 s60, s60, s61
    s_add_u32 s61, s61, s66
    s_mov_b32 m0, s61
    s_nop 0
    buffer_load_dwordx4 v12, s[36:39], s60 offen offset:0 lds
    buffer_load_dwordx4 v12, s[36:39], s60 offen offset:1024 lds
    buffer_load_dwordx4 v12, s[36:39], s60 offen offset:2048 lds
    buffer_load_dwordx4 v12, s[36:39], s60 offen offset:3072 lds
    s_add_u32 s60, s60, 4096
    s_add_u32 s61, s61, 4096
    s_mov_b32 m0, s61
    s_nop 0
    buffer_load_dwordx4 v12, s[36:39], s60 offen offset:0 lds
    buffer_load_dwordx4 v12, s[36:39], s60 offen offset:1024 lds
    buffer_load_dwordx4 v12, s[36:39], s60 offen offset:2048 lds
    buffer_load_dwordx4 v12, s[36:39], s60 offen offset:3072 lds
    v_perm_b32 v4, v137, v136, s56
    v_perm_b32 v8, v137, v136, s57
    v_perm_b32 v5, v139, v138, s56
    v_perm_b32 v9, v139, v138, s57
    v_perm_b32 v6, v141, v140, s56
    v_perm_b32 v10, v141, v140, s57
    v_perm_b32 v7, v143, v142, s56
    v_perm_b32 v11, v143, v142, s57
    v_accvgpr_write_b32 a164, v4
    v_accvgpr_write_b32 a228, v8
    v_accvgpr_write_b32 a165, v5
    v_accvgpr_write_b32 a229, v9
    v_accvgpr_write_b32 a166, v6
    v_accvgpr_write_b32 a230, v10
    v_accvgpr_write_b32 a167, v7
    v_accvgpr_write_b32 a231, v11
    s_waitcnt vmcnt(48)
    v_perm_b32 v4, v145, v144, s56
    v_perm_b32 v8, v145, v144, s57
    v_perm_b32 v5, v147, v146, s56
    v_perm_b32 v9, v147, v146, s57
    v_perm_b32 v6, v149, v148, s56
    v_perm_b32 v10, v149, v148, s57
    v_perm_b32 v7, v151, v150, s56
    v_perm_b32 v11, v151, v150, s57
    v_accvgpr_write_b32 a168, v4
    v_accvgpr_write_b32 a232, v8
    v_accvgpr_write_b32 a169, v5
    v_accvgpr_write_b32 a233, v9
    v_accvgpr_write_b32 a170, v6
    v_accvgpr_write_b32 a234, v10
    v_accvgpr_write_b32 a171, v7
    v_accvgpr_write_b32 a235, v11
    s_waitcnt vmcnt(40)
    v_perm_b32 v4, v153, v152, s56
    v_perm_b32 v8, v153, v152, s57
    v_perm_b32 v5, v155, v154, s56
    v_perm_b32 v9, v155, v154, s57
    v_perm_b32 v6, v157, v156, s56
    v_perm_b32 v10, v157, v156, s57
    v_perm_b32 v7, v159, v158, s56
    v_perm_b32 v11, v159, v158, s57
    v_accvgpr_write_b32 a172, v4
    v_accvgpr_write_b32 a236, v8
    v_accvgpr_write_b32 a173, v5
    v_accvgpr_write_b32 a237, v9
    v_accvgpr_write_b32 a174, v6
    v_accvgpr_write_b32 a238, v10
    v_accvgpr_write_b32 a175, v7
    v_accvgpr_write_b32 a239, v11
    s_waitcnt vmcnt(32)
    v_perm_b32 v4, v161, v160, s56
    v_perm_b32 v8, v161, v160, s57
    v_perm_b32 v5, v163, v162, s56
    v_perm_b32 v9, v163, v162, s57
    v_perm_b32 v6, v165, v164, s56
    v_perm_b32 v10, v165, v164, s57
    v_perm_b32 v7, v167, v166, s56
    v_perm_b32 v11, v167, v166, s57
    v_accvgpr_write_b32 a176, v4
    v_accvgpr_write_b32 a240, v8
    v_accvgpr_write_b32 a177, v5
    v_accvgpr_write_b32 a241, v9
    v_accvgpr_write_b32 a178, v6
    v_accvgpr_write_b32 a242, v10
    v_accvgpr_write_b32 a179, v7
    v_accvgpr_write_b32 a243, v11
    s_waitcnt vmcnt(24)
    v_perm_b32 v4, v169, v168, s56
    v_perm_b32 v8, v169, v168, s57
    v_perm_b32 v5, v171, v170, s56
    v_perm_b32 v9, v171, v170, s57
    v_perm_b32 v6, v173, v172, s56
    v_perm_b32 v10, v173, v172, s57
    v_perm_b32 v7, v175, v174, s56
    v_perm_b32 v11, v175, v174, s57
    v_accvgpr_write_b32 a180, v4
    v_accvgpr_write_b32 a244, v8
    v_accvgpr_write_b32 a181, v5
    v_accvgpr_write_b32 a245, v9
    v_accvgpr_write_b32 a182, v6
    v_accvgpr_write_b32 a246, v10
    v_accvgpr_write_b32 a183, v7
    v_accvgpr_write_b32 a247, v11
    s_waitcnt vmcnt(16)
    v_perm_b32 v4, v177, v176, s56
    v_perm_b32 v8, v177, v176, s57
    v_perm_b32 v5, v179, v178, s56
    v_perm_b32 v9, v179, v178, s57
    v_perm_b32 v6, v181, v180, s56
    v_perm_b32 v10, v181, v180, s57
    v_perm_b32 v7, v183, v182, s56
    v_perm_b32 v11, v183, v182, s57
    v_accvgpr_write_b32 a184, v4
    v_accvgpr_write_b32 a248, v8
    v_accvgpr_write_b32 a185, v5
    v_accvgpr_write_b32 a249, v9
    v_accvgpr_write_b32 a186, v6
    v_accvgpr_write_b32 a250, v10
    v_accvgpr_write_b32 a187, v7
    v_accvgpr_write_b32 a251, v11
    s_waitcnt vmcnt(8)
    v_perm_b32 v4, v185, v184, s56
    v_perm_b32 v8, v185, v184, s57
    v_perm_b32 v5, v187, v186, s56
    v_perm_b32 v9, v187, v186, s57
    v_perm_b32 v6, v189, v188, s56
    v_perm_b32 v10, v189, v188, s57
    v_perm_b32 v7, v191, v190, s56
    v_perm_b32 v11, v191, v190, s57
    v_accvgpr_write_b32 a188, v4
    v_accvgpr_write_b32 a252, v8
    v_accvgpr_write_b32 a189, v5
    v_accvgpr_write_b32 a253, v9
    v_accvgpr_write_b32 a190, v6
    v_accvgpr_write_b32 a254, v10
    v_accvgpr_write_b32 a191, v7
    v_accvgpr_write_b32 a255, v11
    v_lshlrev_b32 v12, 4, v0
    s_mov_b32 s66, 0
    s_mov_b32 s68, -1
    v_mov_b32 v20, -1
    v_mov_b32 v21, -1
    v_mov_b32 v22, -1
    v_mov_b32 v23, -1
    s_waitcnt vmcnt(0)
G_12:
    s_barrier
    v_add_u32 v13, s66, v12
    ds_read_b128 v[64:67], v13 offset:0
    ds_read_b128 v[68:71], v13 offset:16384
    ds_read_b128 v[72:75], v13 offset:1024
    ds_read_b128 v[76:79], v13 offset:17408
    ds_read_b128 v[80:83], v13 offset:2048
    ds_read_b128 v[84:87], v13 offset:18432
    s_add_u32 s69, s64, 7
    s_xor_b32 s66, s66, 32768
    s_cmp_ge_u32 s69, 64
    s_cbranch_scc1 GN_14
    s_lshl_b32 s60, s69, 15
    s_lshl_b32 s61, s3, 13
    s_add_u32 s60, s60, s61
    s_add_u32 s61, s61, s66
    s_mov_b32 m0, s61
    s_nop 0
    buffer_load_dwordx4 v12, s[36:39], s60 offen offset:0 lds
    buffer_load_dwordx4 v12, s[36:39], s60 offen offset:1024 lds
    buffer_load_dwordx4 v12, s[36:39], s60 offen offset:2048 lds
    buffer_load_dwordx4 v12, s[36:39], s60 offen offset:3072 lds
    s_add_u32 s60, s60, 4096
    s_add_u32 s61, s61, 4096
    s_mov_b32 m0, s61
    s_nop 0
    buffer_load_dwordx4 v12, s[36:39], s60 offen offset:0 lds
    buffer_load_dwordx4 v12, s[36:39], s60 offen offset:1024 lds
    buffer_load_dwordx4 v12, s[36:39], s60 offen offset:2048 lds
    buffer_load_dwordx4 v12, s[36:39], s60 offen offset:3072 lds
GN_14:
    ds_read_b128 v[88:91], v13 offset:3072
    ds_read_b128 v[92:95], v13 offset:19456
    s_waitcnt lgkmcnt(6)
    v_mfma_f32_16x16x32_bf16 v[32:35], a[0:3], v[64:67], 0
    v_mfma_f32_16x16x32_bf16 v[48:51], a[0:3], v[68:71], 0
    v_mfma_f32_16x16x32_bf16 v[36:39], a[64:67], v[64:67], 0
    v_mfma_f32_16x16x32_bf16 v[52:55], a[64:67], v[68:71], 0
    v_mfma_f32_16x16x32_bf16 v[40:43], v[64:67], a[128:131], 0
    v_mfma_f32_16x16x32_bf16 v[56:59], v[68:71], a[128:131], 0
    v_mfma_f32_16x16x32_bf16 v[44:47], v[64:67], a[192:195], 0
    v_mfma_f32_16x16x32_bf16 v[60:63], v[68:71], a[192:195], 0
    ds_read_b128 v[64:67], v13 offset:4096
    ds_read_b128 v[68:71], v13 offset:20480
    s_waitcnt lgkmcnt(6)
    v_mfma_f32_16x16x32_bf16 v[32:35], a[4:7], v[72:75], v[32:35]
    v_mfma_f32_16x16x32_bf16 v[48:51], a[4:7], v[76:79], v[48:51]
    v_mfma_f32_16x16x32_bf16 v[36:39], a[68:71], v[72:75], v[36:39]
    v_mfma_f32_16x16x32_bf16 v[52:55], a[68:71], v[76:79], v[52:55]
    v_mfma_f32_16x16x32_bf16 v[40:43], v[72:75], a[132:135], v[40:43]
    v_mfma_f32_16x16x32_bf16 v[56:59], v[76:79], a[132:135], v[56:59]
    v_mfma_f32_16x16x32_bf16 v[44:47], v[72:75], a[196:199], v[44:47]
    v_mfma_f32_16x16x32_bf16 v[60:63], v[76:79], a[196:199], v[60:63]
    ds_read_b128 v[72:75], v13 offset:5120
    ds_read_b128 v[76:79], v13 offset:21504
    s_waitcnt lgkmcnt(6)
    v_mfma_f32_16x16x32_bf16 v[32:35], a[8:11], v[80:83], v[32:35]
    v_mfma_f32_16x16x32_bf16 v[48:51], a[8:11], v[84:87], v[48:51]
    v_mfma_f32_16x16x32_bf16 v[36:39], a[72:75], v[80:83], v[36:39]
    v_mfma_f32_16x16x32_bf16 v[52:55], a[72:75], v[84:87], v[52:55]
    v_mfma_f32_16x16x32_bf16 v[40:43], v[80:83], a[136:139], v[40:43]
    v_mfma_f32_16x16x32_bf16 v[56:59], v[84:87], a[136:139], v[56:59]
    v_mfma_f32_16x16x32_bf16 v[44:47], v[80:83], a[200:203], v[44:47]
    v_mfma_f32_16x16x32_bf16 v[60:63], v[84:87], a[200:203], v[60:63]
    ds_read_b128 v[80:83], v13 offset:6144
    ds_read_b128 v[84:87], v13 offset:22528
    s_waitcnt lgkmcnt(6)
    v_mfma_f32_16x16x32_bf16 v[32:35], a[12:15], v[88:91], v[32:35]
    v_mfma_f32_16x16x32_bf16 v[48:51], a[12:15], v[92:95], v[48:51]
    v_mfma_f32_16x16x32_bf16 v[36:39], a[76:79], v[88:91], v[36:39]
    v_mfma_f32_16x16x32_bf16 v[52:55], a[76:79], v[92:95], v[52:55]
    v_mfma_f32_16x16x32_bf16 v[40:43], v[88:91], a[140:143], v[40:43]
    v_mfma_f32_16x16x32_bf16 v[56:59], v[92:95], a[140:143], v[56:59]
    v_mfma_f32_16x16x32_bf16 v[44:47], v[88:91], a[204:207], v[44:47]
    v_mfma_f32_16x16x32_bf16 v[60:63], v[92:95], a[204:207], v[60:63]
    ds_read_b128 v[88:91], v13 offset:7168
    ds_read_b128 v[92:95], v13 offset:23552
    s_waitcnt lgkmcnt(6)
    v_mfma_f32_16x16x32_bf16 v[32:35], a[16:19], v[64:67], v[32:35]
    v_mfma_f32_16x16x32_bf16 v[48:51], a[16:19], v[68:71], v[48:51]
    v_mfma_f32_16x16x32_bf16 v[36:39], a[80:83], v[64:67], v[36:39]
    v_mfma_f32_16x16x32_bf16 v[52:55], a[80:83], v[68:71], v[52:55]
    v_mfma_f32_16x16x32_bf16 v[40:43], v[64:67], a[144:147], v[40:43]
    v_mfma_f32_16x16x32_bf16 v[56:59], v[68:71], a[144:147], v[56:59]
    v_mfma_f32_16x16x32_bf16 v[44:47], v[64:67], a[208:211], v[44:47]
    v_mfma_f32_16x16x32_bf16 v[60:63], v[68:71], a[208:211], v[60:63]
    ds_read_b128 v[64:67], v13 offset:8192
    ds_read_b128 v[68:71], v13 offset:24576
    s_waitcnt lgkmcnt(6)
    v_mfma_f32_16x16x32_bf16 v[32:35], a[20:23], v[72:75], v[32:35]
    v_mfma_f32_16x16x32_bf16 v[48:51], a[20:23], v[76:79], v[48:51]
    v_mfma_f32_16x16x32_bf16 v[36:39], a[84:87], v[72:75], v[36:39]
    v_mfma_f32_16x16x32_bf16 v[52:55], a[84:87], v[76:79], v[52:55]
    v_mfma_f32_16x16x32_bf16 v[40:43], v[72:75], a[148:151], v[40:43]
    v_mfma_f32_16x16x32_bf16 v[56:59], v[76:79], a[148:151], v[56:59]
    v_mfma_f32_16x16x32_bf16 v[44:47], v[72:75], a[212:215], v[44:47]
    v_mfma_f32_16x16x32_bf16 v[60:63], v[76:79], a[212:215], v[60:63]
    ds_read_b128 v[72:75], v13 offset:9216
    ds_read_b128 v[76:79], v13 offset:25600
    s_waitcnt lgkmcnt(6)
    v_mfma_f32_16x16x32_bf16 v[32:35], a[24:27], v[80:83], v[32:35]
    v_mfma_f32_16x16x32_bf16 v[48:51], a[24:27], v[84:87], v[48:51]
    v_mfma_f32_16x16x32_bf16 v[36:39], a[88:91], v[80:83], v[36:39]
    v_mfma_f32_16x16x32_bf16 v[52:55], a[88:91], v[84:87], v[52:55]
    v_mfma_f32_16x16x32_bf16 v[40:43], v[80:83], a[152:155], v[40:43]
    v_mfma_f32_16x16x32_bf16 v[56:59], v[84:87], a[152:155], v[56:59]
    v_mfma_f32_16x16x32_bf16 v[44:47], v[80:83], a[216:219], v[44:47]
    v_mfma_f32_16x16x32_bf16 v[60:63], v[84:87], a[216:219], v[60:63]
    ds_read_b128 v[80:83], v13 offset:10240
    ds_read_b128 v[84:87], v13 offset:26624
    s_waitcnt lgkmcnt(6)
    v_mfma_f32_16x16x32_bf16 v[32:35], a[28:31], v[88:91], v[32:35]
    v_mfma_f32_16x16x32_bf16 v[48:51], a[28:31], v[92:95], v[48:51]
    v_mfma_f32_16x16x32_bf16 v[36:39], a[92:95], v[88:91], v[36:39]
    v_mfma_f32_16x16x32_bf16 v[52:55], a[92:95], v[92:95], v[52:55]
    v_mfma_f32_16x16x32_bf16 v[40:43], v[88:91], a[156:159], v[40:43]
    v_mfma_f32_16x16x32_bf16 v[56:59], v[92:95], a[156:159], v[56:59]
    v_mfma_f32_16x16x32_bf16 v[44:47], v[88:91], a[220:223], v[44:47]
    v_mfma_f32_16x16x32_bf16 v[60:63], v[92:95], a[220:223], v[60:63]
    ds_read_b128 v[88:91], v13 offset:11264
    ds_read_b128 v[92:95], v13 offset:27648
    s_waitcnt lgkmcnt(6)
    v_mfma_f32_16x16x32_bf16 v[32:35], a[32:35], v[64:67], v[32:35]
    v_mfma_f32_16x16x32_bf16 v[48:51], a[32:35], v[68:71], v[48:51]
    v_mfma_f32_16x16x32_bf16 v[36:39], a[96:99], v[64:67], v[36:39]
    v_mfma_f32_16x16x32_bf16 v[52:55], a[96:99], v[68:71], v[52:55]
    v_mfma_f32_16x16x32_bf16 v[40:43], v[64:67], a[160:163], v[40:43]
    v_mfma_f32_16x16x32_bf16 v[56:59], v[68:71], a[160:163], v[56:59]
    v_mfma_f32_16x16x32_bf16 v[44:47], v[64:67], a[224:227], v[44:47]
    v_mfma_f32_16x16x32_bf16 v[60:63], v[68:71], a[224:227], v[60:63]
    ds_read_b128 v[64:67], v13 offset:12288
    ds_read_b128 v[68:71], v13 offset:28672
    s_waitcnt lgkmcnt(6)
    v_mfma_f32_16x16x32_bf16 v[32:35], a[36:39], v[72:75], v[32:35]
    v_mfma_f32_16x16x32_bf16 v[48:51], a[36:39], v[76:79], v[48:51]
    v_mfma_f32_16x16x32_bf16 v[36:39], a[100:103], v[72:75], v[36:39]
    v_mfma_f32_16x16x32_bf16 v[52:55], a[100:103], v[76:79], v[52:55]
    v_mfma_f32_16x16x32_bf16 v[40:43], v[72:75], a[164:167], v[40:43]
    v_mfma_f32_16x16x32_bf16 v[56:59], v[76:79], a[164:167], v[56:59]
    v_mfma_f32_16x16x32_bf16 v[44:47], v[72:75], a[228:231], v[44:47]
    v_mfma_f32_16x16x32_bf16 v[60:63], v[76:79], a[228:231], v[60:63]
    ds_read_b128 v[72:75], v13 offset:13312
    ds_read_b128 v[76:79], v13 offset:29696
    s_waitcnt lgkmcnt(6)
    v_mfma_f32_16x16x32_bf16 v[32:35], a[40:43], v[80:83], v[32:35]
    v_mfma_f32_16x16x32_bf16 v[48:51], a[40:43], v[84:87], v[48:51]
    v_mfma_f32_16x16x32_bf16 v[36:39], a[104:107], v[80:83], v[36:39]
    v_mfma_f32_16x16x32_bf16 v[52:55], a[104:107], v[84:87], v[52:55]
    v_mfma_f32_16x16x32_bf16 v[40:43], v[80:83], a[168:171], v[40:43]
    v_mfma_f32_16x16x32_bf16 v[56:59], v[84:87], a[168:171], v[56:59]
    v_mfma_f32_16x16x32_bf16 v[44:47], v[80:83], a[232:235], v[44:47]
    v_mfma_f32_16x16x32_bf16 v[60:63], v[84:87], a[232:235], v[60:63]
    ds_read_b128 v[80:83], v13 offset:14336
    ds_read_b128 v[84:87], v13 offset:30720
    s_waitcnt lgkmcnt(6)
    v_mfma_f32_16x16x32_bf16 v[32:35], a[44:47], v[88:91], v[32:35]
    v_mfma_f32_16x16x32_bf16 v[48:51], a[44:47], v[92:95], v[48:51]
    v_mfma_f32_16x16x32_bf16 v[36:39], a[108:111], v[88:91], v[36:39]
    v_mfma_f32_16x16x32_bf16 v[52:55], a[108:111], v[92:95], v[52:55]
    v_mfma_f32_16x16x32_bf16 v[40:43], v[88:91], a[172:175], v[40:43]
    v_mfma_f32_16x16x32_bf16 v[56:59], v[92:95], a[172:175], v[56:59]
    v_mfma_f32_16x16x32_bf16 v[44:47], v[88:91], a[236:239], v[44:47]
    v_mfma_f32_16x16x32_bf16 v[60:63], v[92:95], a[236:239], v[60:63]
    ds_read_b128 v[88:91], v13 offset:15360
    ds_read_b128 v[92:95], v13 offset:31744
    s_waitcnt lgkmcnt(6)
    v_mfma_f32_16x16x32_bf16 v[32:35], a[48:51], v[64:67], v[32:35]
    v_mfma_f32_16x16x32_bf16 v[48:51], a[48:51], v[68:71], v[48:51]
    v_mfma_f32_16x16x32_bf16 v[36:39], a[112:115], v[64:67], v[36:39]
    v_mfma_f32_16x16x32_bf16 v[52:55], a[112:115], v[68:71], v[52:55]
    v_mfma_f32_16x16x32_bf16 v[40:43], v[64:67], a[176:179], v[40:43]
    v_mfma_f32_16x16x32_bf16 v[56:59], v[68:71], a[176:179], v[56:59]
    v_mfma_f32_16x16x32_bf16 v[44:47], v[64:67], a[240:243], v[44:47]
    v_mfma_f32_16x16x32_bf16 v[60:63], v[68:71], a[240:243], v[60:63]
    s_waitcnt lgkmcnt(4)
    v_mfma_f32_16x16x32_bf16 v[32:35], a[52:55], v[72:75], v[32:35]
    v_mfma_f32_16x16x32_bf16 v[48:51], a[52:55], v[76:79], v[48:51]
    v_mfma_f32_16x16x32_bf16 v[36:39], a[116:119], v[72:75], v[36:39]
    v_mfma_f32_16x16x32_bf16 v[52:55], a[116:119], v[76:79], v[52:55]
    v_mfma_f32_16x16x32_bf16 v[40:43], v[72:75], a[180:183], v[40:43]
    v_mfma_f32_16x16x32_bf16 v[56:59], v[76:79], a[180:183], v[56:59]
    v_mfma_f32_16x16x32_bf16 v[44:47], v[72:75], a[244:247], v[44:47]
    v_mfma_f32_16x16x32_bf16 v[60:63], v[76:79], a[244:247], v[60:63]
    s_waitcnt lgkmcnt(2)
    v_mfma_f32_16x16x32_bf16 v[32:35], a[56:59], v[80:83], v[32:35]
    v_mfma_f32_16x16x32_bf16 v[48:51], a[56:59], v[84:87], v[48:51]
    v_mfma_f32_16x16x32_bf16 v[36:39], a[120:123], v[80:83], v[36:39]
    v_mfma_f32_16x16x32_bf16 v[52:55], a[120:123], v[84:87], v[52:55]
    v_mfma_f32_16x16x32_bf16 v[40:43], v[80:83], a[184:187], v[40:43]
    v_mfma_f32_16x16x32_bf16 v[56:59], v[84:87], a[184:187], v[56:59]
    v_mfma_f32_16x16x32_bf16 v[44:47], v[80:83], a[248:251], v[44:47]
    v_mfma_f32_16x16x32_bf16 v[60:63], v[84:87], a[248:251], v[60:63]
    s_waitcnt lgkmcnt(0)
    v_mfma_f32_16x16x32_bf16 v[32:35], a[60:63], v[88:91], v[32:35]
    v_mfma_f32_16x16x32_bf16 v[48:51], a[60:63], v[92:95], v[48:51]
    v_mfma_f32_16x16x32_bf16 v[36:39], a[124:127], v[88:91], v[36:39]
    v_mfma_f32_16x16x32_bf16 v[52:55], a[124:127], v[92:95], v[52:55]
    v_mfma_f32_16x16x32_bf16 v[40:43], v[88:91], a[188:191], v[40:43]
    v_mfma_f32_16x16x32_bf16 v[56:59], v[92:95], a[188:191], v[56:59]
    v_mfma_f32_16x16x32_bf16 v[44:47], v[88:91], a[252:255], v[44:47]
    v_mfma_f32_16x16x32_bf16 v[60:63], v[92:95], a[252:255], v[60:63]
    s_waitcnt vmcnt(0)
    s_cmp_lt_i32 s68, 7
    s_cbranch_scc1 GF_15
    s_lshl_b32 s60, s68, 5
    s_add_u32 s60, s60, s67
    s_lshl_b32 s60, s60, 2
    s_add_u32 s60, s60, s3
    s_lshl_b32 s60, s60, 2
    s_add_u32 s60, s60, 87031808
    v_mov_b32 v15, 1
    v_mov_b32 v16, 0
    s_mov_b64 exec, 1
    buffer_store_dword v15, v16, s[36:39], s60 offen sc1
    s_mov_b64 exec, -1
GF_15:
    s_nop 7
    s_lshl_b32 s60, s64, 5
    s_add_u32 s60, s60, s67
    s_lshl_b32 s60, s60, 14
    s_add_u32 s60, s60, 2097152
    s_lshl_b32 s61, s3, 10
    s_add_u32 s61, s60, s61
    v_cvt_pk_bf16_f32 v96, v32, v36
    v_cvt_pk_bf16_f32 v97, v33, v37
    v_cvt_pk_bf16_f32 v98, v34, v38
    v_cvt_pk_bf16_f32 v99, v35, v39
    buffer_store_dwordx4 v[96:99], v12, s[36:39], s61 offen sc1
    s_add_u32 s61, s61, 4096
    v_cvt_pk_bf16_f32 v100, v48, v52
    v_cvt_pk_bf16_f32 v101, v49, v53
    v_cvt_pk_bf16_f32 v102, v50, v54
    v_cvt_pk_bf16_f32 v103, v51, v55
    buffer_store_dwordx4 v[100:103], v12, s[36:39], s61 offen sc1
    s_add_u32 s61, s61, 4096
    s_lshl_b32 s61, s3, 11
    s_add_u32 s61, s60, s61
    s_add_u32 s61, s61, 8192
    v_cvt_pk_bf16_f32 v104, v40, v41
    v_cvt_pk_bf16_f32 v105, v42, v43
    v_cvt_pk_bf16_f32 v106, v56, v57
    v_cvt_pk_bf16_f32 v107, v58, v59
    buffer_store_dwordx4 v[104:107], v12, s[36:39], s61 offen offset:0 sc1
    v_cvt_pk_bf16_f32 v108, v44, v45
    v_cvt_pk_bf16_f32 v109, v46, v47
    v_cvt_pk_bf16_f32 v110, v60, v61
    v_cvt_pk_bf16_f32 v111, v62, v63
    buffer_store_dwordx4 v[108:111], v12, s[36:39], s61 offen offset:1024 sc1
    s_lshl_b32 s60, s64, 5
    s_add_u32 s60, s60, s67
    s_lshl_b32 s60, s60, 2
    s_add_u32 s60, s60, s3
    s_lshl_b32 s60, s60, 10
    s_add_u32 s60, s60, 89128960
    buffer_store_dwordx4 v[20:23], v12, s[36:39], s60 offen sc1
    s_cmp_ge_u32 s64, 7
    s_cbranch_scc1 GI_16
    s_waitcnt vmcnt(0)
    s_lshl_b32 s60, s64, 5
    s_add_u32 s60, s60, s67
    s_lshl_b32 s60, s60, 2
    s_add_u32 s60, s60, s3
    s_lshl_b32 s60, s60, 2
    s_add_u32 s60, s60, 87031808
    v_mov_b32 v15, 1
    v_mov_b32 v16, 0
    s_mov_b64 exec, 1
    buffer_store_dword v15, v16, s[36:39], s60 offen sc1
    s_mov_b64 exec, -1
GI_16:
    s_mov_b32 s68, s64
    s_add_u32 s64, s64, 7
    s_cmp_lt_u32 s64, 64
    s_cbranch_scc1 G_12
    s_waitcnt vmcnt(0)
    s_lshl_b32 s60, s68, 5
    s_add_u32 s60, s60, s67
    s_lshl_b32 s60, s60, 2
    s_add_u32 s60, s60, s3
    s_lshl_b32 s60, s60, 2
    s_add_u32 s60, s60, 87031808
    v_mov_b32 v15, 1
    v_mov_b32 v16, 0
    s_mov_b64 exec, 1
    buffer_store_dword v15, v16, s[36:39], s60 offen sc1
    s_mov_b64 exec, -1
    s_mov_b32 s64, s65
    s_cmp_ge_u32 s67, 30
    s_cbranch_scc1 P2_DONE
    s_cmp_ge_u32 s67, 16
    s_cbranch_scc1 P2_GU
    s_mov_b32 s40, s12
    s_mov_b32 s41, s13
    s_mov_b32 s42, 4194304
    s_mov_b32 s43, 0x00020000
    s_mov_b32 s44, s12
    s_mov_b32 s45, s13
    s_mov_b32 s46, 4194304
    s_mov_b32 s47, 0x00020000
    s_lshl_b32 s60, s67, 9
    s_lshl_b32 s61, s3, 6
    s_add_u32 s61, s60, s61
    s_add_u32 s62, s61, 256
    v_lshrrev_b32 v4, 4, v0
    v_and_b32 v5, 15, v0
    v_mul_u32_u24 v4, 65536, v4
    v_lshl_add_u32 v4, v5, 2, v4
    v_add_u32 v2, s61, v4
    v_add_u32 v3, s62, v4
    s_add_u32 s62, s60, 256
    v_lshrrev_b32 v4, 1, v0
    v_and_b32 v5, 1, v0
    v_mul_u32_u24 v4, 8192, v4
    v_lshl_add_u32 v4, v5, 7, v4
    s_add_u32 s58, s65, 1
    s_and_b32 s59, s58, 3
    s_lshl_b32 s59, s59, 2
    s_add_u32 s59, s59, s3
    s_mul_i32 s59, s59, 262144
    s_cmp_ge_u32 s58, 4
    s_cbranch_scc1 TB_17
    s_add_u32 s59, s59, s60
    buffer_load_dword v6, v4, s[40:43], s59 offen
    s_branch TE_18
TB_17:
    s_add_u32 s59, s59, s62
    buffer_load_dword v6, v4, s[44:47], s59 offen
TE_18:
    s_add_u32 s58, s58, 4
    s_cmp_gt_u32 s58, 7
    s_cselect_b32 s59, 7, 0
    s_sub_u32 s58, s58, s59
    s_and_b32 s59, s58, 3
    s_lshl_b32 s59, s59, 2
    s_add_u32 s59, s59, s3
    s_mul_i32 s59, s59, 262144
    s_cmp_ge_u32 s58, 4
    s_cbranch_scc1 TB_19
    s_add_u32 s59, s59, s60
    buffer_load_dword v7, v4, s[40:43], s59 offen
    s_branch TE_20
TB_19:
    s_add_u32 s59, s59, s62
    buffer_load_dword v7, v4, s[44:47], s59 offen
TE_20:
    s_mov_b32 s60, 0
    buffer_load_dword v128, v2, s[40:43], s60 offen
    s_mov_b32 s60, 8192
    buffer_load_dword v129, v2, s[40:43], s60 offen
    s_mov_b32 s60, 16384
    buffer_load_dword v130, v2, s[40:43], s60 offen
    s_mov_b32 s60, 24576
    buffer_load_dword v131, v2, s[40:43], s60 offen
    s_mov_b32 s60, 32768
    buffer_load_dword v132, v2, s[40:43], s60 offen
    s_mov_b32 s60, 40960
    buffer_load_dword v133, v2, s[40:43], s60 offen
    s_mov_b32 s60, 49152
    buffer_load_dword v134, v2, s[40:43], s60 offen
    s_mov_b32 s60, 57344
    buffer_load_dword v135, v2, s[40:43], s60 offen
    s_mov_b32 s60, 262144
    buffer_load_dword v136, v2, s[40:43], s60 offen
    s_mov_b32 s60, 270336
    buffer_load_dword v137, v2, s[40:43], s60 offen
    s_mov_b32 s60, 278528
    buffer_load_dword v138, v2, s[40:43], s60 offen
    s_mov_b32 s60, 286720
    buffer_load_dword v139, v2, s[40:43], s60 offen
    s_mov_b32 s60, 294912
    buffer_load_dword v140, v2, s[40:43], s60 offen
    s_mov_b32 s60, 303104
    buffer_load_dword v141, v2, s[40:43], s60 offen
    s_mov_b32 s60, 311296
    buffer_load_dword v142, v2, s[40:43], s60 offen
    s_mov_b32 s60, 319488
    buffer_load_dword v143, v2, s[40:43], s60 offen
    s_mov_b32 s60, 524288
    buffer_load_dword v144, v2, s[40:43], s60 offen
    s_mov_b32 s60, 532480
    buffer_load_dword v145, v2, s[40:43], s60 offen
    s_mov_b32 s60, 540672
    buffer_load_dword v146, v2, s[40:43], s60 offen
    s_mov_b32 s60, 548864
    buffer_load_dword v147, v2, s[40:43], s60 offen
    s_mov_b32 s60, 557056
    buffer_load_dword v148, v2, s[40:43], s60 offen
    s_mov_b32 s60, 565248
    buffer_load_dword v149, v2, s[40:43], s60 offen
    s_mov_b32 s60, 573440
    buffer_load_dword v150, v2, s[40:43], s60 offen
    s_mov_b32 s60, 581632
    buffer_load_dword v151, v2, s[40:43], s60 offen
    s_mov_b32 s60, 786432
    buffer_load_dword v152, v2, s[40:43], s60 offen
    s_mov_b32 s60, 794624
    buffer_load_dword v153, v2, s[40:43], s60 offen
    s_mov_b32 s60, 802816
    buffer_load_dword v154, v2, s[40:43], s60 offen
    s_mov_b32 s60, 811008
    buffer_load_dword v155, v2, s[40:43], s60 offen
    s_mov_b32 s60, 819200
    buffer_load_dword v156, v2, s[40:43], s60 offen
    s_mov_b32 s60, 827392
    buffer_load_dword v157, v2, s[40:43], s60 offen
    s_mov_b32 s60, 835584
    buffer_load_dword v158, v2, s[40:43], s60 offen
    s_mov_b32 s60, 843776
    buffer_load_dword v159, v2, s[40:43], s60 offen
    s_mov_b32 s60, 1048576
    buffer_load_dword v160, v2, s[40:43], s60 offen
    s_mov_b32 s60, 1056768
    buffer_load_dword v161, v2, s[40:43], s60 offen
    s_mov_b32 s60, 1064960
    buffer_load_dword v162, v2, s[40:43], s60 offen
    s_mov_b32 s60, 1073152
    buffer_load_dword v163, v2, s[40:43], s60 offen
    s_mov_b32 s60, 1081344
    buffer_load_dword v164, v2, s[40:43], s60 offen
    s_mov_b32 s60, 1089536
    buffer_load_dword v165, v2, s[40:43], s60 offen
    s_mov_b32 s60, 1097728
    buffer_load_dword v166, v2, s[40:43], s60 offen
    s_mov_b32 s60, 1105920
    buffer_load_dword v167, v2, s[40:43], s60 offen
    s_mov_b32 s60, 1310720
    buffer_load_dword v168, v2, s[40:43], s60 offen
    s_mov_b32 s60, 1318912
    buffer_load_dword v169, v2, s[40:43], s60 offen
    s_mov_b32 s60, 1327104
    buffer_load_dword v170, v2, s[40:43], s60 offen
    s_mov_b32 s60, 1335296
    buffer_load_dword v171, v2, s[40:43], s60 offen
    s_mov_b32 s60, 1343488
    buffer_load_dword v172, v2, s[40:43], s60 offen
    s_mov_b32 s60, 1351680
    buffer_load_dword v173, v2, s[40:43], s60 offen
    s_mov_b32 s60, 1359872
    buffer_load_dword v174, v2, s[40:43], s60 offen
    s_mov_b32 s60, 1368064
    buffer_load_dword v175, v2, s[40:43], s60 offen
    s_mov_b32 s60, 1572864
    buffer_load_dword v176, v2, s[40:43], s60 offen
    s_mov_b32 s60, 1581056
    buffer_load_dword v177, v2, s[40:43], s60 offen
    s_mov_b32 s60, 1589248
    buffer_load_dword v178, v2, s[40:43], s60 offen
    s_mov_b32 s60, 1597440
    buffer_load_dword v179, v2, s[40:43], s60 offen
    s_mov_b32 s60, 1605632
    buffer_load_dword v180, v2, s[40:43], s60 offen
    s_mov_b32 s60, 1613824
    buffer_load_dword v181, v2, s[40:43], s60 offen
    s_mov_b32 s60, 1622016
    buffer_load_dword v182, v2, s[40:43], s60 offen
    s_mov_b32 s60, 1630208
    buffer_load_dword v183, v2, s[40:43], s60 offen
    s_waitcnt vmcnt(48)
    v_perm_b32 v4, v129, v128, s56
    v_perm_b32 v8, v129, v128, s57
    v_perm_b32 v5, v131, v130, s56
    v_perm_b32 v9, v131, v130, s57
    v_perm_b32 v6, v133, v132, s56
    v_perm_b32 v10, v133, v132, s57
    v_perm_b32 v7, v135, v134, s56
    v_perm_b32 v11, v135, v134, s57
    v_accvgpr_write_b32 a0, v4
    v_accvgpr_write_b32 a64, v8
    v_accvgpr_write_b32 a1, v5
    v_accvgpr_write_b32 a65, v9
    v_accvgpr_write_b32 a2, v6
    v_accvgpr_write_b32 a66, v10
    v_accvgpr_write_b32 a3, v7
    v_accvgpr_write_b32 a67, v11
    s_mov_b32 s60, 1835008
    buffer_load_dword v184, v2, s[40:43], s60 offen
    s_mov_b32 s60, 1843200
    buffer_load_dword v185, v2, s[40:43], s60 offen
    s_mov_b32 s60, 1851392
    buffer_load_dword v186, v2, s[40:43], s60 offen
    s_mov_b32 s60, 1859584
    buffer_load_dword v187, v2, s[40:43], s60 offen
    s_mov_b32 s60, 1867776
    buffer_load_dword v188, v2, s[40:43], s60 offen
    s_mov_b32 s60, 1875968
    buffer_load_dword v189, v2, s[40:43], s60 offen
    s_mov_b32 s60, 1884160
    buffer_load_dword v190, v2, s[40:43], s60 offen
    s_mov_b32 s60, 1892352
    buffer_load_dword v191, v2, s[40:43], s60 offen
    s_waitcnt vmcnt(48)
    v_perm_b32 v4, v137, v136, s56
    v_perm_b32 v8, v137, v136, s57
    v_perm_b32 v5, v139, v138, s56
    v_perm_b32 v9, v139, v138, s57
    v_perm_b32 v6, v141, v140, s56
    v_perm_b32 v10, v141, v140, s57
    v_perm_b32 v7, v143, v142, s56
    v_perm_b32 v11, v143, v142, s57
    v_accvgpr_write_b32 a4, v4
    v_accvgpr_write_b32 a68, v8
    v_accvgpr_write_b32 a5, v5
    v_accvgpr_write_b32 a69, v9
    v_accvgpr_write_b32 a6, v6
    v_accvgpr_write_b32 a70, v10
    v_accvgpr_write_b32 a7, v7
    v_accvgpr_write_b32 a71, v11
    s_mov_b32 s60, 2097152
    buffer_load_dword v128, v2, s[40:43], s60 offen
    s_mov_b32 s60, 2105344
    buffer_load_dword v129, v2, s[40:43], s60 offen
    s_mov_b32 s60, 2113536
    buffer_load_dword v130, v2, s[40:43], s60 offen
    s_mov_b32 s60, 2121728
    buffer_load_dword v131, v2, s[40:43], s60 offen
    s_mov_b32 s60, 2129920
    buffer_load_dword v132, v2, s[40:43], s60 offen
    s_mov_b32 s60, 2138112
    buffer_load_dword v133, v2, s[40:43], s60 offen
    s_mov_b32 s60, 2146304
    buffer_load_dword v134, v2, s[40:43], s60 offen
    s_mov_b32 s60, 2154496
    buffer_load_dword v135, v2, s[40:43], s60 offen
    s_waitcnt vmcnt(48)
    v_perm_b32 v4, v145, v144, s56
    v_perm_b32 v8, v145, v144, s57
    v_perm_b32 v5, v147, v146, s56
    v_perm_b32 v9, v147, v146, s57
    v_perm_b32 v6, v149, v148, s56
    v_perm_b32 v10, v149, v148, s57
    v_perm_b32 v7, v151, v150, s56
    v_perm_b32 v11, v151, v150, s57
    v_accvgpr_write_b32 a8, v4
    v_accvgpr_write_b32 a72, v8
    v_accvgpr_write_b32 a9, v5
    v_accvgpr_write_b32 a73, v9
    v_accvgpr_write_b32 a10, v6
    v_accvgpr_write_b32 a74, v10
    v_accvgpr_write_b32 a11, v7
    v_accvgpr_write_b32 a75, v11
    s_mov_b32 s60, 2359296
    buffer_load_dword v136, v2, s[40:43], s60 offen
    s_mov_b32 s60, 2367488
    buffer_load_dword v137, v2, s[40:43], s60 offen
    s_mov_b32 s60, 2375680
    buffer_load_dword v138, v2, s[40:43], s60 offen
    s_mov_b32 s60, 2383872
    buffer_load_dword v139, v2, s[40:43], s60 offen
    s_mov_b32 s60, 2392064
    buffer_load_dword v140, v2, s[40:43], s60 offen
    s_mov_b32 s60, 2400256
    buffer_load_dword v141, v2, s[40:43], s60 offen
    s_mov_b32 s60, 2408448
    buffer_load_dword v142, v2, s[40:43], s60 offen
    s_mov_b32 s60, 2416640
    buffer_load_dword v143, v2, s[40:43], s60 offen
    s_waitcnt vmcnt(48)
    v_perm_b32 v4, v153, v152, s56
    v_perm_b32 v8, v153, v152, s57
    v_perm_b32 v5, v155, v154, s56
    v_perm_b32 v9, v155, v154, s57
    v_perm_b32 v6, v157, v156, s56
    v_perm_b32 v10, v157, v156, s57
    v_perm_b32 v7, v159, v158, s56
    v_perm_b32 v11, v159, v158, s57
    v_accvgpr_write_b32 a12, v4
    v_accvgpr_write_b32 a76, v8
    v_accvgpr_write_b32 a13, v5
    v_accvgpr_write_b32 a77, v9
    v_accvgpr_write_b32 a14, v6
    v_accvgpr_write_b32 a78, v10
    v_accvgpr_write_b32 a15, v7
    v_accvgpr_write_b32 a79, v11
    s_mov_b32 s60, 2621440
    buffer_load_dword v144, v2, s[40:43], s60 offen
    s_mov_b32 s60, 2629632
    buffer_load_dword v145, v2, s[40:43], s60 offen
    s_mov_b32 s60, 2637824
    buffer_load_dword v146, v2, s[40:43], s60 offen
    s_mov_b32 s60, 2646016
    buffer_load_dword v147, v2, s[40:43], s60 offen
    s_mov_b32 s60, 2654208
    buffer_load_dword v148, v2, s[40:43], s60 offen
    s_mov_b32 s60, 2662400
    buffer_load_dword v149, v2, s[40:43], s60 offen
    s_mov_b32 s60, 2670592
    buffer_load_dword v150, v2, s[40:43], s60 offen
    s_mov_b32 s60, 2678784
    buffer_load_dword v151, v2, s[40:43], s60 offen
    s_waitcnt vmcnt(48)
    v_perm_b32 v4, v161, v160, s56
    v_perm_b32 v8, v161, v160, s57
    v_perm_b32 v5, v163, v162, s56
    v_perm_b32 v9, v163, v162, s57
    v_perm_b32 v6, v165, v164, s56
    v_perm_b32 v10, v165, v164, s57
    v_perm_b32 v7, v167, v166, s56
    v_perm_b32 v11, v167, v166, s57
    v_accvgpr_write_b32 a16, v4
    v_accvgpr_write_b32 a80, v8
    v_accvgpr_write_b32 a17, v5
    v_accvgpr_write_b32 a81, v9
    v_accvgpr_write_b32 a18, v6
    v_accvgpr_write_b32 a82, v10
    v_accvgpr_write_b32 a19, v7
    v_accvgpr_write_b32 a83, v11
    s_mov_b32 s60, 2883584
    buffer_load_dword v152, v2, s[40:43], s60 offen
    s_mov_b32 s60, 2891776
    buffer_load_dword v153, v2, s[40:43], s60 offen
    s_mov_b32 s60, 2899968
    buffer_load_dword v154, v2, s[40:43], s60 offen
    s_mov_b32 s60, 2908160
    buffer_load_dword v155, v2, s[40:43], s60 offen
    s_mov_b32 s60, 2916352
    buffer_load_dword v156, v2, s[40:43], s60 offen
    s_mov_b32 s60, 2924544
    buffer_load_dword v157, v2, s[40:43], s60 offen
    s_mov_b32 s60, 2932736
    buffer_load_dword v158, v2, s[40:43], s60 offen
    s_mov_b32 s60, 2940928
    buffer_load_dword v159, v2, s[40:43], s60 offen
    s_waitcnt vmcnt(48)
    v_perm_b32 v4, v169, v168, s56
    v_perm_b32 v8, v169, v168, s57
    v_perm_b32 v5, v171, v170, s56
    v_perm_b32 v9, v171, v170, s57
    v_perm_b32 v6, v173, v172, s56
    v_perm_b32 v10, v173, v172, s57
    v_perm_b32 v7, v175, v174, s56
    v_perm_b32 v11, v175, v174, s57
    v_accvgpr_write_b32 a20, v4
    v_accvgpr_write_b32 a84, v8
    v_accvgpr_write_b32 a21, v5
    v_accvgpr_write_b32 a85, v9
    v_accvgpr_write_b32 a22, v6
    v_accvgpr_write_b32 a86, v10
    v_accvgpr_write_b32 a23, v7
    v_accvgpr_write_b32 a87, v11
    s_mov_b32 s60, 3145728
    buffer_load_dword v160, v2, s[40:43], s60 offen
    s_mov_b32 s60, 3153920
    buffer_load_dword v161, v2, s[40:43], s60 offen
    s_mov_b32 s60, 3162112
    buffer_load_dword v162, v2, s[40:43], s60 offen
    s_mov_b32 s60, 3170304
    buffer_load_dword v163, v2, s[40:43], s60 offen
    s_mov_b32 s60, 3178496
    buffer_load_dword v164, v2, s[40:43], s60 offen
    s_mov_b32 s60, 3186688
    buffer_load_dword v165, v2, s[40:43], s60 offen
    s_mov_b32 s60, 3194880
    buffer_load_dword v166, v2, s[40:43], s60 offen
    s_mov_b32 s60, 3203072
    buffer_load_dword v167, v2, s[40:43], s60 offen
    s_waitcnt vmcnt(48)
    v_perm_b32 v4, v177, v176, s56
    v_perm_b32 v8, v177, v176, s57
    v_perm_b32 v5, v179, v178, s56
    v_perm_b32 v9, v179, v178, s57
    v_perm_b32 v6, v181, v180, s56
    v_perm_b32 v10, v181, v180, s57
    v_perm_b32 v7, v183, v182, s56
    v_perm_b32 v11, v183, v182, s57
    v_accvgpr_write_b32 a24, v4
    v_accvgpr_write_b32 a88, v8
    v_accvgpr_write_b32 a25, v5
    v_accvgpr_write_b32 a89, v9
    v_accvgpr_write_b32 a26, v6
    v_accvgpr_write_b32 a90, v10
    v_accvgpr_write_b32 a27, v7
    v_accvgpr_write_b32 a91, v11
    s_mov_b32 s60, 3407872
    buffer_load_dword v168, v2, s[40:43], s60 offen
    s_mov_b32 s60, 3416064
    buffer_load_dword v169, v2, s[40:43], s60 offen
    s_mov_b32 s60, 3424256
    buffer_load_dword v170, v2, s[40:43], s60 offen
    s_mov_b32 s60, 3432448
    buffer_load_dword v171, v2, s[40:43], s60 offen
    s_mov_b32 s60, 3440640
    buffer_load_dword v172, v2, s[40:43], s60 offen
    s_mov_b32 s60, 3448832
    buffer_load_dword v173, v2, s[40:43], s60 offen
    s_mov_b32 s60, 3457024
    buffer_load_dword v174, v2, s[40:43], s60 offen
    s_mov_b32 s60, 3465216
    buffer_load_dword v175, v2, s[40:43], s60 offen
    s_waitcnt vmcnt(48)
    v_perm_b32 v4, v185, v184, s56
    v_perm_b32 v8, v185, v184, s57
    v_perm_b32 v5, v187, v186, s56
    v_perm_b32 v9, v187, v186, s57
    v_perm_b32 v6, v189, v188, s56
    v_perm_b32 v10, v189, v188, s57
    v_perm_b32 v7, v191, v190, s56
    v_perm_b32 v11, v191, v190, s57
    v_accvgpr_write_b32 a28, v4
    v_accvgpr_write_b32 a92, v8
    v_accvgpr_write_b32 a29, v5
    v_accvgpr_write_b32 a93, v9
    v_accvgpr_write_b32 a30, v6
    v_accvgpr_write_b32 a94, v10
    v_accvgpr_write_b32 a31, v7
    v_accvgpr_write_b32 a95, v11
    s_mov_b32 s60, 3670016
    buffer_load_dword v176, v2, s[40:43], s60 offen
    s_mov_b32 s60, 3678208
    buffer_load_dword v177, v2, s[40:43], s60 offen
    s_mov_b32 s60, 3686400
    buffer_load_dword v178, v2, s[40:43], s60 offen
    s_mov_b32 s60, 3694592
    buffer_load_dword v179, v2, s[40:43], s60 offen
    s_mov_b32 s60, 3702784
    buffer_load_dword v180, v2, s[40:43], s60 offen
    s_mov_b32 s60, 3710976
    buffer_load_dword v181, v2, s[40:43], s60 offen
    s_mov_b32 s60, 3719168
    buffer_load_dword v182, v2, s[40:43], s60 offen
    s_mov_b32 s60, 3727360
    buffer_load_dword v183, v2, s[40:43], s60 offen
    s_waitcnt vmcnt(48)
    v_perm_b32 v4, v129, v128, s56
    v_perm_b32 v8, v129, v128, s57
    v_perm_b32 v5, v131, v130, s56
    v_perm_b32 v9, v131, v130, s57
    v_perm_b32 v6, v133, v132, s56
    v_perm_b32 v10, v133, v132, s57
    v_perm_b32 v7, v135, v134, s56
    v_perm_b32 v11, v135, v134, s57
    v_accvgpr_write_b32 a32, v4
    v_accvgpr_write_b32 a96, v8
    v_accvgpr_write_b32 a33, v5
    v_accvgpr_write_b32 a97, v9
    v_accvgpr_write_b32 a34, v6
    v_accvgpr_write_b32 a98, v10
    v_accvgpr_write_b32 a35, v7
    v_accvgpr_write_b32 a99, v11
    s_mov_b32 s60, 3932160
    buffer_load_dword v184, v2, s[40:43], s60 offen
    s_mov_b32 s60, 3940352
    buffer_load_dword v185, v2, s[40:43], s60 offen
    s_mov_b32 s60, 3948544
    buffer_load_dword v186, v2, s[40:43], s60 offen
    s_mov_b32 s60, 3956736
    buffer_load_dword v187, v2, s[40:43], s60 offen
    s_mov_b32 s60, 3964928
    buffer_load_dword v188, v2, s[40:43], s60 offen
    s_mov_b32 s60, 3973120
    buffer_load_dword v189, v2, s[40:43], s60 offen
    s_mov_b32 s60, 3981312
    buffer_load_dword v190, v2, s[40:43], s60 offen
    s_mov_b32 s60, 3989504
    buffer_load_dword v191, v2, s[40:43], s60 offen
    s_waitcnt vmcnt(48)
    v_perm_b32 v4, v137, v136, s56
    v_perm_b32 v8, v137, v136, s57
    v_perm_b32 v5, v139, v138, s56
    v_perm_b32 v9, v139, v138, s57
    v_perm_b32 v6, v141, v140, s56
    v_perm_b32 v10, v141, v140, s57
    v_perm_b32 v7, v143, v142, s56
    v_perm_b32 v11, v143, v142, s57
    v_accvgpr_write_b32 a36, v4
    v_accvgpr_write_b32 a100, v8
    v_accvgpr_write_b32 a37, v5
    v_accvgpr_write_b32 a101, v9
    v_accvgpr_write_b32 a38, v6
    v_accvgpr_write_b32 a102, v10
    v_accvgpr_write_b32 a39, v7
    v_accvgpr_write_b32 a103, v11
    s_mov_b32 s60, 0
    buffer_load_dword v128, v3, s[44:47], s60 offen
    s_mov_b32 s60, 8192
    buffer_load_dword v129, v3, s[44:47], s60 offen
    s_mov_b32 s60, 16384
    buffer_load_dword v130, v3, s[44:47], s60 offen
    s_mov_b32 s60, 24576
    buffer_load_dword v131, v3, s[44:47], s60 offen
    s_mov_b32 s60, 32768
    buffer_load_dword v132, v3, s[44:47], s60 offen
    s_mov_b32 s60, 40960
    buffer_load_dword v133, v3, s[44:47], s60 offen
    s_mov_b32 s60, 49152
    buffer_load_dword v134, v3, s[44:47], s60 offen
    s_mov_b32 s60, 57344
    buffer_load_dword v135, v3, s[44:47], s60 offen
    s_waitcnt vmcnt(48)
    v_perm_b32 v4, v145, v144, s56
    v_perm_b32 v8, v145, v144, s57
    v_perm_b32 v5, v147, v146, s56
    v_perm_b32 v9, v147, v146, s57
    v_perm_b32 v6, v149, v148, s56
    v_perm_b32 v10, v149, v148, s57
    v_perm_b32 v7, v151, v150, s56
    v_perm_b32 v11, v151, v150, s57
    v_accvgpr_write_b32 a40, v4
    v_accvgpr_write_b32 a104, v8
    v_accvgpr_write_b32 a41, v5
    v_accvgpr_write_b32 a105, v9
    v_accvgpr_write_b32 a42, v6
    v_accvgpr_write_b32 a106, v10
    v_accvgpr_write_b32 a43, v7
    v_accvgpr_write_b32 a107, v11
    s_mov_b32 s60, 262144
    buffer_load_dword v136, v3, s[44:47], s60 offen
    s_mov_b32 s60, 270336
    buffer_load_dword v137, v3, s[44:47], s60 offen
    s_mov_b32 s60, 278528
    buffer_load_dword v138, v3, s[44:47], s60 offen
    s_mov_b32 s60, 286720
    buffer_load_dword v139, v3, s[44:47], s60 offen
    s_mov_b32 s60, 294912
    buffer_load_dword v140, v3, s[44:47], s60 offen
    s_mov_b32 s60, 303104
    buffer_load_dword v141, v3, s[44:47], s60 offen
    s_mov_b32 s60, 311296
    buffer_load_dword v142, v3, s[44:47], s60 offen
    s_mov_b32 s60, 319488
    buffer_load_dword v143, v3, s[44:47], s60 offen
    s_waitcnt vmcnt(48)
    v_perm_b32 v4, v153, v152, s56
    v_perm_b32 v8, v153, v152, s57
    v_perm_b32 v5, v155, v154, s56
    v_perm_b32 v9, v155, v154, s57
    v_perm_b32 v6, v157, v156, s56
    v_perm_b32 v10, v157, v156, s57
    v_perm_b32 v7, v159, v158, s56
    v_perm_b32 v11, v159, v158, s57
    v_accvgpr_write_b32 a44, v4
    v_accvgpr_write_b32 a108, v8
    v_accvgpr_write_b32 a45, v5
    v_accvgpr_write_b32 a109, v9
    v_accvgpr_write_b32 a46, v6
    v_accvgpr_write_b32 a110, v10
    v_accvgpr_write_b32 a47, v7
    v_accvgpr_write_b32 a111, v11
    s_mov_b32 s60, 524288
    buffer_load_dword v144, v3, s[44:47], s60 offen
    s_mov_b32 s60, 532480
    buffer_load_dword v145, v3, s[44:47], s60 offen
    s_mov_b32 s60, 540672
    buffer_load_dword v146, v3, s[44:47], s60 offen
    s_mov_b32 s60, 548864
    buffer_load_dword v147, v3, s[44:47], s60 offen
    s_mov_b32 s60, 557056
    buffer_load_dword v148, v3, s[44:47], s60 offen
    s_mov_b32 s60, 565248
    buffer_load_dword v149, v3, s[44:47], s60 offen
    s_mov_b32 s60, 573440
    buffer_load_dword v150, v3, s[44:47], s60 offen
    s_mov_b32 s60, 581632
    buffer_load_dword v151, v3, s[44:47], s60 offen
    s_waitcnt vmcnt(48)
    v_perm_b32 v4, v161, v160, s56
    v_perm_b32 v8, v161, v160, s57
    v_perm_b32 v5, v163, v162, s56
    v_perm_b32 v9, v163, v162, s57
    v_perm_b32 v6, v165, v164, s56
    v_perm_b32 v10, v165, v164, s57
    v_perm_b32 v7, v167, v166, s56
    v_perm_b32 v11, v167, v166, s57
    v_accvgpr_write_b32 a48, v4
    v_accvgpr_write_b32 a112, v8
    v_accvgpr_write_b32 a49, v5
    v_accvgpr_write_b32 a113, v9
    v_accvgpr_write_b32 a50, v6
    v_accvgpr_write_b32 a114, v10
    v_accvgpr_write_b32 a51, v7
    v_accvgpr_write_b32 a115, v11
    s_mov_b32 s60, 786432
    buffer_load_dword v152, v3, s[44:47], s60 offen
    s_mov_b32 s60, 794624
    buffer_load_dword v153, v3, s[44:47], s60 offen
    s_mov_b32 s60, 802816
    buffer_load_dword v154, v3, s[44:47], s60 offen
    s_mov_b32 s60, 811008
    buffer_load_dword v155, v3, s[44:47], s60 offen
    s_mov_b32 s60, 819200
    buffer_load_dword v156, v3, s[44:47], s60 offen
    s_mov_b32 s60, 827392
    buffer_load_dword v157, v3, s[44:47], s60 offen
    s_mov_b32 s60, 835584
    buffer_load_dword v158, v3, s[44:47], s60 offen
    s_mov_b32 s60, 843776
    buffer_load_dword v159, v3, s[44:47], s60 offen
    s_waitcnt vmcnt(48)
    v_perm_b32 v4, v169, v168, s56
    v_perm_b32 v8, v169, v168, s57
    v_perm_b32 v5, v171, v170, s56
    v_perm_b32 v9, v171, v170, s57
    v_perm_b32 v6, v173, v172, s56
    v_perm_b32 v10, v173, v172, s57
    v_perm_b32 v7, v175, v174, s56
    v_perm_b32 v11, v175, v174, s57
    v_accvgpr_write_b32 a52, v4
    v_accvgpr_write_b32 a116, v8
    v_accvgpr_write_b32 a53, v5
    v_accvgpr_write_b32 a117, v9
    v_accvgpr_write_b32 a54, v6
    v_accvgpr_write_b32 a118, v10
    v_accvgpr_write_b32 a55, v7
    v_accvgpr_write_b32 a119, v11
    s_mov_b32 s60, 1048576
    buffer_load_dword v160, v3, s[44:47], s60 offen
    s_mov_b32 s60, 1056768
    buffer_load_dword v161, v3, s[44:47], s60 offen
    s_mov_b32 s60, 1064960
    buffer_load_dword v162, v3, s[44:47], s60 offen
    s_mov_b32 s60, 1073152
    buffer_load_dword v163, v3, s[44:47], s60 offen
    s_mov_b32 s60, 1081344
    buffer_load_dword v164, v3, s[44:47], s60 offen
    s_mov_b32 s60, 1089536
    buffer_load_dword v165, v3, s[44:47], s60 offen
    s_mov_b32 s60, 1097728
    buffer_load_dword v166, v3, s[44:47], s60 offen
    s_mov_b32 s60, 1105920
    buffer_load_dword v167, v3, s[44:47], s60 offen
    s_waitcnt vmcnt(48)
    v_perm_b32 v4, v177, v176, s56
    v_perm_b32 v8, v177, v176, s57
    v_perm_b32 v5, v179, v178, s56
    v_perm_b32 v9, v179, v178, s57
    v_perm_b32 v6, v181, v180, s56
    v_perm_b32 v10, v181, v180, s57
    v_perm_b32 v7, v183, v182, s56
    v_perm_b32 v11, v183, v182, s57
    v_accvgpr_write_b32 a56, v4
    v_accvgpr_write_b32 a120, v8
    v_accvgpr_write_b32 a57, v5
    v_accvgpr_write_b32 a121, v9
    v_accvgpr_write_b32 a58, v6
    v_accvgpr_write_b32 a122, v10
    v_accvgpr_write_b32 a59, v7
    v_accvgpr_write_b32 a123, v11
    s_mov_b32 s60, 1310720
    buffer_load_dword v168, v3, s[44:47], s60 offen
    s_mov_b32 s60, 1318912
    buffer_load_dword v169, v3, s[44:47], s60 offen
    s_mov_b32 s60, 1327104
    buffer_load_dword v170, v3, s[44:47], s60 offen
    s_mov_b32 s60, 1335296
    buffer_load_dword v171, v3, s[44:47], s60 offen
    s_mov_b32 s60, 1343488
    buffer_load_dword v172, v3, s[44:47], s60 offen
    s_mov_b32 s60, 1351680
    buffer_load_dword v173, v3, s[44:47], s60 offen
    s_mov_b32 s60, 1359872
    buffer_load_dword v174, v3, s[44:47], s60 offen
    s_mov_b32 s60, 1368064
    buffer_load_dword v175, v3, s[44:47], s60 offen
    s_waitcnt vmcnt(48)
    v_perm_b32 v4, v185, v184, s56
    v_perm_b32 v8, v185, v184, s57
    v_perm_b32 v5, v187, v186, s56
    v_perm_b32 v9, v187, v186, s57
    v_perm_b32 v6, v189, v188, s56
    v_perm_b32 v10, v189, v188, s57
    v_perm_b32 v7, v191, v190, s56
    v_perm_b32 v11, v191, v190, s57
    v_accvgpr_write_b32 a60, v4
    v_accvgpr_write_b32 a124, v8
    v_accvgpr_write_b32 a61, v5
    v_accvgpr_write_b32 a125, v9
    v_accvgpr_write_b32 a62, v6
    v_accvgpr_write_b32 a126, v10
    v_accvgpr_write_b32 a63, v7
    v_accvgpr_write_b32 a127, v11
    s_mov_b32 s60, 1572864
    buffer_load_dword v176, v3, s[44:47], s60 offen
    s_mov_b32 s60, 1581056
    buffer_load_dword v177, v3, s[44:47], s60 offen
    s_mov_b32 s60, 1589248
    buffer_load_dword v178, v3, s[44:47], s60 offen
    s_mov_b32 s60, 1597440
    buffer_load_dword v179, v3, s[44:47], s60 offen
    s_mov_b32 s60, 1605632
    buffer_load_dword v180, v3, s[44:47], s60 offen
    s_mov_b32 s60, 1613824
    buffer_load_dword v181, v3, s[44:47], s60 offen
    s_mov_b32 s60, 1622016
    buffer_load_dword v182, v3, s[44:47], s60 offen
    s_mov_b32 s60, 1630208
    buffer_load_dword v183, v3, s[44:47], s60 offen
    s_waitcnt vmcnt(48)
    v_perm_b32 v4, v129, v128, s56
    v_perm_b32 v8, v129, v128, s57
    v_perm_b32 v5, v131, v130, s56
    v_perm_b32 v9, v131, v130, s57
    v_perm_b32 v6, v133, v132, s56
    v_perm_b32 v10, v133, v132, s57
    v_perm_b32 v7, v135, v134, s56
    v_perm_b32 v11, v135, v134, s57
    v_accvgpr_write_b32 a128, v4
    v_accvgpr_write_b32 a192, v8
    v_accvgpr_write_b32 a129, v5
    v_accvgpr_write_b32 a193, v9
    v_accvgpr_write_b32 a130, v6
    v_accvgpr_write_b32 a194, v10
    v_accvgpr_write_b32 a131, v7
    v_accvgpr_write_b32 a195, v11
    s_mov_b32 s60, 1835008
    buffer_load_dword v184, v3, s[44:47], s60 offen
    s_mov_b32 s60, 1843200
    buffer_load_dword v185, v3, s[44:47], s60 offen
    s_mov_b32 s60, 1851392
    buffer_load_dword v186, v3, s[44:47], s60 offen
    s_mov_b32 s60, 1859584
    buffer_load_dword v187, v3, s[44:47], s60 offen
    s_mov_b32 s60, 1867776
    buffer_load_dword v188, v3, s[44:47], s60 offen
    s_mov_b32 s60, 1875968
    buffer_load_dword v189, v3, s[44:47], s60 offen
    s_mov_b32 s60, 1884160
    buffer_load_dword v190, v3, s[44:47], s60 offen
    s_mov_b32 s60, 1892352
    buffer_load_dword v191, v3, s[44:47], s60 offen
    s_waitcnt vmcnt(48)
    v_perm_b32 v4, v137, v136, s56
    v_perm_b32 v8, v137, v136, s57
    v_perm_b32 v5, v139, v138, s56
    v_perm_b32 v9, v139, v138, s57
    v_perm_b32 v6, v141, v140, s56
    v_perm_b32 v10, v141, v140, s57
    v_perm_b32 v7, v143, v142, s56
    v_perm_b32 v11, v143, v142, s57
    v_accvgpr_write_b32 a132, v4
    v_accvgpr_write_b32 a196, v8
    v_accvgpr_write_b32 a133, v5
    v_accvgpr_write_b32 a197, v9
    v_accvgpr_write_b32 a134, v6
    v_accvgpr_write_b32 a198, v10
    v_accvgpr_write_b32 a135, v7
    v_accvgpr_write_b32 a199, v11
    s_mov_b32 s60, 2097152
    buffer_load_dword v128, v3, s[44:47], s60 offen
    s_mov_b32 s60, 2105344
    buffer_load_dword v129, v3, s[44:47], s60 offen
    s_mov_b32 s60, 2113536
    buffer_load_dword v130, v3, s[44:47], s60 offen
    s_mov_b32 s60, 2121728
    buffer_load_dword v131, v3, s[44:47], s60 offen
    s_mov_b32 s60, 2129920
    buffer_load_dword v132, v3, s[44:47], s60 offen
    s_mov_b32 s60, 2138112
    buffer_load_dword v133, v3, s[44:47], s60 offen
    s_mov_b32 s60, 2146304
    buffer_load_dword v134, v3, s[44:47], s60 offen
    s_mov_b32 s60, 2154496
    buffer_load_dword v135, v3, s[44:47], s60 offen
    s_waitcnt vmcnt(48)
    v_perm_b32 v4, v145, v144, s56
    v_perm_b32 v8, v145, v144, s57
    v_perm_b32 v5, v147, v146, s56
    v_perm_b32 v9, v147, v146, s57
    v_perm_b32 v6, v149, v148, s56
    v_perm_b32 v10, v149, v148, s57
    v_perm_b32 v7, v151, v150, s56
    v_perm_b32 v11, v151, v150, s57
    v_accvgpr_write_b32 a136, v4
    v_accvgpr_write_b32 a200, v8
    v_accvgpr_write_b32 a137, v5
    v_accvgpr_write_b32 a201, v9
    v_accvgpr_write_b32 a138, v6
    v_accvgpr_write_b32 a202, v10
    v_accvgpr_write_b32 a139, v7
    v_accvgpr_write_b32 a203, v11
    s_mov_b32 s60, 2359296
    buffer_load_dword v136, v3, s[44:47], s60 offen
    s_mov_b32 s60, 2367488
    buffer_load_dword v137, v3, s[44:47], s60 offen
    s_mov_b32 s60, 2375680
    buffer_load_dword v138, v3, s[44:47], s60 offen
    s_mov_b32 s60, 2383872
    buffer_load_dword v139, v3, s[44:47], s60 offen
    s_mov_b32 s60, 2392064
    buffer_load_dword v140, v3, s[44:47], s60 offen
    s_mov_b32 s60, 2400256
    buffer_load_dword v141, v3, s[44:47], s60 offen
    s_mov_b32 s60, 2408448
    buffer_load_dword v142, v3, s[44:47], s60 offen
    s_mov_b32 s60, 2416640
    buffer_load_dword v143, v3, s[44:47], s60 offen
    s_waitcnt vmcnt(48)
    v_perm_b32 v4, v153, v152, s56
    v_perm_b32 v8, v153, v152, s57
    v_perm_b32 v5, v155, v154, s56
    v_perm_b32 v9, v155, v154, s57
    v_perm_b32 v6, v157, v156, s56
    v_perm_b32 v10, v157, v156, s57
    v_perm_b32 v7, v159, v158, s56
    v_perm_b32 v11, v159, v158, s57
    v_accvgpr_write_b32 a140, v4
    v_accvgpr_write_b32 a204, v8
    v_accvgpr_write_b32 a141, v5
    v_accvgpr_write_b32 a205, v9
    v_accvgpr_write_b32 a142, v6
    v_accvgpr_write_b32 a206, v10
    v_accvgpr_write_b32 a143, v7
    v_accvgpr_write_b32 a207, v11
    s_mov_b32 s60, 2621440
    buffer_load_dword v144, v3, s[44:47], s60 offen
    s_mov_b32 s60, 2629632
    buffer_load_dword v145, v3, s[44:47], s60 offen
    s_mov_b32 s60, 2637824
    buffer_load_dword v146, v3, s[44:47], s60 offen
    s_mov_b32 s60, 2646016
    buffer_load_dword v147, v3, s[44:47], s60 offen
    s_mov_b32 s60, 2654208
    buffer_load_dword v148, v3, s[44:47], s60 offen
    s_mov_b32 s60, 2662400
    buffer_load_dword v149, v3, s[44:47], s60 offen
    s_mov_b32 s60, 2670592
    buffer_load_dword v150, v3, s[44:47], s60 offen
    s_mov_b32 s60, 2678784
    buffer_load_dword v151, v3, s[44:47], s60 offen
    s_waitcnt vmcnt(48)
    v_perm_b32 v4, v161, v160, s56
    v_perm_b32 v8, v161, v160, s57
    v_perm_b32 v5, v163, v162, s56
    v_perm_b32 v9, v163, v162, s57
    v_perm_b32 v6, v165, v164, s56
    v_perm_b32 v10, v165, v164, s57
    v_perm_b32 v7, v167, v166, s56
    v_perm_b32 v11, v167, v166, s57
    v_accvgpr_write_b32 a144, v4
    v_accvgpr_write_b32 a208, v8
    v_accvgpr_write_b32 a145, v5
    v_accvgpr_write_b32 a209, v9
    v_accvgpr_write_b32 a146, v6
    v_accvgpr_write_b32 a210, v10
    v_accvgpr_write_b32 a147, v7
    v_accvgpr_write_b32 a211, v11
    s_mov_b32 s60, 2883584
    buffer_load_dword v152, v3, s[44:47], s60 offen
    s_mov_b32 s60, 2891776
    buffer_load_dword v153, v3, s[44:47], s60 offen
    s_mov_b32 s60, 2899968
    buffer_load_dword v154, v3, s[44:47], s60 offen
    s_mov_b32 s60, 2908160
    buffer_load_dword v155, v3, s[44:47], s60 offen
    s_mov_b32 s60, 2916352
    buffer_load_dword v156, v3, s[44:47], s60 offen
    s_mov_b32 s60, 2924544
    buffer_load_dword v157, v3, s[44:47], s60 offen
    s_mov_b32 s60, 2932736
    buffer_load_dword v158, v3, s[44:47], s60 offen
    s_mov_b32 s60, 2940928
    buffer_load_dword v159, v3, s[44:47], s60 offen
    s_waitcnt vmcnt(48)
    v_perm_b32 v4, v169, v168, s56
    v_perm_b32 v8, v169, v168, s57
    v_perm_b32 v5, v171, v170, s56
    v_perm_b32 v9, v171, v170, s57
    v_perm_b32 v6, v173, v172, s56
    v_perm_b32 v10, v173, v172, s57
    v_perm_b32 v7, v175, v174, s56
    v_perm_b32 v11, v175, v174, s57
    v_accvgpr_write_b32 a148, v4
    v_accvgpr_write_b32 a212, v8
    v_accvgpr_write_b32 a149, v5
    v_accvgpr_write_b32 a213, v9
    v_accvgpr_write_b32 a150, v6
    v_accvgpr_write_b32 a214, v10
    v_accvgpr_write_b32 a151, v7
    v_accvgpr_write_b32 a215, v11
    s_mov_b32 s60, 3145728
    buffer_load_dword v160, v3, s[44:47], s60 offen
    s_mov_b32 s60, 3153920
    buffer_load_dword v161, v3, s[44:47], s60 offen
    s_mov_b32 s60, 3162112
    buffer_load_dword v162, v3, s[44:47], s60 offen
    s_mov_b32 s60, 3170304
    buffer_load_dword v163, v3, s[44:47], s60 offen
    s_mov_b32 s60, 3178496
    buffer_load_dword v164, v3, s[44:47], s60 offen
    s_mov_b32 s60, 3186688
    buffer_load_dword v165, v3, s[44:47], s60 offen
    s_mov_b32 s60, 3194880
    buffer_load_dword v166, v3, s[44:47], s60 offen
    s_mov_b32 s60, 3203072
    buffer_load_dword v167, v3, s[44:47], s60 offen
    s_waitcnt vmcnt(48)
    v_perm_b32 v4, v177, v176, s56
    v_perm_b32 v8, v177, v176, s57
    v_perm_b32 v5, v179, v178, s56
    v_perm_b32 v9, v179, v178, s57
    v_perm_b32 v6, v181, v180, s56
    v_perm_b32 v10, v181, v180, s57
    v_perm_b32 v7, v183, v182, s56
    v_perm_b32 v11, v183, v182, s57
    v_accvgpr_write_b32 a152, v4
    v_accvgpr_write_b32 a216, v8
    v_accvgpr_write_b32 a153, v5
    v_accvgpr_write_b32 a217, v9
    v_accvgpr_write_b32 a154, v6
    v_accvgpr_write_b32 a218, v10
    v_accvgpr_write_b32 a155, v7
    v_accvgpr_write_b32 a219, v11
    s_mov_b32 s60, 3407872
    buffer_load_dword v168, v3, s[44:47], s60 offen
    s_mov_b32 s60, 3416064
    buffer_load_dword v169, v3, s[44:47], s60 offen
    s_mov_b32 s60, 3424256
    buffer_load_dword v170, v3, s[44:47], s60 offen
    s_mov_b32 s60, 3432448
    buffer_load_dword v171, v3, s[44:47], s60 offen
    s_mov_b32 s60, 3440640
    buffer_load_dword v172, v3, s[44:47], s60 offen
    s_mov_b32 s60, 3448832
    buffer_load_dword v173, v3, s[44:47], s60 offen
    s_mov_b32 s60, 3457024
    buffer_load_dword v174, v3, s[44:47], s60 offen
    s_mov_b32 s60, 3465216
    buffer_load_dword v175, v3, s[44:47], s60 offen
    s_waitcnt vmcnt(48)
    v_perm_b32 v4, v185, v184, s56
    v_perm_b32 v8, v185, v184, s57
    v_perm_b32 v5, v187, v186, s56
    v_perm_b32 v9, v187, v186, s57
    v_perm_b32 v6, v189, v188, s56
    v_perm_b32 v10, v189, v188, s57
    v_perm_b32 v7, v191, v190, s56
    v_perm_b32 v11, v191, v190, s57
    v_accvgpr_write_b32 a156, v4
    v_accvgpr_write_b32 a220, v8
    v_accvgpr_write_b32 a157, v5
    v_accvgpr_write_b32 a221, v9
    v_accvgpr_write_b32 a158, v6
    v_accvgpr_write_b32 a222, v10
    v_accvgpr_write_b32 a159, v7
    v_accvgpr_write_b32 a223, v11
    s_mov_b32 s60, 3670016
    buffer_load_dword v176, v3, s[44:47], s60 offen
    s_mov_b32 s60, 3678208
    buffer_load_dword v177, v3, s[44:47], s60 offen
    s_mov_b32 s60, 3686400
    buffer_load_dword v178, v3, s[44:47], s60 offen
    s_mov_b32 s60, 3694592
    buffer_load_dword v179, v3, s[44:47], s60 offen
    s_mov_b32 s60, 3702784
    buffer_load_dword v180, v3, s[44:47], s60 offen
    s_mov_b32 s60, 3710976
    buffer_load_dword v181, v3, s[44:47], s60 offen
    s_mov_b32 s60, 3719168
    buffer_load_dword v182, v3, s[44:47], s60 offen
    s_mov_b32 s60, 3727360
    buffer_load_dword v183, v3, s[44:47], s60 offen
    s_waitcnt vmcnt(48)
    v_perm_b32 v4, v129, v128, s56
    v_perm_b32 v8, v129, v128, s57
    v_perm_b32 v5, v131, v130, s56
    v_perm_b32 v9, v131, v130, s57
    v_perm_b32 v6, v133, v132, s56
    v_perm_b32 v10, v133, v132, s57
    v_perm_b32 v7, v135, v134, s56
    v_perm_b32 v11, v135, v134, s57
    v_accvgpr_write_b32 a160, v4
    v_accvgpr_write_b32 a224, v8
    v_accvgpr_write_b32 a161, v5
    v_accvgpr_write_b32 a225, v9
    v_accvgpr_write_b32 a162, v6
    v_accvgpr_write_b32 a226, v10
    v_accvgpr_write_b32 a163, v7
    v_accvgpr_write_b32 a227, v11
    s_mov_b32 s60, 3932160
    buffer_load_dword v184, v3, s[44:47], s60 offen
    s_mov_b32 s60, 3940352
    buffer_load_dword v185, v3, s[44:47], s60 offen
    s_mov_b32 s60, 3948544
    buffer_load_dword v186, v3, s[44:47], s60 offen
    s_mov_b32 s60, 3956736
    buffer_load_dword v187, v3, s[44:47], s60 offen
    s_mov_b32 s60, 3964928
    buffer_load_dword v188, v3, s[44:47], s60 offen
    s_mov_b32 s60, 3973120
    buffer_load_dword v189, v3, s[44:47], s60 offen
    s_mov_b32 s60, 3981312
    buffer_load_dword v190, v3, s[44:47], s60 offen
    s_mov_b32 s60, 3989504
    buffer_load_dword v191, v3, s[44:47], s60 offen
    s_waitcnt vmcnt(48)
    v_perm_b32 v4, v137, v136, s56
    v_perm_b32 v8, v137, v136, s57
    v_perm_b32 v5, v139, v138, s56
    v_perm_b32 v9, v139, v138, s57
    v_perm_b32 v6, v141, v140, s56
    v_perm_b32 v10, v141, v140, s57
    v_perm_b32 v7, v143, v142, s56
    v_perm_b32 v11, v143, v142, s57
    v_accvgpr_write_b32 a164, v4
    v_accvgpr_write_b32 a228, v8
    v_accvgpr_write_b32 a165, v5
    v_accvgpr_write_b32 a229, v9
    v_accvgpr_write_b32 a166, v6
    v_accvgpr_write_b32 a230, v10
    v_accvgpr_write_b32 a167, v7
    v_accvgpr_write_b32 a231, v11
    s_waitcnt vmcnt(40)
    v_perm_b32 v4, v145, v144, s56
    v_perm_b32 v8, v145, v144, s57
    v_perm_b32 v5, v147, v146, s56
    v_perm_b32 v9, v147, v146, s57
    v_perm_b32 v6, v149, v148, s56
    v_perm_b32 v10, v149, v148, s57
    v_perm_b32 v7, v151, v150, s56
    v_perm_b32 v11, v151, v150, s57
    v_accvgpr_write_b32 a168, v4
    v_accvgpr_write_b32 a232, v8
    v_accvgpr_write_b32 a169, v5
    v_accvgpr_write_b32 a233, v9
    v_accvgpr_write_b32 a170, v6
    v_accvgpr_write_b32 a234, v10
    v_accvgpr_write_b32 a171, v7
    v_accvgpr_write_b32 a235, v11
    s_waitcnt vmcnt(32)
    v_perm_b32 v4, v153, v152, s56
    v_perm_b32 v8, v153, v152, s57
    v_perm_b32 v5, v155, v154, s56
    v_perm_b32 v9, v155, v154, s57
    v_perm_b32 v6, v157, v156, s56
    v_perm_b32 v10, v157, v156, s57
    v_perm_b32 v7, v159, v158, s56
    v_perm_b32 v11, v159, v158, s57
    v_accvgpr_write_b32 a172, v4
    v_accvgpr_write_b32 a236, v8
    v_accvgpr_write_b32 a173, v5
    v_accvgpr_write_b32 a237, v9
    v_accvgpr_write_b32 a174, v6
    v_accvgpr_write_b32 a238, v10
    v_accvgpr_write_b32 a175, v7
    v_accvgpr_write_b32 a239, v11
    s_waitcnt vmcnt(24)
    v_perm_b32 v4, v161, v160, s56
    v_perm_b32 v8, v161, v160, s57
    v_perm_b32 v5, v163, v162, s56
    v_perm_b32 v9, v163, v162, s57
    v_perm_b32 v6, v165, v164, s56
    v_perm_b32 v10, v165, v164, s57
    v_perm_b32 v7, v167, v166, s56
    v_perm_b32 v11, v167, v166, s57
    v_accvgpr_write_b32 a176, v4
    v_accvgpr_write_b32 a240, v8
    v_accvgpr_write_b32 a177, v5
    v_accvgpr_write_b32 a241, v9
    v_accvgpr_write_b32 a178, v6
    v_accvgpr_write_b32 a242, v10
    v_accvgpr_write_b32 a179, v7
    v_accvgpr_write_b32 a243, v11
    s_waitcnt vmcnt(16)
    v_perm_b32 v4, v169, v168, s56
    v_perm_b32 v8, v169, v168, s57
    v_perm_b32 v5, v171, v170, s56
    v_perm_b32 v9, v171, v170, s57
    v_perm_b32 v6, v173, v172, s56
    v_perm_b32 v10, v173, v172, s57
    v_perm_b32 v7, v175, v174, s56
    v_perm_b32 v11, v175, v174, s57
    v_accvgpr_write_b32 a180, v4
    v_accvgpr_write_b32 a244, v8
    v_accvgpr_write_b32 a181, v5
    v_accvgpr_write_b32 a245, v9
    v_accvgpr_write_b32 a182, v6
    v_accvgpr_write_b32 a246, v10
    v_accvgpr_write_b32 a183, v7
    v_accvgpr_write_b32 a247, v11
    s_waitcnt vmcnt(8)
    v_perm_b32 v4, v177, v176, s56
    v_perm_b32 v8, v177, v176, s57
    v_perm_b32 v5, v179, v178, s56
    v_perm_b32 v9, v179, v178, s57
    v_perm_b32 v6, v181, v180, s56
    v_perm_b32 v10, v181, v180, s57
    v_perm_b32 v7, v183, v182, s56
    v_perm_b32 v11, v183, v182, s57
    v_accvgpr_write_b32 a184, v4
    v_accvgpr_write_b32 a248, v8
    v_accvgpr_write_b32 a185, v5
    v_accvgpr_write_b32 a249, v9
    v_accvgpr_write_b32 a186, v6
    v_accvgpr_write_b32 a250, v10
    v_accvgpr_write_b32 a187, v7
    v_accvgpr_write_b32 a251, v11
    s_waitcnt vmcnt(0)
    v_perm_b32 v4, v185, v184, s56
    v_perm_b32 v8, v185, v184, s57
    v_perm_b32 v5, v187, v186, s56
    v_perm_b32 v9, v187, v186, s57
    v_perm_b32 v6, v189, v188, s56
    v_perm_b32 v10, v189, v188, s57
    v_perm_b32 v7, v191, v190, s56
    v_perm_b32 v11, v191, v190, s57
    v_accvgpr_write_b32 a188, v4
    v_accvgpr_write_b32 a252, v8
    v_accvgpr_write_b32 a189, v5
    v_accvgpr_write_b32 a253, v9
    v_accvgpr_write_b32 a190, v6
    v_accvgpr_write_b32 a254, v10
    v_accvgpr_write_b32 a191, v7
    v_accvgpr_write_b32 a255, v11
    s_barrier
    v_lshlrev_b32 v12, 4, v0
    s_mov_b32 s66, 0
    s_mov_b32 s68, -1
    s_lshl_b32 s60, s64, 15
    s_lshl_b32 s61, s3, 13
    s_add_u32 s60, s60, s61
    s_add_u32 s61, s61, s66
    s_mov_b32 m0, s61
    s_nop 0
    buffer_load_dwordx4 v12, s[36:39], s60 offen offset:0 lds
    buffer_load_dwordx4 v12, s[36:39], s60 offen offset:1024 lds
    buffer_load_dwordx4 v12, s[36:39], s60 offen offset:2048 lds
    buffer_load_dwordx4 v12, s[36:39], s60 offen offset:3072 lds
    s_add_u32 s60, s60, 4096
    s_add_u32 s61, s61, 4096
    s_mov_b32 m0, s61
    s_nop 0
    buffer_load_dwordx4 v12, s[36:39], s60 offen offset:0 lds
    buffer_load_dwordx4 v12, s[36:39], s60 offen offset:1024 lds
    buffer_load_dwordx4 v12, s[36:39], s60 offen offset:2048 lds
    buffer_load_dwordx4 v12, s[36:39], s60 offen offset:3072 lds
    s_waitcnt vmcnt(0)
G_21:
    s_barrier
    v_add_u32 v13, s66, v12
    ds_read_b128 v[64:67], v13 offset:0
    ds_read_b128 v[68:71], v13 offset:16384
    ds_read_b128 v[72:75], v13 offset:1024
    ds_read_b128 v[76:79], v13 offset:17408
    ds_read_b128 v[80:83], v13 offset:2048
    ds_read_b128 v[84:87], v13 offset:18432
    s_add_u32 s69, s64, 7
    s_xor_b32 s66, s66, 32768
    s_cmp_ge_u32 s69, 64
    s_cbranch_scc1 GN_23
    s_lshl_b32 s60, s69, 15
    s_lshl_b32 s61, s3, 13
    s_add_u32 s60, s60, s61
    s_add_u32 s61, s61, s66
    s_mov_b32 m0, s61
    s_nop 0
    buffer_load_dwordx4 v12, s[36:39], s60 offen offset:0 lds
    buffer_load_dwordx4 v12, s[36:39], s60 offen offset:1024 lds
    buffer_load_dwordx4 v12, s[36:39], s60 offen offset:2048 lds
    buffer_load_dwordx4 v12, s[36:39], s60 offen offset:3072 lds
    s_add_u32 s60, s60, 4096
    s_add_u32 s61, s61, 4096
    s_mov_b32 m0, s61
    s_nop 0
    buffer_load_dwordx4 v12, s[36:39], s60 offen offset:0 lds
    buffer_load_dwordx4 v12, s[36:39], s60 offen offset:1024 lds
    buffer_load_dwordx4 v12, s[36:39], s60 offen offset:2048 lds
    buffer_load_dwordx4 v12, s[36:39], s60 offen offset:3072 lds
GN_23:
    ds_read_b128 v[88:91], v13 offset:3072
    ds_read_b128 v[92:95], v13 offset:19456
    s_waitcnt lgkmcnt(6)
    v_mfma_f32_16x16x32_bf16 v[32:35], a[0:3], v[64:67], 0
    v_mfma_f32_16x16x32_bf16 v[48:51], a[0:3], v[68:71], 0
    v_mfma_f32_16x16x32_bf16 v[36:39], a[64:67], v[64:67], 0
    v_mfma_f32_16x16x32_bf16 v[52:55], a[64:67], v[68:71], 0
    v_mfma_f32_16x16x32_bf16 v[40:43], a[128:131], v[64:67], 0
    v_mfma_f32_16x16x32_bf16 v[56:59], a[128:131], v[68:71], 0
    v_mfma_f32_16x16x32_bf16 v[44:47], a[192:195], v[64:67], 0
    v_mfma_f32_16x16x32_bf16 v[60:63], a[192:195], v[68:71], 0
    ds_read_b128 v[64:67], v13 offset:4096
    ds_read_b128 v[68:71], v13 offset:20480
    s_waitcnt lgkmcnt(6)
    v_mfma_f32_16x16x32_bf16 v[32:35], a[4:7], v[72:75], v[32:35]
    v_mfma_f32_16x16x32_bf16 v[48:51], a[4:7], v[76:79], v[48:51]
    v_mfma_f32_16x16x32_bf16 v[36:39], a[68:71], v[72:75], v[36:39]
    v_mfma_f32_16x16x32_bf16 v[52:55], a[68:71], v[76:79], v[52:55]
    v_mfma_f32_16x16x32_bf16 v[40:43], a[132:135], v[72:75], v[40:43]
    v_mfma_f32_16x16x32_bf16 v[56:59], a[132:135], v[76:79], v[56:59]
    v_mfma_f32_16x16x32_bf16 v[44:47], a[196:199], v[72:75], v[44:47]
    v_mfma_f32_16x16x32_bf16 v[60:63], a[196:199], v[76:79], v[60:63]
    ds_read_b128 v[72:75], v13 offset:5120
    ds_read_b128 v[76:79], v13 offset:21504
    s_waitcnt lgkmcnt(6)
    v_mfma_f32_16x16x32_bf16 v[32:35], a[8:11], v[80:83], v[32:35]
    v_mfma_f32_16x16x32_bf16 v[48:51], a[8:11], v[84:87], v[48:51]
    v_mfma_f32_16x16x32_bf16 v[36:39], a[72:75], v[80:83], v[36:39]
    v_mfma_f32_16x16x32_bf16 v[52:55], a[72:75], v[84:87], v[52:55]
    v_mfma_f32_16x16x32_bf16 v[40:43], a[136:139], v[80:83], v[40:43]
    v_mfma_f32_16x16x32_bf16 v[56:59], a[136:139], v[84:87], v[56:59]
    v_mfma_f32_16x16x32_bf16 v[44:47], a[200:203], v[80:83], v[44:47]
    v_mfma_f32_16x16x32_bf16 v[60:63], a[200:203], v[84:87], v[60:63]
    ds_read_b128 v[80:83], v13 offset:6144
    ds_read_b128 v[84:87], v13 offset:22528
    s_waitcnt lgkmcnt(6)
    v_mfma_f32_16x16x32_bf16 v[32:35], a[12:15], v[88:91], v[32:35]
    v_mfma_f32_16x16x32_bf16 v[48:51], a[12:15], v[92:95], v[48:51]
    v_mfma_f32_16x16x32_bf16 v[36:39], a[76:79], v[88:91], v[36:39]
    v_mfma_f32_16x16x32_bf16 v[52:55], a[76:79], v[92:95], v[52:55]
    v_mfma_f32_16x16x32_bf16 v[40:43], a[140:143], v[88:91], v[40:43]
    v_mfma_f32_16x16x32_bf16 v[56:59], a[140:143], v[92:95], v[56:59]
    v_mfma_f32_16x16x32_bf16 v[44:47], a[204:207], v[88:91], v[44:47]
    v_mfma_f32_16x16x32_bf16 v[60:63], a[204:207], v[92:95], v[60:63]
    ds_read_b128 v[88:91], v13 offset:7168
    ds_read_b128 v[92:95], v13 offset:23552
    s_waitcnt lgkmcnt(6)
    v_mfma_f32_16x16x32_bf16 v[32:35], a[16:19], v[64:67], v[32:35]
    v_mfma_f32_16x16x32_bf16 v[48:51], a[16:19], v[68:71], v[48:51]
    v_mfma_f32_16x16x32_bf16 v[36:39], a[80:83], v[64:67], v[36:39]
    v_mfma_f32_16x16x32_bf16 v[52:55], a[80:83], v[68:71], v[52:55]
    v_mfma_f32_16x16x32_bf16 v[40:43], a[144:147], v[64:67], v[40:43]
    v_mfma_f32_16x16x32_bf16 v[56:59], a[144:147], v[68:71], v[56:59]
    v_mfma_f32_16x16x32_bf16 v[44:47], a[208:211], v[64:67], v[44:47]
    v_mfma_f32_16x16x32_bf16 v[60:63], a[208:211], v[68:71], v[60:63]
    ds_read_b128 v[64:67], v13 offset:8192
    ds_read_b128 v[68:71], v13 offset:24576
    s_waitcnt lgkmcnt(6)
    v_mfma_f32_16x16x32_bf16 v[32:35], a[20:23], v[72:75], v[32:35]
    v_mfma_f32_16x16x32_bf16 v[48:51], a[20:23], v[76:79], v[48:51]
    v_mfma_f32_16x16x32_bf16 v[36:39], a[84:87], v[72:75], v[36:39]
    v_mfma_f32_16x16x32_bf16 v[52:55], a[84:87], v[76:79], v[52:55]
    v_mfma_f32_16x16x32_bf16 v[40:43], a[148:151], v[72:75], v[40:43]
    v_mfma_f32_16x16x32_bf16 v[56:59], a[148:151], v[76:79], v[56:59]
    v_mfma_f32_16x16x32_bf16 v[44:47], a[212:215], v[72:75], v[44:47]
    v_mfma_f32_16x16x32_bf16 v[60:63], a[212:215], v[76:79], v[60:63]
    ds_read_b128 v[72:75], v13 offset:9216
    ds_read_b128 v[76:79], v13 offset:25600
    s_waitcnt lgkmcnt(6)
    v_mfma_f32_16x16x32_bf16 v[32:35], a[24:27], v[80:83], v[32:35]
    v_mfma_f32_16x16x32_bf16 v[48:51], a[24:27], v[84:87], v[48:51]
    v_mfma_f32_16x16x32_bf16 v[36:39], a[88:91], v[80:83], v[36:39]
    v_mfma_f32_16x16x32_bf16 v[52:55], a[88:91], v[84:87], v[52:55]
    v_mfma_f32_16x16x32_bf16 v[40:43], a[152:155], v[80:83], v[40:43]
    v_mfma_f32_16x16x32_bf16 v[56:59], a[152:155], v[84:87], v[56:59]
    v_mfma_f32_16x16x32_bf16 v[44:47], a[216:219], v[80:83], v[44:47]
    v_mfma_f32_16x16x32_bf16 v[60:63], a[216:219], v[84:87], v[60:63]
    ds_read_b128 v[80:83], v13 offset:10240
    ds_read_b128 v[84:87], v13 offset:26624
    s_waitcnt lgkmcnt(6)
    v_mfma_f32_16x16x32_bf16 v[32:35], a[28:31], v[88:91], v[32:35]
    v_mfma_f32_16x16x32_bf16 v[48:51], a[28:31], v[92:95], v[48:51]
    v_mfma_f32_16x16x32_bf16 v[36:39], a[92:95], v[88:91], v[36:39]
    v_mfma_f32_16x16x32_bf16 v[52:55], a[92:95], v[92:95], v[52:55]
    v_mfma_f32_16x16x32_bf16 v[40:43], a[156:159], v[88:91], v[40:43]
    v_mfma_f32_16x16x32_bf16 v[56:59], a[156:159], v[92:95], v[56:59]
    v_mfma_f32_16x16x32_bf16 v[44:47], a[220:223], v[88:91], v[44:47]
    v_mfma_f32_16x16x32_bf16 v[60:63], a[220:223], v[92:95], v[60:63]
    ds_read_b128 v[88:91], v13 offset:11264
    ds_read_b128 v[92:95], v13 offset:27648
    s_waitcnt lgkmcnt(6)
    v_mfma_f32_16x16x32_bf16 v[32:35], a[32:35], v[64:67], v[32:35]
    v_mfma_f32_16x16x32_bf16 v[48:51], a[32:35], v[68:71], v[48:51]
    v_mfma_f32_16x16x32_bf16 v[36:39], a[96:99], v[64:67], v[36:39]
    v_mfma_f32_16x16x32_bf16 v[52:55], a[96:99], v[68:71], v[52:55]
    v_mfma_f32_16x16x32_bf16 v[40:43], a[160:163], v[64:67], v[40:43]
    v_mfma_f32_16x16x32_bf16 v[56:59], a[160:163], v[68:71], v[56:59]
    v_mfma_f32_16x16x32_bf16 v[44:47], a[224:227], v[64:67], v[44:47]
    v_mfma_f32_16x16x32_bf16 v[60:63], a[224:227], v[68:71], v[60:63]
    ds_read_b128 v[64:67], v13 offset:12288
    ds_read_b128 v[68:71], v13 offset:28672
    s_waitcnt lgkmcnt(6)
    v_mfma_f32_16x16x32_bf16 v[32:35], a[36:39], v[72:75], v[32:35]
    v_mfma_f32_16x16x32_bf16 v[48:51], a[36:39], v[76:79], v[48:51]
    v_mfma_f32_16x16x32_bf16 v[36:39], a[100:103], v[72:75], v[36:39]
    v_mfma_f32_16x16x32_bf16 v[52:55], a[100:103], v[76:79], v[52:55]
    v_mfma_f32_16x16x32_bf16 v[40:43], a[164:167], v[72:75], v[40:43]
    v_mfma_f32_16x16x32_bf16 v[56:59], a[164:167], v[76:79], v[56:59]
    v_mfma_f32_16x16x32_bf16 v[44:47], a[228:231], v[72:75], v[44:47]
    v_mfma_f32_16x16x32_bf16 v[60:63], a[228:231], v[76:79], v[60:63]
    ds_read_b128 v[72:75], v13 offset:13312
    ds_read_b128 v[76:79], v13 offset:29696
    s_waitcnt lgkmcnt(6)
    v_mfma_f32_16x16x32_bf16 v[32:35], a[40:43], v[80:83], v[32:35]
    v_mfma_f32_16x16x32_bf16 v[48:51], a[40:43], v[84:87], v[48:51]
    v_mfma_f32_16x16x32_bf16 v[36:39], a[104:107], v[80:83], v[36:39]
    v_mfma_f32_16x16x32_bf16 v[52:55], a[104:107], v[84:87], v[52:55]
    v_mfma_f32_16x16x32_bf16 v[40:43], a[168:171], v[80:83], v[40:43]
    v_mfma_f32_16x16x32_bf16 v[56:59], a[168:171], v[84:87], v[56:59]
    v_mfma_f32_16x16x32_bf16 v[44:47], a[232:235], v[80:83], v[44:47]
    v_mfma_f32_16x16x32_bf16 v[60:63], a[232:235], v[84:87], v[60:63]
    ds_read_b128 v[80:83], v13 offset:14336
    ds_read_b128 v[84:87], v13 offset:30720
    s_waitcnt lgkmcnt(6)
    v_mfma_f32_16x16x32_bf16 v[32:35], a[44:47], v[88:91], v[32:35]
    v_mfma_f32_16x16x32_bf16 v[48:51], a[44:47], v[92:95], v[48:51]
    v_mfma_f32_16x16x32_bf16 v[36:39], a[108:111], v[88:91], v[36:39]
    v_mfma_f32_16x16x32_bf16 v[52:55], a[108:111], v[92:95], v[52:55]
    v_mfma_f32_16x16x32_bf16 v[40:43], a[172:175], v[88:91], v[40:43]
    v_mfma_f32_16x16x32_bf16 v[56:59], a[172:175], v[92:95], v[56:59]
    v_mfma_f32_16x16x32_bf16 v[44:47], a[236:239], v[88:91], v[44:47]
    v_mfma_f32_16x16x32_bf16 v[60:63], a[236:239], v[92:95], v[60:63]
    ds_read_b128 v[88:91], v13 offset:15360
    ds_read_b128 v[92:95], v13 offset:31744
    s_waitcnt lgkmcnt(6)
    v_mfma_f32_16x16x32_bf16 v[32:35], a[48:51], v[64:67], v[32:35]
    v_mfma_f32_16x16x32_bf16 v[48:51], a[48:51], v[68:71], v[48:51]
    v_mfma_f32_16x16x32_bf16 v[36:39], a[112:115], v[64:67], v[36:39]
    v_mfma_f32_16x16x32_bf16 v[52:55], a[112:115], v[68:71], v[52:55]
    v_mfma_f32_16x16x32_bf16 v[40:43], a[176:179], v[64:67], v[40:43]
    v_mfma_f32_16x16x32_bf16 v[56:59], a[176:179], v[68:71], v[56:59]
    v_mfma_f32_16x16x32_bf16 v[44:47], a[240:243], v[64:67], v[44:47]
    v_mfma_f32_16x16x32_bf16 v[60:63], a[240:243], v[68:71], v[60:63]
    s_waitcnt lgkmcnt(4)
    v_mfma_f32_16x16x32_bf16 v[32:35], a[52:55], v[72:75], v[32:35]
    v_mfma_f32_16x16x32_bf16 v[48:51], a[52:55], v[76:79], v[48:51]
    v_mfma_f32_16x16x32_bf16 v[36:39], a[116:119], v[72:75], v[36:39]
    v_mfma_f32_16x16x32_bf16 v[52:55], a[116:119], v[76:79], v[52:55]
    v_mfma_f32_16x16x32_bf16 v[40:43], a[180:183], v[72:75], v[40:43]
    v_mfma_f32_16x16x32_bf16 v[56:59], a[180:183], v[76:79], v[56:59]
    v_mfma_f32_16x16x32_bf16 v[44:47], a[244:247], v[72:75], v[44:47]
    v_mfma_f32_16x16x32_bf16 v[60:63], a[244:247], v[76:79], v[60:63]
    s_waitcnt lgkmcnt(2)
    v_mfma_f32_16x16x32_bf16 v[32:35], a[56:59], v[80:83], v[32:35]
    v_mfma_f32_16x16x32_bf16 v[48:51], a[56:59], v[84:87], v[48:51]
    v_mfma_f32_16x16x32_bf16 v[36:39], a[120:123], v[80:83], v[36:39]
    v_mfma_f32_16x16x32_bf16 v[52:55], a[120:123], v[84:87], v[52:55]
    v_mfma_f32_16x16x32_bf16 v[40:43], a[184:187], v[80:83], v[40:43]
    v_mfma_f32_16x16x32_bf16 v[56:59], a[184:187], v[84:87], v[56:59]
    v_mfma_f32_16x16x32_bf16 v[44:47], a[248:251], v[80:83], v[44:47]
    v_mfma_f32_16x16x32_bf16 v[60:63], a[248:251], v[84:87], v[60:63]
    s_waitcnt lgkmcnt(0)
    v_mfma_f32_16x16x32_bf16 v[32:35], a[60:63], v[88:91], v[32:35]
    v_mfma_f32_16x16x32_bf16 v[48:51], a[60:63], v[92:95], v[48:51]
    v_mfma_f32_16x16x32_bf16 v[36:39], a[124:127], v[88:91], v[36:39]
    v_mfma_f32_16x16x32_bf16 v[52:55], a[124:127], v[92:95], v[52:55]
    v_mfma_f32_16x16x32_bf16 v[40:43], a[188:191], v[88:91], v[40:43]
    v_mfma_f32_16x16x32_bf16 v[56:59], a[188:191], v[92:95], v[56:59]
    v_mfma_f32_16x16x32_bf16 v[44:47], a[252:255], v[88:91], v[44:47]
    v_mfma_f32_16x16x32_bf16 v[60:63], a[252:255], v[92:95], v[60:63]
    s_waitcnt vmcnt(0)
    s_nop 7
    s_lshl_b32 s60, s64, 4
    s_add_u32 s60, s60, s67
    s_lshl_b32 s60, s60, 14
    s_add_u32 s60, s60, 36700160
    s_lshl_b32 s61, s3, 10
    s_add_u32 s61, s60, s61
    v_cvt_pk_bf16_f32 v96, v32, v36
    v_cvt_pk_bf16_f32 v97, v33, v37
    v_cvt_pk_bf16_f32 v98, v34, v38
    v_cvt_pk_bf16_f32 v99, v35, v39
    buffer_store_dwordx4 v[96:99], v12, s[36:39], s61 offen sc1
    s_add_u32 s61, s61, 4096
    v_cvt_pk_bf16_f32 v100, v48, v52
    v_cvt_pk_bf16_f32 v101, v49, v53
    v_cvt_pk_bf16_f32 v102, v50, v54
    v_cvt_pk_bf16_f32 v103, v51, v55
    buffer_store_dwordx4 v[100:103], v12, s[36:39], s61 offen sc1
    s_add_u32 s61, s61, 4096
    v_cvt_pk_bf16_f32 v104, v40, v44
    v_cvt_pk_bf16_f32 v105, v41, v45
    v_cvt_pk_bf16_f32 v106, v42, v46
    v_cvt_pk_bf16_f32 v107, v43, v47
    buffer_store_dwordx4 v[104:107], v12, s[36:39], s61 offen sc1
    s_add_u32 s61, s61, 4096
    v_cvt_pk_bf16_f32 v108, v56, v60
    v_cvt_pk_bf16_f32 v109, v57, v61
    v_cvt_pk_bf16_f32 v110, v58, v62
    v_cvt_pk_bf16_f32 v111, v59, v63
    buffer_store_dwordx4 v[108:111], v12, s[36:39], s61 offen sc1
    s_add_u32 s61, s61, 4096
    s_mov_b32 s68, s64
    s_add_u32 s64, s64, 7
    s_cmp_lt_u32 s64, 64
    s_cbranch_scc1 G_21
    s_branch P2_DONE
P2_GU:
    s_mov_b32 s40, s24
    s_mov_b32 s41, s25
    s_mov_b32 s42, 1835008
    s_mov_b32 s43, 0x00020000
    s_mov_b32 s44, s26
    s_mov_b32 s45, s27
    s_mov_b32 s46, 1835008
    s_mov_b32 s47, 0x00020000
    s_sub_u32 s67, s67, 16
    s_lshl_b32 s60, s67, 8
    s_lshl_b32 s61, s3, 6
    s_add_u32 s61, s60, s61
    v_lshrrev_b32 v4, 4, v0
    v_and_b32 v5, 15, v0
    v_mul_u32_u24 v4, 28672, v4
    v_lshl_add_u32 v4, v5, 2, v4
    v_add_u32 v2, s61, v4
    v_add_u32 v3, s61, v4
    v_lshrrev_b32 v4, 1, v0
    v_and_b32 v5, 1, v0
    v_mul_u32_u24 v4, 3584, v4
    v_lshl_add_u32 v4, v5, 7, v4
    s_add_u32 s58, s65, 1
    s_and_b32 s59, s58, 3
    s_lshl_b32 s59, s59, 2
    s_add_u32 s59, s59, s3
    s_mul_i32 s59, s59, 114688
    s_cmp_ge_u32 s58, 4
    s_cbranch_scc1 TB_25
    s_add_u32 s59, s59, s60
    buffer_load_dword v6, v4, s[40:43], s59 offen
    s_branch TE_26
TB_25:
    s_add_u32 s59, s59, s60
    buffer_load_dword v6, v4, s[44:47], s59 offen
TE_26:
    s_add_u32 s58, s58, 4
    s_cmp_gt_u32 s58, 7
    s_cselect_b32 s59, 7, 0
    s_sub_u32 s58, s58, s59
    s_and_b32 s59, s58, 3
    s_lshl_b32 s59, s59, 2
    s_add_u32 s59, s59, s3
    s_mul_i32 s59, s59, 114688
    s_cmp_ge_u32 s58, 4
    s_cbranch_scc1 TB_27
    s_add_u32 s59, s59, s60
    buffer_load_dword v7, v4, s[40:43], s59 offen
    s_branch TE_28
TB_27:
    s_add_u32 s59, s59, s60
    buffer_load_dword v7, v4, s[44:47], s59 offen
TE_28:
    s_mov_b32 s60, 0
    buffer_load_dword v128, v2, s[40:43], s60 offen
    s_mov_b32 s60, 3584
    buffer_load_dword v129, v2, s[40:43], s60 offen
    s_mov_b32 s60, 7168
    buffer_load_dword v130, v2, s[40:43], s60 offen
    s_mov_b32 s60, 10752
    buffer_load_dword v131, v2, s[40:43], s60 offen
    s_mov_b32 s60, 14336
    buffer_load_dword v132, v2, s[40:43], s60 offen
    s_mov_b32 s60, 17920
    buffer_load_dword v133, v2, s[40:43], s60 offen
    s_mov_b32 s60, 21504
    buffer_load_dword v134, v2, s[40:43], s60 offen
    s_mov_b32 s60, 25088
    buffer_load_dword v135, v2, s[40:43], s60 offen
    s_mov_b32 s60, 114688
    buffer_load_dword v136, v2, s[40:43], s60 offen
    s_mov_b32 s60, 118272
    buffer_load_dword v137, v2, s[40:43], s60 offen
    s_mov_b32 s60, 121856
    buffer_load_dword v138, v2, s[40:43], s60 offen
    s_mov_b32 s60, 125440
    buffer_load_dword v139, v2, s[40:43], s60 offen
    s_mov_b32 s60, 129024
    buffer_load_dword v140, v2, s[40:43], s60 offen
    s_mov_b32 s60, 132608
    buffer_load_dword v141, v2, s[40:43], s60 offen
    s_mov_b32 s60, 136192
    buffer_load_dword v142, v2, s[40:43], s60 offen
    s_mov_b32 s60, 139776
    buffer_load_dword v143, v2, s[40:43], s60 offen
    s_mov_b32 s60, 229376
    buffer_load_dword v144, v2, s[40:43], s60 offen
    s_mov_b32 s60, 232960
    buffer_load_dword v145, v2, s[40:43], s60 offen
    s_mov_b32 s60, 236544
    buffer_load_dword v146, v2, s[40:43], s60 offen
    s_mov_b32 s60, 240128
    buffer_load_dword v147, v2, s[40:43], s60 offen
    s_mov_b32 s60, 243712
    buffer_load_dword v148, v2, s[40:43], s60 offen
    s_mov_b32 s60, 247296
    buffer_load_dword v149, v2, s[40:43], s60 offen
    s_mov_b32 s60, 250880
    buffer_load_dword v150, v2, s[40:43], s60 offen
    s_mov_b32 s60, 254464
    buffer_load_dword v151, v2, s[40:43], s60 offen
    s_mov_b32 s60, 344064
    buffer_load_dword v152, v2, s[40:43], s60 offen
    s_mov_b32 s60, 347648
    buffer_load_dword v153, v2, s[40:43], s60 offen
    s_mov_b32 s60, 351232
    buffer_load_dword v154, v2, s[40:43], s60 offen
    s_mov_b32 s60, 354816
    buffer_load_dword v155, v2, s[40:43], s60 offen
    s_mov_b32 s60, 358400
    buffer_load_dword v156, v2, s[40:43], s60 offen
    s_mov_b32 s60, 361984
    buffer_load_dword v157, v2, s[40:43], s60 offen
    s_mov_b32 s60, 365568
    buffer_load_dword v158, v2, s[40:43], s60 offen
    s_mov_b32 s60, 369152
    buffer_load_dword v159, v2, s[40:43], s60 offen
    s_mov_b32 s60, 458752
    buffer_load_dword v160, v2, s[40:43], s60 offen
    s_mov_b32 s60, 462336
    buffer_load_dword v161, v2, s[40:43], s60 offen
    s_mov_b32 s60, 465920
    buffer_load_dword v162, v2, s[40:43], s60 offen
    s_mov_b32 s60, 469504
    buffer_load_dword v163, v2, s[40:43], s60 offen
    s_mov_b32 s60, 473088
    buffer_load_dword v164, v2, s[40:43], s60 offen
    s_mov_b32 s60, 476672
    buffer_load_dword v165, v2, s[40:43], s60 offen
    s_mov_b32 s60, 480256
    buffer_load_dword v166, v2, s[40:43], s60 offen
    s_mov_b32 s60, 483840
    buffer_load_dword v167, v2, s[40:43], s60 offen
    s_mov_b32 s60, 573440
    buffer_load_dword v168, v2, s[40:43], s60 offen
    s_mov_b32 s60, 577024
    buffer_load_dword v169, v2, s[40:43], s60 offen
    s_mov_b32 s60, 580608
    buffer_load_dword v170, v2, s[40:43], s60 offen
    s_mov_b32 s60, 584192
    buffer_load_dword v171, v2, s[40:43], s60 offen
    s_mov_b32 s60, 587776
    buffer_load_dword v172, v2, s[40:43], s60 offen
    s_mov_b32 s60, 591360
    buffer_load_dword v173, v2, s[40:43], s60 offen
    s_mov_b32 s60, 594944
    buffer_load_dword v174, v2, s[40:43], s60 offen
    s_mov_b32 s60, 598528
    buffer_load_dword v175, v2, s[40:43], s60 offen
    s_mov_b32 s60, 688128
    buffer_load_dword v176, v2, s[40:43], s60 offen
    s_mov_b32 s60, 691712
    buffer_load_dword v177, v2, s[40:43], s60 offen
    s_mov_b32 s60, 695296
    buffer_load_dword v178, v2, s[40:43], s60 offen
    s_mov_b32 s60, 698880
    buffer_load_dword v179, v2, s[40:43], s60 offen
    s_mov_b32 s60, 702464
    buffer_load_dword v180, v2, s[40:43], s60 offen
    s_mov_b32 s60, 706048
    buffer_load_dword v181, v2, s[40:43], s60 offen
    s_mov_b32 s60, 709632
    buffer_load_dword v182, v2, s[40:43], s60 offen
    s_mov_b32 s60, 713216
    buffer_load_dword v183, v2, s[40:43], s60 offen
    s_waitcnt vmcnt(48)
    v_perm_b32 v4, v129, v128, s56
    v_perm_b32 v8, v129, v128, s57
    v_perm_b32 v5, v131, v130, s56
    v_perm_b32 v9, v131, v130, s57
    v_perm_b32 v6, v133, v132, s56
    v_perm_b32 v10, v133, v132, s57
    v_perm_b32 v7, v135, v134, s56
    v_perm_b32 v11, v135, v134, s57
    v_accvgpr_write_b32 a0, v4
    v_accvgpr_write_b32 a64, v8
    v_accvgpr_write_b32 a1, v5
    v_accvgpr_write_b32 a65, v9
    v_accvgpr_write_b32 a2, v6
    v_accvgpr_write_b32 a66, v10
    v_accvgpr_write_b32 a3, v7
    v_accvgpr_write_b32 a67, v11
    s_mov_b32 s60, 802816
    buffer_load_dword v184, v2, s[40:43], s60 offen
    s_mov_b32 s60, 806400
    buffer_load_dword v185, v2, s[40:43], s60 offen
    s_mov_b32 s60, 809984
    buffer_load_dword v186, v2, s[40:43], s60 offen
    s_mov_b32 s60, 813568
    buffer_load_dword v187, v2, s[40:43], s60 offen
    s_mov_b32 s60, 817152
    buffer_load_dword v188, v2, s[40:43], s60 offen
    s_mov_b32 s60, 820736
    buffer_load_dword v189, v2, s[40:43], s60 offen
    s_mov_b32 s60, 824320
    buffer_load_dword v190, v2, s[40:43], s60 offen
    s_mov_b32 s60, 827904
    buffer_load_dword v191, v2, s[40:43], s60 offen
    s_waitcnt vmcnt(48)
    v_perm_b32 v4, v137, v136, s56
    v_perm_b32 v8, v137, v136, s57
    v_perm_b32 v5, v139, v138, s56
    v_perm_b32 v9, v139, v138, s57
    v_perm_b32 v6, v141, v140, s56
    v_perm_b32 v10, v141, v140, s57
    v_perm_b32 v7, v143, v142, s56
    v_perm_b32 v11, v143, v142, s57
    v_accvgpr_write_b32 a4, v4
    v_accvgpr_write_b32 a68, v8
    v_accvgpr_write_b32 a5, v5
    v_accvgpr_write_b32 a69, v9
    v_accvgpr_write_b32 a6, v6
    v_accvgpr_write_b32 a70, v10
    v_accvgpr_write_b32 a7, v7
    v_accvgpr_write_b32 a71, v11
    s_mov_b32 s60, 917504
    buffer_load_dword v128, v2, s[40:43], s60 offen
    s_mov_b32 s60, 921088
    buffer_load_dword v129, v2, s[40:43], s60 offen
    s_mov_b32 s60, 924672
    buffer_load_dword v130, v2, s[40:43], s60 offen
    s_mov_b32 s60, 928256
    buffer_load_dword v131, v2, s[40:43], s60 offen
    s_mov_b32 s60, 931840
    buffer_load_dword v132, v2, s[40:43], s60 offen
    s_mov_b32 s60, 935424
    buffer_load_dword v133, v2, s[40:43], s60 offen
    s_mov_b32 s60, 939008
    buffer_load_dword v134, v2, s[40:43], s60 offen
    s_mov_b32 s60, 942592
    buffer_load_dword v135, v2, s[40:43], s60 offen
    s_waitcnt vmcnt(48)
    v_perm_b32 v4, v145, v144, s56
    v_perm_b32 v8, v145, v144, s57
    v_perm_b32 v5, v147, v146, s56
    v_perm_b32 v9, v147, v146, s57
    v_perm_b32 v6, v149, v148, s56
    v_perm_b32 v10, v149, v148, s57
    v_perm_b32 v7, v151, v150, s56
    v_perm_b32 v11, v151, v150, s57
    v_accvgpr_write_b32 a8, v4
    v_accvgpr_write_b32 a72, v8
    v_accvgpr_write_b32 a9, v5
    v_accvgpr_write_b32 a73, v9
    v_accvgpr_write_b32 a10, v6
    v_accvgpr_write_b32 a74, v10
    v_accvgpr_write_b32 a11, v7
    v_accvgpr_write_b32 a75, v11
    s_mov_b32 s60, 1032192
    buffer_load_dword v136, v2, s[40:43], s60 offen
    s_mov_b32 s60, 1035776
    buffer_load_dword v137, v2, s[40:43], s60 offen
    s_mov_b32 s60, 1039360
    buffer_load_dword v138, v2, s[40:43], s60 offen
    s_mov_b32 s60, 1042944
    buffer_load_dword v139, v2, s[40:43], s60 offen
    s_mov_b32 s60, 1046528
    buffer_load_dword v140, v2, s[40:43], s60 offen
    s_mov_b32 s60, 1050112
    buffer_load_dword v141, v2, s[40:43], s60 offen
    s_mov_b32 s60, 1053696
    buffer_load_dword v142, v2, s[40:43], s60 offen
    s_mov_b32 s60, 1057280
    buffer_load_dword v143, v2, s[40:43], s60 offen
    s_waitcnt vmcnt(48)
    v_perm_b32 v4, v153, v152, s56
    v_perm_b32 v8, v153, v152, s57
    v_perm_b32 v5, v155, v154, s56
    v_perm_b32 v9, v155, v154, s57
    v_perm_b32 v6, v157, v156, s56
    v_perm_b32 v10, v157, v156, s57
    v_perm_b32 v7, v159, v158, s56
    v_perm_b32 v11, v159, v158, s57
    v_accvgpr_write_b32 a12, v4
    v_accvgpr_write_b32 a76, v8
    v_accvgpr_write_b32 a13, v5
    v_accvgpr_write_b32 a77, v9
    v_accvgpr_write_b32 a14, v6
    v_accvgpr_write_b32 a78, v10
    v_accvgpr_write_b32 a15, v7
    v_accvgpr_write_b32 a79, v11
    s_mov_b32 s60, 1146880
    buffer_load_dword v144, v2, s[40:43], s60 offen
    s_mov_b32 s60, 1150464
    buffer_load_dword v145, v2, s[40:43], s60 offen
    s_mov_b32 s60, 1154048
    buffer_load_dword v146, v2, s[40:43], s60 offen
    s_mov_b32 s60, 1157632
    buffer_load_dword v147, v2, s[40:43], s60 offen
    s_mov_b32 s60, 1161216
    buffer_load_dword v148, v2, s[40:43], s60 offen
    s_mov_b32 s60, 1164800
    buffer_load_dword v149, v2, s[40:43], s60 offen
    s_mov_b32 s60, 1168384
    buffer_load_dword v150, v2, s[40:43], s60 offen
    s_mov_b32 s60, 1171968
    buffer_load_dword v151, v2, s[40:43], s60 offen
    s_waitcnt vmcnt(48)
    v_perm_b32 v4, v161, v160, s56
    v_perm_b32 v8, v161, v160, s57
    v_perm_b32 v5, v163, v162, s56
    v_perm_b32 v9, v163, v162, s57
    v_perm_b32 v6, v165, v164, s56
    v_perm_b32 v10, v165, v164, s57
    v_perm_b32 v7, v167, v166, s56
    v_perm_b32 v11, v167, v166, s57
    v_accvgpr_write_b32 a16, v4
    v_accvgpr_write_b32 a80, v8
    v_accvgpr_write_b32 a17, v5
    v_accvgpr_write_b32 a81, v9
    v_accvgpr_write_b32 a18, v6
    v_accvgpr_write_b32 a82, v10
    v_accvgpr_write_b32 a19, v7
    v_accvgpr_write_b32 a83, v11
    s_mov_b32 s60, 1261568
    buffer_load_dword v152, v2, s[40:43], s60 offen
    s_mov_b32 s60, 1265152
    buffer_load_dword v153, v2, s[40:43], s60 offen
    s_mov_b32 s60, 1268736
    buffer_load_dword v154, v2, s[40:43], s60 offen
    s_mov_b32 s60, 1272320
    buffer_load_dword v155, v2, s[40:43], s60 offen
    s_mov_b32 s60, 1275904
    buffer_load_dword v156, v2, s[40:43], s60 offen
    s_mov_b32 s60, 1279488
    buffer_load_dword v157, v2, s[40:43], s60 offen
    s_mov_b32 s60, 1283072
    buffer_load_dword v158, v2, s[40:43], s60 offen
    s_mov_b32 s60, 1286656
    buffer_load_dword v159, v2, s[40:43], s60 offen
    s_waitcnt vmcnt(48)
    v_perm_b32 v4, v169, v168, s56
    v_perm_b32 v8, v169, v168, s57
    v_perm_b32 v5, v171, v170, s56
    v_perm_b32 v9, v171, v170, s57
    v_perm_b32 v6, v173, v172, s56
    v_perm_b32 v10, v173, v172, s57
    v_perm_b32 v7, v175, v174, s56
    v_perm_b32 v11, v175, v174, s57
    v_accvgpr_write_b32 a20, v4
    v_accvgpr_write_b32 a84, v8
    v_accvgpr_write_b32 a21, v5
    v_accvgpr_write_b32 a85, v9
    v_accvgpr_write_b32 a22, v6
    v_accvgpr_write_b32 a86, v10
    v_accvgpr_write_b32 a23, v7
    v_accvgpr_write_b32 a87, v11
    s_mov_b32 s60, 1376256
    buffer_load_dword v160, v2, s[40:43], s60 offen
    s_mov_b32 s60, 1379840
    buffer_load_dword v161, v2, s[40:43], s60 offen
    s_mov_b32 s60, 1383424
    buffer_load_dword v162, v2, s[40:43], s60 offen
    s_mov_b32 s60, 1387008
    buffer_load_dword v163, v2, s[40:43], s60 offen
    s_mov_b32 s60, 1390592
    buffer_load_dword v164, v2, s[40:43], s60 offen
    s_mov_b32 s60, 1394176
    buffer_load_dword v165, v2, s[40:43], s60 offen
    s_mov_b32 s60, 1397760
    buffer_load_dword v166, v2, s[40:43], s60 offen
    s_mov_b32 s60, 1401344
    buffer_load_dword v167, v2, s[40:43], s60 offen
    s_waitcnt vmcnt(48)
    v_perm_b32 v4, v177, v176, s56
    v_perm_b32 v8, v177, v176, s57
    v_perm_b32 v5, v179, v178, s56
    v_perm_b32 v9, v179, v178, s57
    v_perm_b32 v6, v181, v180, s56
    v_perm_b32 v10, v181, v180, s57
    v_perm_b32 v7, v183, v182, s56
    v_perm_b32 v11, v183, v182, s57
    v_accvgpr_write_b32 a24, v4
    v_accvgpr_write_b32 a88, v8
    v_accvgpr_write_b32 a25, v5
    v_accvgpr_write_b32 a89, v9
    v_accvgpr_write_b32 a26, v6
    v_accvgpr_write_b32 a90, v10
    v_accvgpr_write_b32 a27, v7
    v_accvgpr_write_b32 a91, v11
    s_mov_b32 s60, 1490944
    buffer_load_dword v168, v2, s[40:43], s60 offen
    s_mov_b32 s60, 1494528
    buffer_load_dword v169, v2, s[40:43], s60 offen
    s_mov_b32 s60, 1498112
    buffer_load_dword v170, v2, s[40:43], s60 offen
    s_mov_b32 s60, 1501696
    buffer_load_dword v171, v2, s[40:43], s60 offen
    s_mov_b32 s60, 1505280
    buffer_load_dword v172, v2, s[40:43], s60 offen
    s_mov_b32 s60, 1508864
    buffer_load_dword v173, v2, s[40:43], s60 offen
    s_mov_b32 s60, 1512448
    buffer_load_dword v174, v2, s[40:43], s60 offen
    s_mov_b32 s60, 1516032
    buffer_load_dword v175, v2, s[40:43], s60 offen
    s_waitcnt vmcnt(48)
    v_perm_b32 v4, v185, v184, s56
    v_perm_b32 v8, v185, v184, s57
    v_perm_b32 v5, v187, v186, s56
    v_perm_b32 v9, v187, v186, s57
    v_perm_b32 v6, v189, v188, s56
    v_perm_b32 v10, v189, v188, s57
    v_perm_b32 v7, v191, v190, s56
    v_perm_b32 v11, v191, v190, s57
    v_accvgpr_write_b32 a28, v4
    v_accvgpr_write_b32 a92, v8
    v_accvgpr_write_b32 a29, v5
    v_accvgpr_write_b32 a93, v9
    v_accvgpr_write_b32 a30, v6
    v_accvgpr_write_b32 a94, v10
    v_accvgpr_write_b32 a31, v7
    v_accvgpr_write_b32 a95, v11
    s_mov_b32 s60, 1605632
    buffer_load_dword v176, v2, s[40:43], s60 offen
    s_mov_b32 s60, 1609216
    buffer_load_dword v177, v2, s[40:43], s60 offen
    s_mov_b32 s60, 1612800
    buffer_load_dword v178, v2, s[40:43], s60 offen
    s_mov_b32 s60, 1616384
    buffer_load_dword v179, v2, s[40:43], s60 offen
    s_mov_b32 s60, 1619968
    buffer_load_dword v180, v2, s[40:43], s60 offen
    s_mov_b32 s60, 1623552
    buffer_load_dword v181, v2, s[40:43], s60 offen
    s_mov_b32 s60, 1627136
    buffer_load_dword v182, v2, s[40:43], s60 offen
    s_mov_b32 s60, 1630720
    buffer_load_dword v183, v2, s[40:43], s60 offen
    s_waitcnt vmcnt(48)
    v_perm_b32 v4, v129, v128, s56
    v_perm_b32 v8, v129, v128, s57
    v_perm_b32 v5, v131, v130, s56
    v_perm_b32 v9, v131, v130, s57
    v_perm_b32 v6, v133, v132, s56
    v_perm_b32 v10, v133, v132, s57
    v_perm_b32 v7, v135, v134, s56
    v_perm_b32 v11, v135, v134, s57
    v_accvgpr_write_b32 a32, v4
    v_accvgpr_write_b32 a96, v8
    v_accvgpr_write_b32 a33, v5
    v_accvgpr_write_b32 a97, v9
    v_accvgpr_write_b32 a34, v6
    v_accvgpr_write_b32 a98, v10
    v_accvgpr_write_b32 a35, v7
    v_accvgpr_write_b32 a99, v11
    s_mov_b32 s60, 1720320
    buffer_load_dword v184, v2, s[40:43], s60 offen
    s_mov_b32 s60, 1723904
    buffer_load_dword v185, v2, s[40:43], s60 offen
    s_mov_b32 s60, 1727488
    buffer_load_dword v186, v2, s[40:43], s60 offen
    s_mov_b32 s60, 1731072
    buffer_load_dword v187, v2, s[40:43], s60 offen
    s_mov_b32 s60, 1734656
    buffer_load_dword v188, v2, s[40:43], s60 offen
    s_mov_b32 s60, 1738240
    buffer_load_dword v189, v2, s[40:43], s60 offen
    s_mov_b32 s60, 1741824
    buffer_load_dword v190, v2, s[40:43], s60 offen
    s_mov_b32 s60, 1745408
    buffer_load_dword v191, v2, s[40:43], s60 offen
    s_waitcnt vmcnt(48)
    v_perm_b32 v4, v137, v136, s56
    v_perm_b32 v8, v137, v136, s57
    v_perm_b32 v5, v139, v138, s56
    v_perm_b32 v9, v139, v138, s57
    v_perm_b32 v6, v141, v140, s56
    v_perm_b32 v10, v141, v140, s57
    v_perm_b32 v7, v143, v142, s56
    v_perm_b32 v11, v143, v142, s57
    v_accvgpr_write_b32 a36, v4
    v_accvgpr_write_b32 a100, v8
    v_accvgpr_write_b32 a37, v5
    v_accvgpr_write_b32 a101, v9
    v_accvgpr_write_b32 a38, v6
    v_accvgpr_write_b32 a102, v10
    v_accvgpr_write_b32 a39, v7
    v_accvgpr_write_b32 a103, v11
    s_mov_b32 s60, 0
    buffer_load_dword v128, v3, s[44:47], s60 offen
    s_mov_b32 s60, 3584
    buffer_load_dword v129, v3, s[44:47], s60 offen
    s_mov_b32 s60, 7168
    buffer_load_dword v130, v3, s[44:47], s60 offen
    s_mov_b32 s60, 10752
    buffer_load_dword v131, v3, s[44:47], s60 offen
    s_mov_b32 s60, 14336
    buffer_load_dword v132, v3, s[44:47], s60 offen
    s_mov_b32 s60, 17920
    buffer_load_dword v133, v3, s[44:47], s60 offen
    s_mov_b32 s60, 21504
    buffer_load_dword v134, v3, s[44:47], s60 offen
    s_mov_b32 s60, 25088
    buffer_load_dword v135, v3, s[44:47], s60 offen
    s_waitcnt vmcnt(48)
    v_perm_b32 v4, v145, v144, s56
    v_perm_b32 v8, v145, v144, s57
    v_perm_b32 v5, v147, v146, s56
    v_perm_b32 v9, v147, v146, s57
    v_perm_b32 v6, v149, v148, s56
    v_perm_b32 v10, v149, v148, s57
    v_perm_b32 v7, v151, v150, s56
    v_perm_b32 v11, v151, v150, s57
    v_accvgpr_write_b32 a40, v4
    v_accvgpr_write_b32 a104, v8
    v_accvgpr_write_b32 a41, v5
    v_accvgpr_write_b32 a105, v9
    v_accvgpr_write_b32 a42, v6
    v_accvgpr_write_b32 a106, v10
    v_accvgpr_write_b32 a43, v7
    v_accvgpr_write_b32 a107, v11
    s_mov_b32 s60, 114688
    buffer_load_dword v136, v3, s[44:47], s60 offen
    s_mov_b32 s60, 118272
    buffer_load_dword v137, v3, s[44:47], s60 offen
    s_mov_b32 s60, 121856
    buffer_load_dword v138, v3, s[44:47], s60 offen
    s_mov_b32 s60, 125440
    buffer_load_dword v139, v3, s[44:47], s60 offen
    s_mov_b32 s60, 129024
    buffer_load_dword v140, v3, s[44:47], s60 offen
    s_mov_b32 s60, 132608
    buffer_load_dword v141, v3, s[44:47], s60 offen
    s_mov_b32 s60, 136192
    buffer_load_dword v142, v3, s[44:47], s60 offen
    s_mov_b32 s60, 139776
    buffer_load_dword v143, v3, s[44:47], s60 offen
    s_waitcnt vmcnt(48)
    v_perm_b32 v4, v153, v152, s56
    v_perm_b32 v8, v153, v152, s57
    v_perm_b32 v5, v155, v154, s56
    v_perm_b32 v9, v155, v154, s57
    v_perm_b32 v6, v157, v156, s56
    v_perm_b32 v10, v157, v156, s57
    v_perm_b32 v7, v159, v158, s56
    v_perm_b32 v11, v159, v158, s57
    v_accvgpr_write_b32 a44, v4
    v_accvgpr_write_b32 a108, v8
    v_accvgpr_write_b32 a45, v5
    v_accvgpr_write_b32 a109, v9
    v_accvgpr_write_b32 a46, v6
    v_accvgpr_write_b32 a110, v10
    v_accvgpr_write_b32 a47, v7
    v_accvgpr_write_b32 a111, v11
    s_mov_b32 s60, 229376
    buffer_load_dword v144, v3, s[44:47], s60 offen
    s_mov_b32 s60, 232960
    buffer_load_dword v145, v3, s[44:47], s60 offen
    s_mov_b32 s60, 236544
    buffer_load_dword v146, v3, s[44:47], s60 offen
    s_mov_b32 s60, 240128
    buffer_load_dword v147, v3, s[44:47], s60 offen
    s_mov_b32 s60, 243712
    buffer_load_dword v148, v3, s[44:47], s60 offen
    s_mov_b32 s60, 247296
    buffer_load_dword v149, v3, s[44:47], s60 offen
    s_mov_b32 s60, 250880
    buffer_load_dword v150, v3, s[44:47], s60 offen
    s_mov_b32 s60, 254464
    buffer_load_dword v151, v3, s[44:47], s60 offen
    s_waitcnt vmcnt(48)
    v_perm_b32 v4, v161, v160, s56
    v_perm_b32 v8, v161, v160, s57
    v_perm_b32 v5, v163, v162, s56
    v_perm_b32 v9, v163, v162, s57
    v_perm_b32 v6, v165, v164, s56
    v_perm_b32 v10, v165, v164, s57
    v_perm_b32 v7, v167, v166, s56
    v_perm_b32 v11, v167, v166, s57
    v_accvgpr_write_b32 a48, v4
    v_accvgpr_write_b32 a112, v8
    v_accvgpr_write_b32 a49, v5
    v_accvgpr_write_b32 a113, v9
    v_accvgpr_write_b32 a50, v6
    v_accvgpr_write_b32 a114, v10
    v_accvgpr_write_b32 a51, v7
    v_accvgpr_write_b32 a115, v11
    s_mov_b32 s60, 344064
    buffer_load_dword v152, v3, s[44:47], s60 offen
    s_mov_b32 s60, 347648
    buffer_load_dword v153, v3, s[44:47], s60 offen
    s_mov_b32 s60, 351232
    buffer_load_dword v154, v3, s[44:47], s60 offen
    s_mov_b32 s60, 354816
    buffer_load_dword v155, v3, s[44:47], s60 offen
    s_mov_b32 s60, 358400
    buffer_load_dword v156, v3, s[44:47], s60 offen
    s_mov_b32 s60, 361984
    buffer_load_dword v157, v3, s[44:47], s60 offen
    s_mov_b32 s60, 365568
    buffer_load_dword v158, v3, s[44:47], s60 offen
    s_mov_b32 s60, 369152
    buffer_load_dword v159, v3, s[44:47], s60 offen
    s_waitcnt vmcnt(48)
    v_perm_b32 v4, v169, v168, s56
    v_perm_b32 v8, v169, v168, s57
    v_perm_b32 v5, v171, v170, s56
    v_perm_b32 v9, v171, v170, s57
    v_perm_b32 v6, v173, v172, s56
    v_perm_b32 v10, v173, v172, s57
    v_perm_b32 v7, v175, v174, s56
    v_perm_b32 v11, v175, v174, s57
    v_accvgpr_write_b32 a52, v4
    v_accvgpr_write_b32 a116, v8
    v_accvgpr_write_b32 a53, v5
    v_accvgpr_write_b32 a117, v9
    v_accvgpr_write_b32 a54, v6
    v_accvgpr_write_b32 a118, v10
    v_accvgpr_write_b32 a55, v7
    v_accvgpr_write_b32 a119, v11
    s_mov_b32 s60, 458752
    buffer_load_dword v160, v3, s[44:47], s60 offen
    s_mov_b32 s60, 462336
    buffer_load_dword v161, v3, s[44:47], s60 offen
    s_mov_b32 s60, 465920
    buffer_load_dword v162, v3, s[44:47], s60 offen
    s_mov_b32 s60, 469504
    buffer_load_dword v163, v3, s[44:47], s60 offen
    s_mov_b32 s60, 473088
    buffer_load_dword v164, v3, s[44:47], s60 offen
    s_mov_b32 s60, 476672
    buffer_load_dword v165, v3, s[44:47], s60 offen
    s_mov_b32 s60, 480256
    buffer_load_dword v166, v3, s[44:47], s60 offen
    s_mov_b32 s60, 483840
    buffer_load_dword v167, v3, s[44:47], s60 offen
    s_waitcnt vmcnt(48)
    v_perm_b32 v4, v177, v176, s56
    v_perm_b32 v8, v177, v176, s57
    v_perm_b32 v5, v179, v178, s56
    v_perm_b32 v9, v179, v178, s57
    v_perm_b32 v6, v181, v180, s56
    v_perm_b32 v10, v181, v180, s57
    v_perm_b32 v7, v183, v182, s56
    v_perm_b32 v11, v183, v182, s57
    v_accvgpr_write_b32 a56, v4
    v_accvgpr_write_b32 a120, v8
    v_accvgpr_write_b32 a57, v5
    v_accvgpr_write_b32 a121, v9
    v_accvgpr_write_b32 a58, v6
    v_accvgpr_write_b32 a122, v10
    v_accvgpr_write_b32 a59, v7
    v_accvgpr_write_b32 a123, v11
    s_mov_b32 s60, 573440
    buffer_load_dword v168, v3, s[44:47], s60 offen
    s_mov_b32 s60, 577024
    buffer_load_dword v169, v3, s[44:47], s60 offen
    s_mov_b32 s60, 580608
    buffer_load_dword v170, v3, s[44:47], s60 offen
    s_mov_b32 s60, 584192
    buffer_load_dword v171, v3, s[44:47], s60 offen
    s_mov_b32 s60, 587776
    buffer_load_dword v172, v3, s[44:47], s60 offen
    s_mov_b32 s60, 591360
    buffer_load_dword v173, v3, s[44:47], s60 offen
    s_mov_b32 s60, 594944
    buffer_load_dword v174, v3, s[44:47], s60 offen
    s_mov_b32 s60, 598528
    buffer_load_dword v175, v3, s[44:47], s60 offen
    s_waitcnt vmcnt(48)
    v_perm_b32 v4, v185, v184, s56
    v_perm_b32 v8, v185, v184, s57
    v_perm_b32 v5, v187, v186, s56
    v_perm_b32 v9, v187, v186, s57
    v_perm_b32 v6, v189, v188, s56
    v_perm_b32 v10, v189, v188, s57
    v_perm_b32 v7, v191, v190, s56
    v_perm_b32 v11, v191, v190, s57
    v_accvgpr_write_b32 a60, v4
    v_accvgpr_write_b32 a124, v8
    v_accvgpr_write_b32 a61, v5
    v_accvgpr_write_b32 a125, v9
    v_accvgpr_write_b32 a62, v6
    v_accvgpr_write_b32 a126, v10
    v_accvgpr_write_b32 a63, v7
    v_accvgpr_write_b32 a127, v11
    s_mov_b32 s60, 688128
    buffer_load_dword v176, v3, s[44:47], s60 offen
    s_mov_b32 s60, 691712
    buffer_load_dword v177, v3, s[44:47], s60 offen
    s_mov_b32 s60, 695296
    buffer_load_dword v178, v3, s[44:47], s60 offen
    s_mov_b32 s60, 698880
    buffer_load_dword v179, v3, s[44:47], s60 offen
    s_mov_b32 s60, 702464
    buffer_load_dword v180, v3, s[44:47], s60 offen
    s_mov_b32 s60, 706048
    buffer_load_dword v181, v3, s[44:47], s60 offen
    s_mov_b32 s60, 709632
    buffer_load_dword v182, v3, s[44:47], s60 offen
    s_mov_b32 s60, 713216
    buffer_load_dword v183, v3, s[44:47], s60 offen
    s_waitcnt vmcnt(48)
    v_perm_b32 v4, v129, v128, s56
    v_perm_b32 v8, v129, v128, s57
    v_perm_b32 v5, v131, v130, s56
    v_perm_b32 v9, v131, v130, s57
    v_perm_b32 v6, v133, v132, s56
    v_perm_b32 v10, v133, v132, s57
    v_perm_b32 v7, v135, v134, s56
    v_perm_b32 v11, v135, v134, s57
    v_accvgpr_write_b32 a128, v4
    v_accvgpr_write_b32 a192, v8
    v_accvgpr_write_b32 a129, v5
    v_accvgpr_write_b32 a193, v9
    v_accvgpr_write_b32 a130, v6
    v_accvgpr_write_b32 a194, v10
    v_accvgpr_write_b32 a131, v7
    v_accvgpr_write_b32 a195, v11
    s_mov_b32 s60, 802816
    buffer_load_dword v184, v3, s[44:47], s60 offen
    s_mov_b32 s60, 806400
    buffer_load_dword v185, v3, s[44:47], s60 offen
    s_mov_b32 s60, 809984
    buffer_load_dword v186, v3, s[44:47], s60 offen
    s_mov_b32 s60, 813568
    buffer_load_dword v187, v3, s[44:47], s60 offen
    s_mov_b32 s60, 817152
    buffer_load_dword v188, v3, s[44:47], s60 offen
    s_mov_b32 s60, 820736
    buffer_load_dword v189, v3, s[44:47], s60 offen
    s_mov_b32 s60, 824320
    buffer_load_dword v190, v3, s[44:47], s60 offen
    s_mov_b32 s60, 827904
    buffer_load_dword v191, v3, s[44:47], s60 offen
    s_waitcnt vmcnt(48)
    v_perm_b32 v4, v137, v136, s56
    v_perm_b32 v8, v137, v136, s57
    v_perm_b32 v5, v139, v138, s56
    v_perm_b32 v9, v139, v138, s57
    v_perm_b32 v6, v141, v140, s56
    v_perm_b32 v10, v141, v140, s57
    v_perm_b32 v7, v143, v142, s56
    v_perm_b32 v11, v143, v142, s57
    v_accvgpr_write_b32 a132, v4
    v_accvgpr_write_b32 a196, v8
    v_accvgpr_write_b32 a133, v5
    v_accvgpr_write_b32 a197, v9
    v_accvgpr_write_b32 a134, v6
    v_accvgpr_write_b32 a198, v10
    v_accvgpr_write_b32 a135, v7
    v_accvgpr_write_b32 a199, v11
    s_mov_b32 s60, 917504
    buffer_load_dword v128, v3, s[44:47], s60 offen
    s_mov_b32 s60, 921088
    buffer_load_dword v129, v3, s[44:47], s60 offen
    s_mov_b32 s60, 924672
    buffer_load_dword v130, v3, s[44:47], s60 offen
    s_mov_b32 s60, 928256
    buffer_load_dword v131, v3, s[44:47], s60 offen
    s_mov_b32 s60, 931840
    buffer_load_dword v132, v3, s[44:47], s60 offen
    s_mov_b32 s60, 935424
    buffer_load_dword v133, v3, s[44:47], s60 offen
    s_mov_b32 s60, 939008
    buffer_load_dword v134, v3, s[44:47], s60 offen
    s_mov_b32 s60, 942592
    buffer_load_dword v135, v3, s[44:47], s60 offen
    s_waitcnt vmcnt(48)
    v_perm_b32 v4, v145, v144, s56
    v_perm_b32 v8, v145, v144, s57
    v_perm_b32 v5, v147, v146, s56
    v_perm_b32 v9, v147, v146, s57
    v_perm_b32 v6, v149, v148, s56
    v_perm_b32 v10, v149, v148, s57
    v_perm_b32 v7, v151, v150, s56
    v_perm_b32 v11, v151, v150, s57
    v_accvgpr_write_b32 a136, v4
    v_accvgpr_write_b32 a200, v8
    v_accvgpr_write_b32 a137, v5
    v_accvgpr_write_b32 a201, v9
    v_accvgpr_write_b32 a138, v6
    v_accvgpr_write_b32 a202, v10
    v_accvgpr_write_b32 a139, v7
    v_accvgpr_write_b32 a203, v11
    s_mov_b32 s60, 1032192
    buffer_load_dword v136, v3, s[44:47], s60 offen
    s_mov_b32 s60, 1035776
    buffer_load_dword v137, v3, s[44:47], s60 offen
    s_mov_b32 s60, 1039360
    buffer_load_dword v138, v3, s[44:47], s60 offen
    s_mov_b32 s60, 1042944
    buffer_load_dword v139, v3, s[44:47], s60 offen
    s_mov_b32 s60, 1046528
    buffer_load_dword v140, v3, s[44:47], s60 offen
    s_mov_b32 s60, 1050112
    buffer_load_dword v141, v3, s[44:47], s60 offen
    s_mov_b32 s60, 1053696
    buffer_load_dword v142, v3, s[44:47], s60 offen
    s_mov_b32 s60, 1057280
    buffer_load_dword v143, v3, s[44:47], s60 offen
    s_waitcnt vmcnt(48)
    v_perm_b32 v4, v153, v152, s56
    v_perm_b32 v8, v153, v152, s57
    v_perm_b32 v5, v155, v154, s56
    v_perm_b32 v9, v155, v154, s57
    v_perm_b32 v6, v157, v156, s56
    v_perm_b32 v10, v157, v156, s57
    v_perm_b32 v7, v159, v158, s56
    v_perm_b32 v11, v159, v158, s57
    v_accvgpr_write_b32 a140, v4
    v_accvgpr_write_b32 a204, v8
    v_accvgpr_write_b32 a141, v5
    v_accvgpr_write_b32 a205, v9
    v_accvgpr_write_b32 a142, v6
    v_accvgpr_write_b32 a206, v10
    v_accvgpr_write_b32 a143, v7
    v_accvgpr_write_b32 a207, v11
    s_mov_b32 s60, 1146880
    buffer_load_dword v144, v3, s[44:47], s60 offen
    s_mov_b32 s60, 1150464
    buffer_load_dword v145, v3, s[44:47], s60 offen
    s_mov_b32 s60, 1154048
    buffer_load_dword v146, v3, s[44:47], s60 offen
    s_mov_b32 s60, 1157632
    buffer_load_dword v147, v3, s[44:47], s60 offen
    s_mov_b32 s60, 1161216
    buffer_load_dword v148, v3, s[44:47], s60 offen
    s_mov_b32 s60, 1164800
    buffer_load_dword v149, v3, s[44:47], s60 offen
    s_mov_b32 s60, 1168384
    buffer_load_dword v150, v3, s[44:47], s60 offen
    s_mov_b32 s60, 1171968
    buffer_load_dword v151, v3, s[44:47], s60 offen
    s_waitcnt vmcnt(48)
    v_perm_b32 v4, v161, v160, s56
    v_perm_b32 v8, v161, v160, s57
    v_perm_b32 v5, v163, v162, s56
    v_perm_b32 v9, v163, v162, s57
    v_perm_b32 v6, v165, v164, s56
    v_perm_b32 v10, v165, v164, s57
    v_perm_b32 v7, v167, v166, s56
    v_perm_b32 v11, v167, v166, s57
    v_accvgpr_write_b32 a144, v4
    v_accvgpr_write_b32 a208, v8
    v_accvgpr_write_b32 a145, v5
    v_accvgpr_write_b32 a209, v9
    v_accvgpr_write_b32 a146, v6
    v_accvgpr_write_b32 a210, v10
    v_accvgpr_write_b32 a147, v7
    v_accvgpr_write_b32 a211, v11
    s_mov_b32 s60, 1261568
    buffer_load_dword v152, v3, s[44:47], s60 offen
    s_mov_b32 s60, 1265152
    buffer_load_dword v153, v3, s[44:47], s60 offen
    s_mov_b32 s60, 1268736
    buffer_load_dword v154, v3, s[44:47], s60 offen
    s_mov_b32 s60, 1272320
    buffer_load_dword v155, v3, s[44:47], s60 offen
    s_mov_b32 s60, 1275904
    buffer_load_dword v156, v3, s[44:47], s60 offen
    s_mov_b32 s60, 1279488
    buffer_load_dword v157, v3, s[44:47], s60 offen
    s_mov_b32 s60, 1283072
    buffer_load_dword v158, v3, s[44:47], s60 offen
    s_mov_b32 s60, 1286656
    buffer_load_dword v159, v3, s[44:47], s60 offen
    s_waitcnt vmcnt(48)
    v_perm_b32 v4, v169, v168, s56
    v_perm_b32 v8, v169, v168, s57
    v_perm_b32 v5, v171, v170, s56
    v_perm_b32 v9, v171, v170, s57
    v_perm_b32 v6, v173, v172, s56
    v_perm_b32 v10, v173, v172, s57
    v_perm_b32 v7, v175, v174, s56
    v_perm_b32 v11, v175, v174, s57
    v_accvgpr_write_b32 a148, v4
    v_accvgpr_write_b32 a212, v8
    v_accvgpr_write_b32 a149, v5
    v_accvgpr_write_b32 a213, v9
    v_accvgpr_write_b32 a150, v6
    v_accvgpr_write_b32 a214, v10
    v_accvgpr_write_b32 a151, v7
    v_accvgpr_write_b32 a215, v11
    s_mov_b32 s60, 1376256
    buffer_load_dword v160, v3, s[44:47], s60 offen
    s_mov_b32 s60, 1379840
    buffer_load_dword v161, v3, s[44:47], s60 offen
    s_mov_b32 s60, 1383424
    buffer_load_dword v162, v3, s[44:47], s60 offen
    s_mov_b32 s60, 1387008
    buffer_load_dword v163, v3, s[44:47], s60 offen
    s_mov_b32 s60, 1390592
    buffer_load_dword v164, v3, s[44:47], s60 offen
    s_mov_b32 s60, 1394176
    buffer_load_dword v165, v3, s[44:47], s60 offen
    s_mov_b32 s60, 1397760
    buffer_load_dword v166, v3, s[44:47], s60 offen
    s_mov_b32 s60, 1401344
    buffer_load_dword v167, v3, s[44:47], s60 offen
    s_waitcnt vmcnt(48)
    v_perm_b32 v4, v177, v176, s56
    v_perm_b32 v8, v177, v176, s57
    v_perm_b32 v5, v179, v178, s56
    v_perm_b32 v9, v179, v178, s57
    v_perm_b32 v6, v181, v180, s56
    v_perm_b32 v10, v181, v180, s57
    v_perm_b32 v7, v183, v182, s56
    v_perm_b32 v11, v183, v182, s57
    v_accvgpr_write_b32 a152, v4
    v_accvgpr_write_b32 a216, v8
    v_accvgpr_write_b32 a153, v5
    v_accvgpr_write_b32 a217, v9
    v_accvgpr_write_b32 a154, v6
    v_accvgpr_write_b32 a218, v10
    v_accvgpr_write_b32 a155, v7
    v_accvgpr_write_b32 a219, v11
    s_mov_b32 s60, 1490944
    buffer_load_dword v168, v3, s[44:47], s60 offen
    s_mov_b32 s60, 1494528
    buffer_load_dword v169, v3, s[44:47], s60 offen
    s_mov_b32 s60, 1498112
    buffer_load_dword v170, v3, s[44:47], s60 offen
    s_mov_b32 s60, 1501696
    buffer_load_dword v171, v3, s[44:47], s60 offen
    s_mov_b32 s60, 1505280
    buffer_load_dword v172, v3, s[44:47], s60 offen
    s_mov_b32 s60, 1508864
    buffer_load_dword v173, v3, s[44:47], s60 offen
    s_mov_b32 s60, 1512448
    buffer_load_dword v174, v3, s[44:47], s60 offen
    s_mov_b32 s60, 1516032
    buffer_load_dword v175, v3, s[44:47], s60 offen
    s_waitcnt vmcnt(48)
    v_perm_b32 v4, v185, v184, s56
    v_perm_b32 v8, v185, v184, s57
    v_perm_b32 v5, v187, v186, s56
    v_perm_b32 v9, v187, v186, s57
    v_perm_b32 v6, v189, v188, s56
    v_perm_b32 v10, v189, v188, s57
    v_perm_b32 v7, v191, v190, s56
    v_perm_b32 v11, v191, v190, s57
    v_accvgpr_write_b32 a156, v4
    v_accvgpr_write_b32 a220, v8
    v_accvgpr_write_b32 a157, v5
    v_accvgpr_write_b32 a221, v9
    v_accvgpr_write_b32 a158, v6
    v_accvgpr_write_b32 a222, v10
    v_accvgpr_write_b32 a159, v7
    v_accvgpr_write_b32 a223, v11
    s_mov_b32 s60, 1605632
    buffer_load_dword v176, v3, s[44:47], s60 offen
    s_mov_b32 s60, 1609216
    buffer_load_dword v177, v3, s[44:47], s60 offen
    s_mov_b32 s60, 1612800
    buffer_load_dword v178, v3, s[44:47], s60 offen
    s_mov_b32 s60, 1616384
    buffer_load_dword v179, v3, s[44:47], s60 offen
    s_mov_b32 s60, 1619968
    buffer_load_dword v180, v3, s[44:47], s60 offen
    s_mov_b32 s60, 1623552
    buffer_load_dword v181, v3, s[44:47], s60 offen
    s_mov_b32 s60, 1627136
    buffer_load_dword v182, v3, s[44:47], s60 offen
    s_mov_b32 s60, 1630720
    buffer_load_dword v183, v3, s[44:47], s60 offen
    s_waitcnt vmcnt(48)
    v_perm_b32 v4, v129, v128, s56
    v_perm_b32 v8, v129, v128, s57
    v_perm_b32 v5, v131, v130, s56
    v_perm_b32 v9, v131, v130, s57
    v_perm_b32 v6, v133, v132, s56
    v_perm_b32 v10, v133, v132, s57
    v_perm_b32 v7, v135, v134, s56
    v_perm_b32 v11, v135, v134, s57
    v_accvgpr_write_b32 a160, v4
    v_accvgpr_write_b32 a224, v8
    v_accvgpr_write_b32 a161, v5
    v_accvgpr_write_b32 a225, v9
    v_accvgpr_write_b32 a162, v6
    v_accvgpr_write_b32 a226, v10
    v_accvgpr_write_b32 a163, v7
    v_accvgpr_write_b32 a227, v11
    s_mov_b32 s60, 1720320
    buffer_load_dword v184, v3, s[44:47], s60 offen
    s_mov_b32 s60, 1723904
    buffer_load_dword v185, v3, s[44:47], s60 offen
    s_mov_b32 s60, 1727488
    buffer_load_dword v186, v3, s[44:47], s60 offen
    s_mov_b32 s60, 1731072
    buffer_load_dword v187, v3, s[44:47], s60 offen
    s_mov_b32 s60, 1734656
    buffer_load_dword v188, v3, s[44:47], s60 offen
    s_mov_b32 s60, 1738240
    buffer_load_dword v189, v3, s[44:47], s60 offen
    s_mov_b32 s60, 1741824
    buffer_load_dword v190, v3, s[44:47], s60 offen
    s_mov_b32 s60, 1745408
    buffer_load_dword v191, v3, s[44:47], s60 offen
    s_waitcnt vmcnt(48)
    v_perm_b32 v4, v137, v136, s56
    v_perm_b32 v8, v137, v136, s57
    v_perm_b32 v5, v139, v138, s56
    v_perm_b32 v9, v139, v138, s57
    v_perm_b32 v6, v141, v140, s56
    v_perm_b32 v10, v141, v140, s57
    v_perm_b32 v7, v143, v142, s56
    v_perm_b32 v11, v143, v142, s57
    v_accvgpr_write_b32 a164, v4
    v_accvgpr_write_b32 a228, v8
    v_accvgpr_write_b32 a165, v5
    v_accvgpr_write_b32 a229, v9
    v_accvgpr_write_b32 a166, v6
    v_accvgpr_write_b32 a230, v10
    v_accvgpr_write_b32 a167, v7
    v_accvgpr_write_b32 a231, v11
    s_waitcnt vmcnt(40)
    v_perm_b32 v4, v145, v144, s56
    v_perm_b32 v8, v145, v144, s57
    v_perm_b32 v5, v147, v146, s56
    v_perm_b32 v9, v147, v146, s57
    v_perm_b32 v6, v149, v148, s56
    v_perm_b32 v10, v149, v148, s57
    v_perm_b32 v7, v151, v150, s56
    v_perm_b32 v11, v151, v150, s57
    v_accvgpr_write_b32 a168, v4
    v_accvgpr_write_b32 a232, v8
    v_accvgpr_write_b32 a169, v5
    v_accvgpr_write_b32 a233, v9
    v_accvgpr_write_b32 a170, v6
    v_accvgpr_write_b32 a234, v10
    v_accvgpr_write_b32 a171, v7
    v_accvgpr_write_b32 a235, v11
    s_waitcnt vmcnt(32)
    v_perm_b32 v4, v153, v152, s56
    v_perm_b32 v8, v153, v152, s57
    v_perm_b32 v5, v155, v154, s56
    v_perm_b32 v9, v155, v154, s57
    v_perm_b32 v6, v157, v156, s56
    v_perm_b32 v10, v157, v156, s57
    v_perm_b32 v7, v159, v158, s56
    v_perm_b32 v11, v159, v158, s57
    v_accvgpr_write_b32 a172, v4
    v_accvgpr_write_b32 a236, v8
    v_accvgpr_write_b32 a173, v5
    v_accvgpr_write_b32 a237, v9
    v_accvgpr_write_b32 a174, v6
    v_accvgpr_write_b32 a238, v10
    v_accvgpr_write_b32 a175, v7
    v_accvgpr_write_b32 a239, v11
    s_waitcnt vmcnt(24)
    v_perm_b32 v4, v161, v160, s56
    v_perm_b32 v8, v161, v160, s57
    v_perm_b32 v5, v163, v162, s56
    v_perm_b32 v9, v163, v162, s57
    v_perm_b32 v6, v165, v164, s56
    v_perm_b32 v10, v165, v164, s57
    v_perm_b32 v7, v167, v166, s56
    v_perm_b32 v11, v167, v166, s57
    v_accvgpr_write_b32 a176, v4
    v_accvgpr_write_b32 a240, v8
    v_accvgpr_write_b32 a177, v5
    v_accvgpr_write_b32 a241, v9
    v_accvgpr_write_b32 a178, v6
    v_accvgpr_write_b32 a242, v10
    v_accvgpr_write_b32 a179, v7
    v_accvgpr_write_b32 a243, v11
    s_waitcnt vmcnt(16)
    v_perm_b32 v4, v169, v168, s56
    v_perm_b32 v8, v169, v168, s57
    v_perm_b32 v5, v171, v170, s56
    v_perm_b32 v9, v171, v170, s57
    v_perm_b32 v6, v173, v172, s56
    v_perm_b32 v10, v173, v172, s57
    v_perm_b32 v7, v175, v174, s56
    v_perm_b32 v11, v175, v174, s57
    v_accvgpr_write_b32 a180, v4
    v_accvgpr_write_b32 a244, v8
    v_accvgpr_write_b32 a181, v5
    v_accvgpr_write_b32 a245, v9
    v_accvgpr_write_b32 a182, v6
    v_accvgpr_write_b32 a246, v10
    v_accvgpr_write_b32 a183, v7
    v_accvgpr_write_b32 a247, v11
    s_waitcnt vmcnt(8)
    v_perm_b32 v4, v177, v176, s56
    v_perm_b32 v8, v177, v176, s57
    v_perm_b32 v5, v179, v178, s56
    v_perm_b32 v9, v179, v178, s57
    v_perm_b32 v6, v181, v180, s56
    v_perm_b32 v10, v181, v180, s57
    v_perm_b32 v7, v183, v182, s56
    v_perm_b32 v11, v183, v182, s57
    v_accvgpr_write_b32 a184, v4
    v_accvgpr_write_b32 a248, v8
    v_accvgpr_write_b32 a185, v5
    v_accvgpr_write_b32 a249, v9
    v_accvgpr_write_b32 a186, v6
    v_accvgpr_write_b32 a250, v10
    v_accvgpr_write_b32 a187, v7
    v_accvgpr_write_b32 a251, v11
    s_waitcnt vmcnt(0)
    v_perm_b32 v4, v185, v184, s56
    v_perm_b32 v8, v185, v184, s57
    v_perm_b32 v5, v187, v186, s56
    v_perm_b32 v9, v187, v186, s57
    v_perm_b32 v6, v189, v188, s56
    v_perm_b32 v10, v189, v188, s57
    v_perm_b32 v7, v191, v190, s56
    v_perm_b32 v11, v191, v190, s57
    v_accvgpr_write_b32 a188, v4
    v_accvgpr_write_b32 a252, v8
    v_accvgpr_write_b32 a189, v5
    v_accvgpr_write_b32 a253, v9
    v_accvgpr_write_b32 a190, v6
    v_accvgpr_write_b32 a254, v10
    v_accvgpr_write_b32 a191, v7
    v_accvgpr_write_b32 a255, v11
    s_barrier
    v_lshlrev_b32 v12, 4, v0
    s_mov_b32 s66, 0
    s_mov_b32 s68, -1
    s_mov_b32 s70, 0xbdd2d3e8
    v_mov_b32 v14, 0xc0135761
    s_lshl_b32 s60, s64, 15
    s_lshl_b32 s61, s3, 13
    s_add_u32 s60, s60, s61
    s_add_u32 s61, s61, s66
    s_mov_b32 m0, s61
    s_nop 0
    buffer_load_dwordx4 v12, s[36:39], s60 offen offset:0 lds
    buffer_load_dwordx4 v12, s[36:39], s60 offen offset:1024 lds
    buffer_load_dwordx4 v12, s[36:39], s60 offen offset:2048 lds
    buffer_load_dwordx4 v12, s[36:39], s60 offen offset:3072 lds
    s_add_u32 s60, s60, 4096
    s_add_u32 s61, s61, 4096
    s_mov_b32 m0, s61
    s_nop 0
    buffer_load_dwordx4 v12, s[36:39], s60 offen offset:0 lds
    buffer_load_dwordx4 v12, s[36:39], s60 offen offset:1024 lds
    buffer_load_dwordx4 v12, s[36:39], s60 offen offset:2048 lds
    buffer_load_dwordx4 v12, s[36:39], s60 offen offset:3072 lds
    s_waitcnt vmcnt(0)
G_29:
    s_barrier
    v_add_u32 v13, s66, v12
    ds_read_b128 v[64:67], v13 offset:0
    ds_read_b128 v[68:71], v13 offset:16384
    ds_read_b128 v[72:75], v13 offset:1024
    ds_read_b128 v[76:79], v13 offset:17408
    ds_read_b128 v[80:83], v13 offset:2048
    ds_read_b128 v[84:87], v13 offset:18432
    s_add_u32 s69, s64, 7
    s_xor_b32 s66, s66, 32768
    s_cmp_ge_u32 s69, 64
    s_cbranch_scc1 GN_31
    s_lshl_b32 s60, s69, 15
    s_lshl_b32 s61, s3, 13
    s_add_u32 s60, s60, s61
    s_add_u32 s61, s61, s66
    s_mov_b32 m0, s61
    s_nop 0
    buffer_load_dwordx4 v12, s[36:39], s60 offen offset:0 lds
    buffer_load_dwordx4 v12, s[36:39], s60 offen offset:1024 lds
    buffer_load_dwordx4 v12, s[36:39], s60 offen offset:2048 lds
    buffer_load_dwordx4 v12, s[36:39], s60 offen offset:3072 lds
    s_add_u32 s60, s60, 4096
    s_add_u32 s61, s61, 4096
    s_mov_b32 m0, s61
    s_nop 0
    buffer_load_dwordx4 v12, s[36:39], s60 offen offset:0 lds
    buffer_load_dwordx4 v12, s[36:39], s60 offen offset:1024 lds
    buffer_load_dwordx4 v12, s[36:39], s60 offen offset:2048 lds
    buffer_load_dwordx4 v12, s[36:39], s60 offen offset:3072 lds
GN_31:
    ds_read_b128 v[88:91], v13 offset:3072
    ds_read_b128 v[92:95], v13 offset:19456
    s_waitcnt lgkmcnt(6)
    v_mfma_f32_16x16x32_bf16 v[32:35], a[0:3], v[64:67], 0
    v_mfma_f32_16x16x32_bf16 v[48:51], a[0:3], v[68:71], 0
    v_mfma_f32_16x16x32_bf16 v[36:39], a[64:67], v[64:67], 0
    v_mfma_f32_16x16x32_bf16 v[52:55], a[64:67], v[68:71], 0
    v_mfma_f32_16x16x32_bf16 v[40:43], a[128:131], v[64:67], 0
    v_mfma_f32_16x16x32_bf16 v[56:59], a[128:131], v[68:71], 0
    v_mfma_f32_16x16x32_bf16 v[44:47], a[192:195], v[64:67], 0
    v_mfma_f32_16x16x32_bf16 v[60:63], a[192:195], v[68:71], 0
    ds_read_b128 v[64:67], v13 offset:4096
    ds_read_b128 v[68:71], v13 offset:20480
    s_waitcnt lgkmcnt(6)
    v_mfma_f32_16x16x32_bf16 v[32:35], a[4:7], v[72:75], v[32:35]
    v_mfma_f32_16x16x32_bf16 v[48:51], a[4:7], v[76:79], v[48:51]
    v_mfma_f32_16x16x32_bf16 v[36:39], a[68:71], v[72:75], v[36:39]
    v_mfma_f32_16x16x32_bf16 v[52:55], a[68:71], v[76:79], v[52:55]
    v_mfma_f32_16x16x32_bf16 v[40:43], a[132:135], v[72:75], v[40:43]
    v_mfma_f32_16x16x32_bf16 v[56:59], a[132:135], v[76:79], v[56:59]
    v_mfma_f32_16x16x32_bf16 v[44:47], a[196:199], v[72:75], v[44:47]
    v_mfma_f32_16x16x32_bf16 v[60:63], a[196:199], v[76:79], v[60:63]
    ds_read_b128 v[72:75], v13 offset:5120
    ds_read_b128 v[76:79], v13 offset:21504
    s_waitcnt lgkmcnt(6)
    v_mfma_f32_16x16x32_bf16 v[32:35], a[8:11], v[80:83], v[32:35]
    v_mfma_f32_16x16x32_bf16 v[48:51], a[8:11], v[84:87], v[48:51]
    v_mfma_f32_16x16x32_bf16 v[36:39], a[72:75], v[80:83], v[36:39]
    v_mfma_f32_16x16x32_bf16 v[52:55], a[72:75], v[84:87], v[52:55]
    v_mfma_f32_16x16x32_bf16 v[40:43], a[136:139], v[80:83], v[40:43]
    v_mfma_f32_16x16x32_bf16 v[56:59], a[136:139], v[84:87], v[56:59]
    v_mfma_f32_16x16x32_bf16 v[44:47], a[200:203], v[80:83], v[44:47]
    v_mfma_f32_16x16x32_bf16 v[60:63], a[200:203], v[84:87], v[60:63]
    ds_read_b128 v[80:83], v13 offset:6144
    ds_read_b128 v[84:87], v13 offset:22528
    s_waitcnt lgkmcnt(6)
    v_mfma_f32_16x16x32_bf16 v[32:35], a[12:15], v[88:91], v[32:35]
    v_mfma_f32_16x16x32_bf16 v[48:51], a[12:15], v[92:95], v[48:51]
    v_mfma_f32_16x16x32_bf16 v[36:39], a[76:79], v[88:91], v[36:39]
    v_mfma_f32_16x16x32_bf16 v[52:55], a[76:79], v[92:95], v[52:55]
    v_mfma_f32_16x16x32_bf16 v[40:43], a[140:143], v[88:91], v[40:43]
    v_mfma_f32_16x16x32_bf16 v[56:59], a[140:143], v[92:95], v[56:59]
    v_mfma_f32_16x16x32_bf16 v[44:47], a[204:207], v[88:91], v[44:47]
    v_mfma_f32_16x16x32_bf16 v[60:63], a[204:207], v[92:95], v[60:63]
    ds_read_b128 v[88:91], v13 offset:7168
    ds_read_b128 v[92:95], v13 offset:23552
    s_waitcnt lgkmcnt(6)
    v_mfma_f32_16x16x32_bf16 v[32:35], a[16:19], v[64:67], v[32:35]
    v_mfma_f32_16x16x32_bf16 v[48:51], a[16:19], v[68:71], v[48:51]
    v_mfma_f32_16x16x32_bf16 v[36:39], a[80:83], v[64:67], v[36:39]
    v_mfma_f32_16x16x32_bf16 v[52:55], a[80:83], v[68:71], v[52:55]
    v_mfma_f32_16x16x32_bf16 v[40:43], a[144:147], v[64:67], v[40:43]
    v_mfma_f32_16x16x32_bf16 v[56:59], a[144:147], v[68:71], v[56:59]
    v_mfma_f32_16x16x32_bf16 v[44:47], a[208:211], v[64:67], v[44:47]
    v_mfma_f32_16x16x32_bf16 v[60:63], a[208:211], v[68:71], v[60:63]
    ds_read_b128 v[64:67], v13 offset:8192
    ds_read_b128 v[68:71], v13 offset:24576
    s_waitcnt lgkmcnt(6)
    v_mfma_f32_16x16x32_bf16 v[32:35], a[20:23], v[72:75], v[32:35]
    v_mfma_f32_16x16x32_bf16 v[48:51], a[20:23], v[76:79], v[48:51]
    v_mfma_f32_16x16x32_bf16 v[36:39], a[84:87], v[72:75], v[36:39]
    v_mfma_f32_16x16x32_bf16 v[52:55], a[84:87], v[76:79], v[52:55]
    v_mfma_f32_16x16x32_bf16 v[40:43], a[148:151], v[72:75], v[40:43]
    v_mfma_f32_16x16x32_bf16 v[56:59], a[148:151], v[76:79], v[56:59]
    v_mfma_f32_16x16x32_bf16 v[44:47], a[212:215], v[72:75], v[44:47]
    v_mfma_f32_16x16x32_bf16 v[60:63], a[212:215], v[76:79], v[60:63]
    ds_read_b128 v[72:75], v13 offset:9216
    ds_read_b128 v[76:79], v13 offset:25600
    s_waitcnt lgkmcnt(6)
    v_mfma_f32_16x16x32_bf16 v[32:35], a[24:27], v[80:83], v[32:35]
    v_mfma_f32_16x16x32_bf16 v[48:51], a[24:27], v[84:87], v[48:51]
    v_mfma_f32_16x16x32_bf16 v[36:39], a[88:91], v[80:83], v[36:39]
    v_mfma_f32_16x16x32_bf16 v[52:55], a[88:91], v[84:87], v[52:55]
    v_mfma_f32_16x16x32_bf16 v[40:43], a[152:155], v[80:83], v[40:43]
    v_mfma_f32_16x16x32_bf16 v[56:59], a[152:155], v[84:87], v[56:59]
    v_mfma_f32_16x16x32_bf16 v[44:47], a[216:219], v[80:83], v[44:47]
    v_mfma_f32_16x16x32_bf16 v[60:63], a[216:219], v[84:87], v[60:63]
    ds_read_b128 v[80:83], v13 offset:10240
    ds_read_b128 v[84:87], v13 offset:26624
    s_waitcnt lgkmcnt(6)
    v_mfma_f32_16x16x32_bf16 v[32:35], a[28:31], v[88:91], v[32:35]
    v_mfma_f32_16x16x32_bf16 v[48:51], a[28:31], v[92:95], v[48:51]
    v_mfma_f32_16x16x32_bf16 v[36:39], a[92:95], v[88:91], v[36:39]
    v_mfma_f32_16x16x32_bf16 v[52:55], a[92:95], v[92:95], v[52:55]
    v_mfma_f32_16x16x32_bf16 v[40:43], a[156:159], v[88:91], v[40:43]
    v_mfma_f32_16x16x32_bf16 v[56:59], a[156:159], v[92:95], v[56:59]
    v_mfma_f32_16x16x32_bf16 v[44:47], a[220:223], v[88:91], v[44:47]
    v_mfma_f32_16x16x32_bf16 v[60:63], a[220:223], v[92:95], v[60:63]
    ds_read_b128 v[88:91], v13 offset:11264
    ds_read_b128 v[92:95], v13 offset:27648
    s_waitcnt lgkmcnt(6)
    v_mfma_f32_16x16x32_bf16 v[32:35], a[32:35], v[64:67], v[32:35]
    v_mfma_f32_16x16x32_bf16 v[48:51], a[32:35], v[68:71], v[48:51]
    v_mfma_f32_16x16x32_bf16 v[36:39], a[96:99], v[64:67], v[36:39]
    v_mfma_f32_16x16x32_bf16 v[52:55], a[96:99], v[68:71], v[52:55]
    v_mfma_f32_16x16x32_bf16 v[40:43], a[160:163], v[64:67], v[40:43]
    v_mfma_f32_16x16x32_bf16 v[56:59], a[160:163], v[68:71], v[56:59]
    v_mfma_f32_16x16x32_bf16 v[44:47], a[224:227], v[64:67], v[44:47]
    v_mfma_f32_16x16x32_bf16 v[60:63], a[224:227], v[68:71], v[60:63]
    ds_read_b128 v[64:67], v13 offset:12288
    ds_read_b128 v[68:71], v13 offset:28672
    s_waitcnt lgkmcnt(6)
    v_mfma_f32_16x16x32_bf16 v[32:35], a[36:39], v[72:75], v[32:35]
    v_mfma_f32_16x16x32_bf16 v[48:51], a[36:39], v[76:79], v[48:51]
    v_mfma_f32_16x16x32_bf16 v[36:39], a[100:103], v[72:75], v[36:39]
    v_mfma_f32_16x16x32_bf16 v[52:55], a[100:103], v[76:79], v[52:55]
    v_mfma_f32_16x16x32_bf16 v[40:43], a[164:167], v[72:75], v[40:43]
    v_mfma_f32_16x16x32_bf16 v[56:59], a[164:167], v[76:79], v[56:59]
    v_mfma_f32_16x16x32_bf16 v[44:47], a[228:231], v[72:75], v[44:47]
    v_mfma_f32_16x16x32_bf16 v[60:63], a[228:231], v[76:79], v[60:63]
    ds_read_b128 v[72:75], v13 offset:13312
    ds_read_b128 v[76:79], v13 offset:29696
    s_waitcnt lgkmcnt(6)
    v_mfma_f32_16x16x32_bf16 v[32:35], a[40:43], v[80:83], v[32:35]
    v_mfma_f32_16x16x32_bf16 v[48:51], a[40:43], v[84:87], v[48:51]
    v_mfma_f32_16x16x32_bf16 v[36:39], a[104:107], v[80:83], v[36:39]
    v_mfma_f32_16x16x32_bf16 v[52:55], a[104:107], v[84:87], v[52:55]
    v_mfma_f32_16x16x32_bf16 v[40:43], a[168:171], v[80:83], v[40:43]
    v_mfma_f32_16x16x32_bf16 v[56:59], a[168:171], v[84:87], v[56:59]
    v_mfma_f32_16x16x32_bf16 v[44:47], a[232:235], v[80:83], v[44:47]
    v_mfma_f32_16x16x32_bf16 v[60:63], a[232:235], v[84:87], v[60:63]
    ds_read_b128 v[80:83], v13 offset:14336
    ds_read_b128 v[84:87], v13 offset:30720
    s_waitcnt lgkmcnt(6)
    v_mfma_f32_16x16x32_bf16 v[32:35], a[44:47], v[88:91], v[32:35]
    v_mfma_f32_16x16x32_bf16 v[48:51], a[44:47], v[92:95], v[48:51]
    v_mfma_f32_16x16x32_bf16 v[36:39], a[108:111], v[88:91], v[36:39]
    v_mfma_f32_16x16x32_bf16 v[52:55], a[108:111], v[92:95], v[52:55]
    v_mfma_f32_16x16x32_bf16 v[40:43], a[172:175], v[88:91], v[40:43]
    v_mfma_f32_16x16x32_bf16 v[56:59], a[172:175], v[92:95], v[56:59]
    v_mfma_f32_16x16x32_bf16 v[44:47], a[236:239], v[88:91], v[44:47]
    v_mfma_f32_16x16x32_bf16 v[60:63], a[236:239], v[92:95], v[60:63]
    ds_read_b128 v[88:91], v13 offset:15360
    ds_read_b128 v[92:95], v13 offset:31744
    s_waitcnt lgkmcnt(6)
    v_mfma_f32_16x16x32_bf16 v[32:35], a[48:51], v[64:67], v[32:35]
    v_mfma_f32_16x16x32_bf16 v[48:51], a[48:51], v[68:71], v[48:51]
    v_mfma_f32_16x16x32_bf16 v[36:39], a[112:115], v[64:67], v[36:39]
    v_mfma_f32_16x16x32_bf16 v[52:55], a[112:115], v[68:71], v[52:55]
    v_mfma_f32_16x16x32_bf16 v[40:43], a[176:179], v[64:67], v[40:43]
    v_mfma_f32_16x16x32_bf16 v[56:59], a[176:179], v[68:71], v[56:59]
    v_mfma_f32_16x16x32_bf16 v[44:47], a[240:243], v[64:67], v[44:47]
    v_mfma_f32_16x16x32_bf16 v[60:63], a[240:243], v[68:71], v[60:63]
    s_waitcnt lgkmcnt(4)
    v_mfma_f32_16x16x32_bf16 v[32:35], a[52:55], v[72:75], v[32:35]
    v_mfma_f32_16x16x32_bf16 v[48:51], a[52:55], v[76:79], v[48:51]
    v_mfma_f32_16x16x32_bf16 v[36:39], a[116:119], v[72:75], v[36:39]
    v_mfma_f32_16x16x32_bf16 v[52:55], a[116:119], v[76:79], v[52:55]
    v_mfma_f32_16x16x32_bf16 v[40:43], a[180:183], v[72:75], v[40:43]
    v_mfma_f32_16x16x32_bf16 v[56:59], a[180:183], v[76:79], v[56:59]
    v_mfma_f32_16x16x32_bf16 v[44:47], a[244:247], v[72:75], v[44:47]
    v_mfma_f32_16x16x32_bf16 v[60:63], a[244:247], v[76:79], v[60:63]
    s_waitcnt lgkmcnt(2)
    v_mfma_f32_16x16x32_bf16 v[32:35], a[56:59], v[80:83], v[32:35]
    v_mfma_f32_16x16x32_bf16 v[48:51], a[56:59], v[84:87], v[48:51]
    v_mfma_f32_16x16x32_bf16 v[36:39], a[120:123], v[80:83], v[36:39]
    v_mfma_f32_16x16x32_bf16 v[52:55], a[120:123], v[84:87], v[52:55]
    v_mfma_f32_16x16x32_bf16 v[40:43], a[184:187], v[80:83], v[40:43]
    v_mfma_f32_16x16x32_bf16 v[56:59], a[184:187], v[84:87], v[56:59]
    v_mfma_f32_16x16x32_bf16 v[44:47], a[248:251], v[80:83], v[44:47]
    v_mfma_f32_16x16x32_bf16 v[60:63], a[248:251], v[84:87], v[60:63]
    s_waitcnt lgkmcnt(0)
    v_mfma_f32_16x16x32_bf16 v[32:35], a[60:63], v[88:91], v[32:35]
    v_mfma_f32_16x16x32_bf16 v[48:51], a[60:63], v[92:95], v[48:51]
    v_mfma_f32_16x16x32_bf16 v[36:39], a[124:127], v[88:91], v[36:39]
    v_mfma_f32_16x16x32_bf16 v[52:55], a[124:127], v[92:95], v[52:55]
    v_mfma_f32_16x16x32_bf16 v[40:43], a[188:191], v[88:91], v[40:43]
    v_mfma_f32_16x16x32_bf16 v[56:59], a[188:191], v[92:95], v[56:59]
    v_mfma_f32_16x16x32_bf16 v[44:47], a[252:255], v[88:91], v[44:47]
    v_mfma_f32_16x16x32_bf16 v[60:63], a[252:255], v[92:95], v[60:63]
    s_waitcnt vmcnt(0)
    s_nop 7
    s_mul_i32 s60, s64, 114688
    s_lshl_b32 s61, s67, 2
    s_add_u32 s61, s61, s3
    s_lshl_b32 s61, s61, 10
    s_add_u32 s60, s60, s61
    s_add_u32 s60, s60, 53477376
    v_cvt_pk_bf16_f32 v15, v32, v36
    v_lshlrev_b32 v32, 16, v15
    v_and_b32 v36, 0xffff0000, v15
    v_cvt_pk_bf16_f32 v15, v40, v44
    v_lshlrev_b32 v40, 16, v15
    v_and_b32 v44, 0xffff0000, v15
    v_mul_f32 v16, v32, v32
    v_fma_f32 v16, v16, s70, v14
    v_mul_f32 v16, v16, v32
    v_exp_f32 v16, v16
    s_nop 0
    v_add_f32 v16, 1.0, v16
    v_rcp_f32 v16, v16
    s_nop 0
    v_mul_f32 v32, v32, v16
    v_mul_f32 v16, v36, v36
    v_fma_f32 v16, v16, s70, v14
    v_mul_f32 v16, v16, v36
    v_exp_f32 v16, v16
    s_nop 0
    v_add_f32 v16, 1.0, v16
    v_rcp_f32 v16, v16
    s_nop 0
    v_mul_f32 v36, v36, v16
    v_cvt_pk_bf16_f32 v15, v32, v36
    v_lshlrev_b32 v32, 16, v15
    v_and_b32 v36, 0xffff0000, v15
    v_mul_f32 v32, v32, v40
    v_mul_f32 v36, v36, v44
    v_cvt_pk_bf16_f32 v96, v32, v36
    v_cvt_pk_bf16_f32 v15, v33, v37
    v_lshlrev_b32 v33, 16, v15
    v_and_b32 v37, 0xffff0000, v15
    v_cvt_pk_bf16_f32 v15, v41, v45
    v_lshlrev_b32 v41, 16, v15
    v_and_b32 v45, 0xffff0000, v15
    v_mul_f32 v16, v33, v33
    v_fma_f32 v16, v16, s70, v14
    v_mul_f32 v16, v16, v33
    v_exp_f32 v16, v16
    s_nop 0
    v_add_f32 v16, 1.0, v16
    v_rcp_f32 v16, v16
    s_nop 0
    v_mul_f32 v33, v33, v16
    v_mul_f32 v16, v37, v37
    v_fma_f32 v16, v16, s70, v14
    v_mul_f32 v16, v16, v37
    v_exp_f32 v16, v16
    s_nop 0
    v_add_f32 v16, 1.0, v16
    v_rcp_f32 v16, v16
    s_nop 0
    v_mul_f32 v37, v37, v16
    v_cvt_pk_bf16_f32 v15, v33, v37
    v_lshlrev_b32 v33, 16, v15
    v_and_b32 v37, 0xffff0000, v15
    v_mul_f32 v33, v33, v41
    v_mul_f32 v37, v37, v45
    v_cvt_pk_bf16_f32 v97, v33, v37
    v_cvt_pk_bf16_f32 v15, v34, v38
    v_lshlrev_b32 v34, 16, v15
    v_and_b32 v38, 0xffff0000, v15
    v_cvt_pk_bf16_f32 v15, v42, v46
    v_lshlrev_b32 v42, 16, v15
    v_and_b32 v46, 0xffff0000, v15
    v_mul_f32 v16, v34, v34
    v_fma_f32 v16, v16, s70, v14
    v_mul_f32 v16, v16, v34
    v_exp_f32 v16, v16
    s_nop 0
    v_add_f32 v16, 1.0, v16
    v_rcp_f32 v16, v16
    s_nop 0
    v_mul_f32 v34, v34, v16
    v_mul_f32 v16, v38, v38
    v_fma_f32 v16, v16, s70, v14
    v_mul_f32 v16, v16, v38
    v_exp_f32 v16, v16
    s_nop 0
    v_add_f32 v16, 1.0, v16
    v_rcp_f32 v16, v16
    s_nop 0
    v_mul_f32 v38, v38, v16
    v_cvt_pk_bf16_f32 v15, v34, v38
    v_lshlrev_b32 v34, 16, v15
    v_and_b32 v38, 0xffff0000, v15
    v_mul_f32 v34, v34, v42
    v_mul_f32 v38, v38, v46
    v_cvt_pk_bf16_f32 v98, v34, v38
    v_cvt_pk_bf16_f32 v15, v35, v39
    v_lshlrev_b32 v35, 16, v15
    v_and_b32 v39, 0xffff0000, v15
    v_cvt_pk_bf16_f32 v15, v43, v47
    v_lshlrev_b32 v43, 16, v15
    v_and_b32 v47, 0xffff0000, v15
    v_mul_f32 v16, v35, v35
    v_fma_f32 v16, v16, s70, v14
    v_mul_f32 v16, v16, v35
    v_exp_f32 v16, v16
    s_nop 0
    v_add_f32 v16, 1.0, v16
    v_rcp_f32 v16, v16
    s_nop 0
    v_mul_f32 v35, v35, v16
    v_mul_f32 v16, v39, v39
    v_fma_f32 v16, v16, s70, v14
    v_mul_f32 v16, v16, v39
    v_exp_f32 v16, v16
    s_nop 0
    v_add_f32 v16, 1.0, v16
    v_rcp_f32 v16, v16
    s_nop 0
    v_mul_f32 v39, v39, v16
    v_cvt_pk_bf16_f32 v15, v35, v39
    v_lshlrev_b32 v35, 16, v15
    v_and_b32 v39, 0xffff0000, v15
    v_mul_f32 v35, v35, v43
    v_mul_f32 v39, v39, v47
    v_cvt_pk_bf16_f32 v99, v35, v39
    buffer_store_dwordx4 v[96:99], v12, s[36:39], s60 offen sc1
    s_add_u32 s60, s60, 57344
    v_cvt_pk_bf16_f32 v15, v48, v52
    v_lshlrev_b32 v48, 16, v15
    v_and_b32 v52, 0xffff0000, v15
    v_cvt_pk_bf16_f32 v15, v56, v60
    v_lshlrev_b32 v56, 16, v15
    v_and_b32 v60, 0xffff0000, v15
    v_mul_f32 v16, v48, v48
    v_fma_f32 v16, v16, s70, v14
    v_mul_f32 v16, v16, v48
    v_exp_f32 v16, v16
    s_nop 0
    v_add_f32 v16, 1.0, v16
    v_rcp_f32 v16, v16
    s_nop 0
    v_mul_f32 v48, v48, v16
    v_mul_f32 v16, v52, v52
    v_fma_f32 v16, v16, s70, v14
    v_mul_f32 v16, v16, v52
    v_exp_f32 v16, v16
    s_nop 0
    v_add_f32 v16, 1.0, v16
    v_rcp_f32 v16, v16
    s_nop 0
    v_mul_f32 v52, v52, v16
    v_cvt_pk_bf16_f32 v15, v48, v52
    v_lshlrev_b32 v48, 16, v15
    v_and_b32 v52, 0xffff0000, v15
    v_mul_f32 v48, v48, v56
    v_mul_f32 v52, v52, v60
    v_cvt_pk_bf16_f32 v100, v48, v52
    v_cvt_pk_bf16_f32 v15, v49, v53
    v_lshlrev_b32 v49, 16, v15
    v_and_b32 v53, 0xffff0000, v15
    v_cvt_pk_bf16_f32 v15, v57, v61
    v_lshlrev_b32 v57, 16, v15
    v_and_b32 v61, 0xffff0000, v15
    v_mul_f32 v16, v49, v49
    v_fma_f32 v16, v16, s70, v14
    v_mul_f32 v16, v16, v49
    v_exp_f32 v16, v16
    s_nop 0
    v_add_f32 v16, 1.0, v16
    v_rcp_f32 v16, v16
    s_nop 0
    v_mul_f32 v49, v49, v16
    v_mul_f32 v16, v53, v53
    v_fma_f32 v16, v16, s70, v14
    v_mul_f32 v16, v16, v53
    v_exp_f32 v16, v16
    s_nop 0
    v_add_f32 v16, 1.0, v16
    v_rcp_f32 v16, v16
    s_nop 0
    v_mul_f32 v53, v53, v16
    v_cvt_pk_bf16_f32 v15, v49, v53
    v_lshlrev_b32 v49, 16, v15
    v_and_b32 v53, 0xffff0000, v15
    v_mul_f32 v49, v49, v57
    v_mul_f32 v53, v53, v61
    v_cvt_pk_bf16_f32 v101, v49, v53
    v_cvt_pk_bf16_f32 v15, v50, v54
    v_lshlrev_b32 v50, 16, v15
    v_and_b32 v54, 0xffff0000, v15
    v_cvt_pk_bf16_f32 v15, v58, v62
    v_lshlrev_b32 v58, 16, v15
    v_and_b32 v62, 0xffff0000, v15
    v_mul_f32 v16, v50, v50
    v_fma_f32 v16, v16, s70, v14
    v_mul_f32 v16, v16, v50
    v_exp_f32 v16, v16
    s_nop 0
    v_add_f32 v16, 1.0, v16
    v_rcp_f32 v16, v16
    s_nop 0
    v_mul_f32 v50, v50, v16
    v_mul_f32 v16, v54, v54
    v_fma_f32 v16, v16, s70, v14
    v_mul_f32 v16, v16, v54
    v_exp_f32 v16, v16
    s_nop 0
    v_add_f32 v16, 1.0, v16
    v_rcp_f32 v16, v16
    s_nop 0
    v_mul_f32 v54, v54, v16
    v_cvt_pk_bf16_f32 v15, v50, v54
    v_lshlrev_b32 v50, 16, v15
    v_and_b32 v54, 0xffff0000, v15
    v_mul_f32 v50, v50, v58
    v_mul_f32 v54, v54, v62
    v_cvt_pk_bf16_f32 v102, v50, v54
    v_cvt_pk_bf16_f32 v15, v51, v55
    v_lshlrev_b32 v51, 16, v15
    v_and_b32 v55, 0xffff0000, v15
    v_cvt_pk_bf16_f32 v15, v59, v63
    v_lshlrev_b32 v59, 16, v15
    v_and_b32 v63, 0xffff0000, v15
    v_mul_f32 v16, v51, v51
    v_fma_f32 v16, v16, s70, v14
    v_mul_f32 v16, v16, v51
    v_exp_f32 v16, v16
    s_nop 0
    v_add_f32 v16, 1.0, v16
    v_rcp_f32 v16, v16
    s_nop 0
    v_mul_f32 v51, v51, v16
    v_mul_f32 v16, v55, v55
    v_fma_f32 v16, v16, s70, v14
    v_mul_f32 v16, v16, v55
    v_exp_f32 v16, v16
    s_nop 0
    v_add_f32 v16, 1.0, v16
    v_rcp_f32 v16, v16
    s_nop 0
    v_mul_f32 v55, v55, v16
    v_cvt_pk_bf16_f32 v15, v51, v55
    v_lshlrev_b32 v51, 16, v15
    v_and_b32 v55, 0xffff0000, v15
    v_mul_f32 v51, v51, v59
    v_mul_f32 v55, v55, v63
    v_cvt_pk_bf16_f32 v103, v51, v55
    buffer_store_dwordx4 v[100:103], v12, s[36:39], s60 offen sc1
    s_add_u32 s60, s60, 57344
    s_mov_b32 s68, s64
    s_add_u32 s64, s64, 7
    s_cmp_lt_u32 s64, 64
    s_cbranch_scc1 G_29
P2_DONE:
    s_sub_u32 s60, s4, 32
    s_lshr_b32 s61, s60, 4
    s_mul_i32 s61, s61, 393216
    s_and_b32 s60, s60, 15
    s_lshl_b32 s60, s60, 13
    s_add_u32 s60, s60, s61
    s_lshl_b32 s61, s3, 11
    s_add_u32 s60, s60, s61
    s_add_u32 s60, s60, 60817408
    s_add_u32 s61, s60, 131072
    v_lshlrev_b32 v8, 4, v0
    v_mov_b32 v4, -1
    v_mov_b32 v5, -1
    v_mov_b32 v6, -1
    v_mov_b32 v7, -1
    buffer_store_dwordx4 v[4:7], v8, s[36:39], s60 offen offset:0 sc1
    buffer_store_dwordx4 v[4:7], v8, s[36:39], s60 offen offset:1024 sc1
    buffer_store_dwordx4 v[4:7], v8, s[36:39], s61 offen offset:0 sc1
    buffer_store_dwordx4 v[4:7], v8, s[36:39], s61 offen offset:1024 sc1
    s_waitcnt vmcnt(0)
    s_barrier
    s_cmp_lg_u32 s3, 0
    s_cbranch_scc1 AR_33
    v_mov_b32 v5, 160
    v_mov_b32 v4, 1
    s_mov_b64 exec, 1
    global_atomic_add v5, v4, s[32:33] sc1
    s_mov_b64 exec, -1
AR_33:
    s_sub_u32 s60, s4, 32
    s_and_b32 s64, s60, 15
    s_lshr_b32 s65, s60, 4
    s_cmp_lt_u32 s65, 2
    s_cbranch_scc1 P3_END
    v_lshrrev_b32 v4, 4, v0
    v_and_b32 v5, 15, v0
    v_lshlrev_b32 v4, 13, v4
    v_lshl_add_u32 v4, v5, 2, v4
    s_lshl_b32 s60, s64, 6
    s_lshl_b32 s61, s3, 20
    s_add_u32 s61, s61, s60
    v_add_u32 v2, s61, v4
    s_mul_i32 s61, s3, 458752
    s_add_u32 s61, s61, s60
    v_add_u32 v3, s61, v4
    s_mov_b32 s40, s18
    s_mov_b32 s41, s19
    s_mov_b32 s42, 4194304
    s_mov_b32 s43, 0x00020000
    s_mov_b32 s44, s28
    s_mov_b32 s45, s29
    s_mov_b32 s46, 1835008
    s_mov_b32 s47, 0x00020000
    s_mov_b32 s60, 0
    buffer_load_dword v16, v3, s[44:47], s60 offen offset:0
    buffer_load_dword v17, v3, s[44:47], s60 offen offset:1024
    buffer_load_dword v18, v3, s[44:47], s60 offen offset:2048
    buffer_load_dword v19, v3, s[44:47], s60 offen offset:3072
    s_mov_b32 s60, 4096
    buffer_load_dword v20, v3, s[44:47], s60 offen offset:0
    buffer_load_dword v21, v3, s[44:47], s60 offen offset:1024
    buffer_load_dword v22, v3, s[44:47], s60 offen offset:2048
    buffer_load_dword v23, v3, s[44:47], s60 offen offset:3072
    s_mov_b32 s60, 32768
    buffer_load_dword v24, v3, s[44:47], s60 offen offset:0
    buffer_load_dword v25, v3, s[44:47], s60 offen offset:1024
    buffer_load_dword v26, v3, s[44:47], s60 offen offset:2048
    buffer_load_dword v27, v3, s[44:47], s60 offen offset:3072
    s_mov_b32 s60, 36864
    buffer_load_dword v28, v3, s[44:47], s60 offen offset:0
    buffer_load_dword v29, v3, s[44:47], s60 offen offset:1024
    buffer_load_dword v30, v3, s[44:47], s60 offen offset:2048
    buffer_load_dword v31, v3, s[44:47], s60 offen offset:3072
    s_mov_b32 s60, 65536
    buffer_load_dword v32, v3, s[44:47], s60 offen offset:0
    buffer_load_dword v33, v3, s[44:47], s60 offen offset:1024
    buffer_load_dword v34, v3, s[44:47], s60 offen offset:2048
    buffer_load_dword v35, v3, s[44:47], s60 offen offset:3072
    s_mov_b32 s60, 69632
    buffer_load_dword v36, v3, s[44:47], s60 offen offset:0
    buffer_load_dword v37, v3, s[44:47], s60 offen offset:1024
    buffer_load_dword v38, v3, s[44:47], s60 offen offset:2048
    buffer_load_dword v39, v3, s[44:47], s60 offen offset:3072
    s_mov_b32 s60, 98304
    buffer_load_dword v40, v3, s[44:47], s60 offen offset:0
    buffer_load_dword v41, v3, s[44:47], s60 offen offset:1024
    buffer_load_dword v42, v3, s[44:47], s60 offen offset:2048
    buffer_load_dword v43, v3, s[44:47], s60 offen offset:3072
    s_mov_b32 s60, 102400
    buffer_load_dword v44, v3, s[44:47], s60 offen offset:0
    buffer_load_dword v45, v3, s[44:47], s60 offen offset:1024
    buffer_load_dword v46, v3, s[44:47], s60 offen offset:2048
    buffer_load_dword v47, v3, s[44:47], s60 offen offset:3072
    s_mov_b32 s60, 131072
    buffer_load_dword v48, v3, s[44:47], s60 offen offset:0
    buffer_load_dword v49, v3, s[44:47], s60 offen offset:1024
    buffer_load_dword v50, v3, s[44:47], s60 offen offset:2048
    buffer_load_dword v51, v3, s[44:47], s60 offen offset:3072
    s_mov_b32 s60, 135168
    buffer_load_dword v52, v3, s[44:47], s60 offen offset:0
    buffer_load_dword v53, v3, s[44:47], s60 offen offset:1024
    buffer_load_dword v54, v3, s[44:47], s60 offen offset:2048
    buffer_load_dword v55, v3, s[44:47], s60 offen offset:3072
    s_mov_b32 s60, 163840
    buffer_load_dword v56, v3, s[44:47], s60 offen offset:0
    buffer_load_dword v57, v3, s[44:47], s60 offen offset:1024
    buffer_load_dword v58, v3, s[44:47], s60 offen offset:2048
    buffer_load_dword v59, v3, s[44:47], s60 offen offset:3072
    s_mov_b32 s60, 167936
    buffer_load_dword v60, v3, s[44:47], s60 offen offset:0
    buffer_load_dword v61, v3, s[44:47], s60 offen offset:1024
    buffer_load_dword v62, v3, s[44:47], s60 offen offset:2048
    buffer_load_dword v63, v3, s[44:47], s60 offen offset:3072
    s_mov_b32 s60, 196608
    buffer_load_dword v64, v3, s[44:47], s60 offen offset:0
    buffer_load_dword v65, v3, s[44:47], s60 offen offset:1024
    buffer_load_dword v66, v3, s[44:47], s60 offen offset:2048
    buffer_load_dword v67, v3, s[44:47], s60 offen offset:3072
    s_mov_b32 s60, 200704
    buffer_load_dword v68, v3, s[44:47], s60 offen offset:0
    buffer_load_dword v69, v3, s[44:47], s60 offen offset:1024
    buffer_load_dword v70, v3, s[44:47], s60 offen offset:2048
    buffer_load_dword v71, v3, s[44:47], s60 offen offset:3072
    s_waitcnt vmcnt(48)
    v_perm_b32 v144, v17, v16, s56
    v_perm_b32 v145, v19, v18, s56
    v_perm_b32 v146, v21, v20, s56
    v_perm_b32 v147, v23, v22, s56
    v_perm_b32 v148, v17, v16, s57
    v_perm_b32 v149, v19, v18, s57
    v_perm_b32 v150, v21, v20, s57
    v_perm_b32 v151, v23, v22, s57
    s_mov_b32 s60, 229376
    buffer_load_dword v72, v3, s[44:47], s60 offen offset:0
    buffer_load_dword v73, v3, s[44:47], s60 offen offset:1024
    buffer_load_dword v74, v3, s[44:47], s60 offen offset:2048
    buffer_load_dword v75, v3, s[44:47], s60 offen offset:3072
    s_mov_b32 s60, 233472
    buffer_load_dword v76, v3, s[44:47], s60 offen offset:0
    buffer_load_dword v77, v3, s[44:47], s60 offen offset:1024
    buffer_load_dword v78, v3, s[44:47], s60 offen offset:2048
    buffer_load_dword v79, v3, s[44:47], s60 offen offset:3072
    s_waitcnt vmcnt(48)
    v_perm_b32 v152, v25, v24, s56
    v_perm_b32 v153, v27, v26, s56
    v_perm_b32 v154, v29, v28, s56
    v_perm_b32 v155, v31, v30, s56
    v_perm_b32 v156, v25, v24, s57
    v_perm_b32 v157, v27, v26, s57
    v_perm_b32 v158, v29, v28, s57
    v_perm_b32 v159, v31, v30, s57
    s_mov_b32 s60, 262144
    buffer_load_dword v16, v3, s[44:47], s60 offen offset:0
    buffer_load_dword v17, v3, s[44:47], s60 offen offset:1024
    buffer_load_dword v18, v3, s[44:47], s60 offen offset:2048
    buffer_load_dword v19, v3, s[44:47], s60 offen offset:3072
    s_mov_b32 s60, 266240
    buffer_load_dword v20, v3, s[44:47], s60 offen offset:0
    buffer_load_dword v21, v3, s[44:47], s60 offen offset:1024
    buffer_load_dword v22, v3, s[44:47], s60 offen offset:2048
    buffer_load_dword v23, v3, s[44:47], s60 offen offset:3072
    s_waitcnt vmcnt(48)
    v_perm_b32 v160, v33, v32, s56
    v_perm_b32 v161, v35, v34, s56
    v_perm_b32 v162, v37, v36, s56
    v_perm_b32 v163, v39, v38, s56
    v_perm_b32 v164, v33, v32, s57
    v_perm_b32 v165, v35, v34, s57
    v_perm_b32 v166, v37, v36, s57
    v_perm_b32 v167, v39, v38, s57
    s_mov_b32 s60, 294912
    buffer_load_dword v24, v3, s[44:47], s60 offen offset:0
    buffer_load_dword v25, v3, s[44:47], s60 offen offset:1024
    buffer_load_dword v26, v3, s[44:47], s60 offen offset:2048
    buffer_load_dword v27, v3, s[44:47], s60 offen offset:3072
    s_mov_b32 s60, 299008
    buffer_load_dword v28, v3, s[44:47], s60 offen offset:0
    buffer_load_dword v29, v3, s[44:47], s60 offen offset:1024
    buffer_load_dword v30, v3, s[44:47], s60 offen offset:2048
    buffer_load_dword v31, v3, s[44:47], s60 offen offset:3072
    s_waitcnt vmcnt(48)
    v_perm_b32 v168, v41, v40, s56
    v_perm_b32 v169, v43, v42, s56
    v_perm_b32 v170, v45, v44, s56
    v_perm_b32 v171, v47, v46, s56
    v_perm_b32 v172, v41, v40, s57
    v_perm_b32 v173, v43, v42, s57
    v_perm_b32 v174, v45, v44, s57
    v_perm_b32 v175, v47, v46, s57
    s_mov_b32 s60, 327680
    buffer_load_dword v32, v3, s[44:47], s60 offen offset:0
    buffer_load_dword v33, v3, s[44:47], s60 offen offset:1024
    buffer_load_dword v34, v3, s[44:47], s60 offen offset:2048
    buffer_load_dword v35, v3, s[44:47], s60 offen offset:3072
    s_mov_b32 s60, 331776
    buffer_load_dword v36, v3, s[44:47], s60 offen offset:0
    buffer_load_dword v37, v3, s[44:47], s60 offen offset:1024
    buffer_load_dword v38, v3, s[44:47], s60 offen offset:2048
    buffer_load_dword v39, v3, s[44:47], s60 offen offset:3072
    s_waitcnt vmcnt(48)
    v_perm_b32 v176, v49, v48, s56
    v_perm_b32 v177, v51, v50, s56
    v_perm_b32 v178, v53, v52, s56
    v_perm_b32 v179, v55, v54, s56
    v_perm_b32 v180, v49, v48, s57
    v_perm_b32 v181, v51, v50, s57
    v_perm_b32 v182, v53, v52, s57
    v_perm_b32 v183, v55, v54, s57
    s_mov_b32 s60, 360448
    buffer_load_dword v40, v3, s[44:47], s60 offen offset:0
    buffer_load_dword v41, v3, s[44:47], s60 offen offset:1024
    buffer_load_dword v42, v3, s[44:47], s60 offen offset:2048
    buffer_load_dword v43, v3, s[44:47], s60 offen offset:3072
    s_mov_b32 s60, 364544
    buffer_load_dword v44, v3, s[44:47], s60 offen offset:0
    buffer_load_dword v45, v3, s[44:47], s60 offen offset:1024
    buffer_load_dword v46, v3, s[44:47], s60 offen offset:2048
    buffer_load_dword v47, v3, s[44:47], s60 offen offset:3072
    s_waitcnt vmcnt(48)
    v_perm_b32 v184, v57, v56, s56
    v_perm_b32 v185, v59, v58, s56
    v_perm_b32 v186, v61, v60, s56
    v_perm_b32 v187, v63, v62, s56
    v_perm_b32 v188, v57, v56, s57
    v_perm_b32 v189, v59, v58, s57
    v_perm_b32 v190, v61, v60, s57
    v_perm_b32 v191, v63, v62, s57
    s_mov_b32 s60, 393216
    buffer_load_dword v48, v3, s[44:47], s60 offen offset:0
    buffer_load_dword v49, v3, s[44:47], s60 offen offset:1024
    buffer_load_dword v50, v3, s[44:47], s60 offen offset:2048
    buffer_load_dword v51, v3, s[44:47], s60 offen offset:3072
    s_mov_b32 s60, 397312
    buffer_load_dword v52, v3, s[44:47], s60 offen offset:0
    buffer_load_dword v53, v3, s[44:47], s60 offen offset:1024
    buffer_load_dword v54, v3, s[44:47], s60 offen offset:2048
    buffer_load_dword v55, v3, s[44:47], s60 offen offset:3072
    s_waitcnt vmcnt(48)
    v_perm_b32 v192, v65, v64, s56
    v_perm_b32 v193, v67, v66, s56
    v_perm_b32 v194, v69, v68, s56
    v_perm_b32 v195, v71, v70, s56
    v_perm_b32 v196, v65, v64, s57
    v_perm_b32 v197, v67, v66, s57
    v_perm_b32 v198, v69, v68, s57
    v_perm_b32 v199, v71, v70, s57
    s_mov_b32 s60, 425984
    buffer_load_dword v56, v3, s[44:47], s60 offen offset:0
    buffer_load_dword v57, v3, s[44:47], s60 offen offset:1024
    buffer_load_dword v58, v3, s[44:47], s60 offen offset:2048
    buffer_load_dword v59, v3, s[44:47], s60 offen offset:3072
    s_mov_b32 s60, 430080
    buffer_load_dword v60, v3, s[44:47], s60 offen offset:0
    buffer_load_dword v61, v3, s[44:47], s60 offen offset:1024
    buffer_load_dword v62, v3, s[44:47], s60 offen offset:2048
    buffer_load_dword v63, v3, s[44:47], s60 offen offset:3072
    s_waitcnt vmcnt(48)
    v_perm_b32 v200, v73, v72, s56
    v_perm_b32 v201, v75, v74, s56
    v_perm_b32 v202, v77, v76, s56
    v_perm_b32 v203, v79, v78, s56
    v_perm_b32 v204, v73, v72, s57
    v_perm_b32 v205, v75, v74, s57
    v_perm_b32 v206, v77, v76, s57
    v_perm_b32 v207, v79, v78, s57
    s_mov_b32 s60, 0
    buffer_load_dword v64, v2, s[40:43], s60 offen offset:0
    buffer_load_dword v65, v2, s[40:43], s60 offen offset:1024
    buffer_load_dword v66, v2, s[40:43], s60 offen offset:2048
    buffer_load_dword v67, v2, s[40:43], s60 offen offset:3072
    s_mov_b32 s60, 4096
    buffer_load_dword v68, v2, s[40:43], s60 offen offset:0
    buffer_load_dword v69, v2, s[40:43], s60 offen offset:1024
    buffer_load_dword v70, v2, s[40:43], s60 offen offset:2048
    buffer_load_dword v71, v2, s[40:43], s60 offen offset:3072
    s_waitcnt vmcnt(48)
    v_perm_b32 v208, v17, v16, s56
    v_perm_b32 v209, v19, v18, s56
    v_perm_b32 v210, v21, v20, s56
    v_perm_b32 v211, v23, v22, s56
    v_perm_b32 v212, v17, v16, s57
    v_perm_b32 v213, v19, v18, s57
    v_perm_b32 v214, v21, v20, s57
    v_perm_b32 v215, v23, v22, s57
    s_mov_b32 s60, 32768
    buffer_load_dword v72, v2, s[40:43], s60 offen offset:0
    buffer_load_dword v73, v2, s[40:43], s60 offen offset:1024
    buffer_load_dword v74, v2, s[40:43], s60 offen offset:2048
    buffer_load_dword v75, v2, s[40:43], s60 offen offset:3072
    s_mov_b32 s60, 36864
    buffer_load_dword v76, v2, s[40:43], s60 offen offset:0
    buffer_load_dword v77, v2, s[40:43], s60 offen offset:1024
    buffer_load_dword v78, v2, s[40:43], s60 offen offset:2048
    buffer_load_dword v79, v2, s[40:43], s60 offen offset:3072
    s_waitcnt vmcnt(48)
    v_perm_b32 v216, v25, v24, s56
    v_perm_b32 v217, v27, v26, s56
    v_perm_b32 v218, v29, v28, s56
    v_perm_b32 v219, v31, v30, s56
    v_perm_b32 v220, v25, v24, s57
    v_perm_b32 v221, v27, v26, s57
    v_perm_b32 v222, v29, v28, s57
    v_perm_b32 v223, v31, v30, s57
    s_mov_b32 s60, 65536
    buffer_load_dword v16, v2, s[40:43], s60 offen offset:0
    buffer_load_dword v17, v2, s[40:43], s60 offen offset:1024
    buffer_load_dword v18, v2, s[40:43], s60 offen offset:2048
    buffer_load_dword v19, v2, s[40:43], s60 offen offset:3072
    s_mov_b32 s60, 69632
    buffer_load_dword v20, v2, s[40:43], s60 offen offset:0
    buffer_load_dword v21, v2, s[40:43], s60 offen offset:1024
    buffer_load_dword v22, v2, s[40:43], s60 offen offset:2048
    buffer_load_dword v23, v2, s[40:43], s60 offen offset:3072
    s_waitcnt vmcnt(48)
    v_perm_b32 v224, v33, v32, s56
    v_perm_b32 v225, v35, v34, s56
    v_perm_b32 v226, v37, v36, s56
    v_perm_b32 v227, v39, v38, s56
    v_perm_b32 v228, v33, v32, s57
    v_perm_b32 v229, v35, v34, s57
    v_perm_b32 v230, v37, v36, s57
    v_perm_b32 v231, v39, v38, s57
    s_mov_b32 s60, 98304
    buffer_load_dword v24, v2, s[40:43], s60 offen offset:0
    buffer_load_dword v25, v2, s[40:43], s60 offen offset:1024
    buffer_load_dword v26, v2, s[40:43], s60 offen offset:2048
    buffer_load_dword v27, v2, s[40:43], s60 offen offset:3072
    s_mov_b32 s60, 102400
    buffer_load_dword v28, v2, s[40:43], s60 offen offset:0
    buffer_load_dword v29, v2, s[40:43], s60 offen offset:1024
    buffer_load_dword v30, v2, s[40:43], s60 offen offset:2048
    buffer_load_dword v31, v2, s[40:43], s60 offen offset:3072
    s_waitcnt vmcnt(48)
    v_perm_b32 v232, v41, v40, s56
    v_perm_b32 v233, v43, v42, s56
    v_perm_b32 v234, v45, v44, s56
    v_perm_b32 v235, v47, v46, s56
    v_perm_b32 v236, v41, v40, s57
    v_perm_b32 v237, v43, v42, s57
    v_perm_b32 v238, v45, v44, s57
    v_perm_b32 v239, v47, v46, s57
    s_mov_b32 s60, 131072
    buffer_load_dword v32, v2, s[40:43], s60 offen offset:0
    buffer_load_dword v33, v2, s[40:43], s60 offen offset:1024
    buffer_load_dword v34, v2, s[40:43], s60 offen offset:2048
    buffer_load_dword v35, v2, s[40:43], s60 offen offset:3072
    s_mov_b32 s60, 135168
    buffer_load_dword v36, v2, s[40:43], s60 offen offset:0
    buffer_load_dword v37, v2, s[40:43], s60 offen offset:1024
    buffer_load_dword v38, v2, s[40:43], s60 offen offset:2048
    buffer_load_dword v39, v2, s[40:43], s60 offen offset:3072
    s_waitcnt vmcnt(48)
    v_perm_b32 v240, v49, v48, s56
    v_perm_b32 v241, v51, v50, s56
    v_perm_b32 v242, v53, v52, s56
    v_perm_b32 v243, v55, v54, s56
    v_perm_b32 v244, v49, v48, s57
    v_perm_b32 v245, v51, v50, s57
    v_perm_b32 v246, v53, v52, s57
    v_perm_b32 v247, v55, v54, s57
    s_mov_b32 s60, 163840
    buffer_load_dword v40, v2, s[40:43], s60 offen offset:0
    buffer_load_dword v41, v2, s[40:43], s60 offen offset:1024
    buffer_load_dword v42, v2, s[40:43], s60 offen offset:2048
    buffer_load_dword v43, v2, s[40:43], s60 offen offset:3072
    s_mov_b32 s60, 167936
    buffer_load_dword v44, v2, s[40:43], s60 offen offset:0
    buffer_load_dword v45, v2, s[40:43], s60 offen offset:1024
    buffer_load_dword v46, v2, s[40:43], s60 offen offset:2048
    buffer_load_dword v47, v2, s[40:43], s60 offen offset:3072
    s_waitcnt vmcnt(48)
    v_perm_b32 v248, v57, v56, s56
    v_perm_b32 v249, v59, v58, s56
    v_perm_b32 v250, v61, v60, s56
    v_perm_b32 v251, v63, v62, s56
    v_perm_b32 v252, v57, v56, s57
    v_perm_b32 v253, v59, v58, s57
    v_perm_b32 v254, v61, v60, s57
    v_perm_b32 v255, v63, v62, s57
    s_mov_b32 s60, 196608
    buffer_load_dword v48, v2, s[40:43], s60 offen offset:0
    buffer_load_dword v49, v2, s[40:43], s60 offen offset:1024
    buffer_load_dword v50, v2, s[40:43], s60 offen offset:2048
    buffer_load_dword v51, v2, s[40:43], s60 offen offset:3072
    s_mov_b32 s60, 200704
    buffer_load_dword v52, v2, s[40:43], s60 offen offset:0
    buffer_load_dword v53, v2, s[40:43], s60 offen offset:1024
    buffer_load_dword v54, v2, s[40:43], s60 offen offset:2048
    buffer_load_dword v55, v2, s[40:43], s60 offen offset:3072
    s_waitcnt vmcnt(48)
    v_perm_b32 v4, v65, v64, s56
    v_perm_b32 v5, v67, v66, s56
    v_perm_b32 v6, v69, v68, s56
    v_perm_b32 v7, v71, v70, s56
    v_perm_b32 v8, v65, v64, s57
    v_perm_b32 v9, v67, v66, s57
    v_perm_b32 v10, v69, v68, s57
    v_perm_b32 v11, v71, v70, s57
    v_accvgpr_write_b32 a0, v4
    v_accvgpr_write_b32 a1, v5
    v_accvgpr_write_b32 a2, v6
    v_accvgpr_write_b32 a3, v7
    v_accvgpr_write_b32 a4, v8
    v_accvgpr_write_b32 a5, v9
    v_accvgpr_write_b32 a6, v10
    v_accvgpr_write_b32 a7, v11
    s_mov_b32 s60, 229376
    buffer_load_dword v56, v2, s[40:43], s60 offen offset:0
    buffer_load_dword v57, v2, s[40:43], s60 offen offset:1024
    buffer_load_dword v58, v2, s[40:43], s60 offen offset:2048
    buffer_load_dword v59, v2, s[40:43], s60 offen offset:3072
    s_mov_b32 s60, 233472
    buffer_load_dword v60, v2, s[40:43], s60 offen offset:0
    buffer_load_dword v61, v2, s[40:43], s60 offen offset:1024
    buffer_load_dword v62, v2, s[40:43], s60 offen offset:2048
    buffer_load_dword v63, v2, s[40:43], s60 offen offset:3072
    s_waitcnt vmcnt(48)
    v_perm_b32 v4, v73, v72, s56
    v_perm_b32 v5, v75, v74, s56
    v_perm_b32 v6, v77, v76, s56
    v_perm_b32 v7, v79, v78, s56
    v_perm_b32 v8, v73, v72, s57
    v_perm_b32 v9, v75, v74, s57
    v_perm_b32 v10, v77, v76, s57
    v_perm_b32 v11, v79, v78, s57
    v_accvgpr_write_b32 a8, v4
    v_accvgpr_write_b32 a9, v5
    v_accvgpr_write_b32 a10, v6
    v_accvgpr_write_b32 a11, v7
    v_accvgpr_write_b32 a12, v8
    v_accvgpr_write_b32 a13, v9
    v_accvgpr_write_b32 a14, v10
    v_accvgpr_write_b32 a15, v11
    s_mov_b32 s60, 262144
    buffer_load_dword v64, v2, s[40:43], s60 offen offset:0
    buffer_load_dword v65, v2, s[40:43], s60 offen offset:1024
    buffer_load_dword v66, v2, s[40:43], s60 offen offset:2048
    buffer_load_dword v67, v2, s[40:43], s60 offen offset:3072
    s_mov_b32 s60, 266240
    buffer_load_dword v68, v2, s[40:43], s60 offen offset:0
    buffer_load_dword v69, v2, s[40:43], s60 offen offset:1024
    buffer_load_dword v70, v2, s[40:43], s60 offen offset:2048
    buffer_load_dword v71, v2, s[40:43], s60 offen offset:3072
    s_waitcnt vmcnt(48)
    v_perm_b32 v4, v17, v16, s56
    v_perm_b32 v5, v19, v18, s56
    v_perm_b32 v6, v21, v20, s56
    v_perm_b32 v7, v23, v22, s56
    v_perm_b32 v8, v17, v16, s57
    v_perm_b32 v9, v19, v18, s57
    v_perm_b32 v10, v21, v20, s57
    v_perm_b32 v11, v23, v22, s57
    v_accvgpr_write_b32 a16, v4
    v_accvgpr_write_b32 a17, v5
    v_accvgpr_write_b32 a18, v6
    v_accvgpr_write_b32 a19, v7
    v_accvgpr_write_b32 a20, v8
    v_accvgpr_write_b32 a21, v9
    v_accvgpr_write_b32 a22, v10
    v_accvgpr_write_b32 a23, v11
    s_mov_b32 s60, 294912
    buffer_load_dword v72, v2, s[40:43], s60 offen offset:0
    buffer_load_dword v73, v2, s[40:43], s60 offen offset:1024
    buffer_load_dword v74, v2, s[40:43], s60 offen offset:2048
    buffer_load_dword v75, v2, s[40:43], s60 offen offset:3072
    s_mov_b32 s60, 299008
    buffer_load_dword v76, v2, s[40:43], s60 offen offset:0
    buffer_load_dword v77, v2, s[40:43], s60 offen offset:1024
    buffer_load_dword v78, v2, s[40:43], s60 offen offset:2048
    buffer_load_dword v79, v2, s[40:43], s60 offen offset:3072
    s_waitcnt vmcnt(48)
    v_perm_b32 v4, v25, v24, s56
    v_perm_b32 v5, v27, v26, s56
    v_perm_b32 v6, v29, v28, s56
    v_perm_b32 v7, v31, v30, s56
    v_perm_b32 v8, v25, v24, s57
    v_perm_b32 v9, v27, v26, s57
    v_perm_b32 v10, v29, v28, s57
    v_perm_b32 v11, v31, v30, s57
    v_accvgpr_write_b32 a24, v4
    v_accvgpr_write_b32 a25, v5
    v_accvgpr_write_b32 a26, v6
    v_accvgpr_write_b32 a27, v7
    v_accvgpr_write_b32 a28, v8
    v_accvgpr_write_b32 a29, v9
    v_accvgpr_write_b32 a30, v10
    v_accvgpr_write_b32 a31, v11
    s_mov_b32 s60, 327680
    buffer_load_dword v16, v2, s[40:43], s60 offen offset:0
    buffer_load_dword v17, v2, s[40:43], s60 offen offset:1024
    buffer_load_dword v18, v2, s[40:43], s60 offen offset:2048
    buffer_load_dword v19, v2, s[40:43], s60 offen offset:3072
    s_mov_b32 s60, 331776
    buffer_load_dword v20, v2, s[40:43], s60 offen offset:0
    buffer_load_dword v21, v2, s[40:43], s60 offen offset:1024
    buffer_load_dword v22, v2, s[40:43], s60 offen offset:2048
    buffer_load_dword v23, v2, s[40:43], s60 offen offset:3072
    s_waitcnt vmcnt(48)
    v_perm_b32 v4, v33, v32, s56
    v_perm_b32 v5, v35, v34, s56
    v_perm_b32 v6, v37, v36, s56
    v_perm_b32 v7, v39, v38, s56
    v_perm_b32 v8, v33, v32, s57
    v_perm_b32 v9, v35, v34, s57
    v_perm_b32 v10, v37, v36, s57
    v_perm_b32 v11, v39, v38, s57
    v_accvgpr_write_b32 a32, v4
    v_accvgpr_write_b32 a33, v5
    v_accvgpr_write_b32 a34, v6
    v_accvgpr_write_b32 a35, v7
    v_accvgpr_write_b32 a36, v8
    v_accvgpr_write_b32 a37, v9
    v_accvgpr_write_b32 a38, v10
    v_accvgpr_write_b32 a39, v11
    s_mov_b32 s60, 360448
    buffer_load_dword v24, v2, s[40:43], s60 offen offset:0
    buffer_load_dword v25, v2, s[40:43], s60 offen offset:1024
    buffer_load_dword v26, v2, s[40:43], s60 offen offset:2048
    buffer_load_dword v27, v2, s[40:43], s60 offen offset:3072
    s_mov_b32 s60, 364544
    buffer_load_dword v28, v2, s[40:43], s60 offen offset:0
    buffer_load_dword v29, v2, s[40:43], s60 offen offset:1024
    buffer_load_dword v30, v2, s[40:43], s60 offen offset:2048
    buffer_load_dword v31, v2, s[40:43], s60 offen offset:3072
    s_waitcnt vmcnt(48)
    v_perm_b32 v4, v41, v40, s56
    v_perm_b32 v5, v43, v42, s56
    v_perm_b32 v6, v45, v44, s56
    v_perm_b32 v7, v47, v46, s56
    v_perm_b32 v8, v41, v40, s57
    v_perm_b32 v9, v43, v42, s57
    v_perm_b32 v10, v45, v44, s57
    v_perm_b32 v11, v47, v46, s57
    v_accvgpr_write_b32 a40, v4
    v_accvgpr_write_b32 a41, v5
    v_accvgpr_write_b32 a42, v6
    v_accvgpr_write_b32 a43, v7
    v_accvgpr_write_b32 a44, v8
    v_accvgpr_write_b32 a45, v9
    v_accvgpr_write_b32 a46, v10
    v_accvgpr_write_b32 a47, v11
    s_mov_b32 s60, 393216
    buffer_load_dword v32, v2, s[40:43], s60 offen offset:0
    buffer_load_dword v33, v2, s[40:43], s60 offen offset:1024
    buffer_load_dword v34, v2, s[40:43], s60 offen offset:2048
    buffer_load_dword v35, v2, s[40:43], s60 offen offset:3072
    s_mov_b32 s60, 397312
    buffer_load_dword v36, v2, s[40:43], s60 offen offset:0
    buffer_load_dword v37, v2, s[40:43], s60 offen offset:1024
    buffer_load_dword v38, v2, s[40:43], s60 offen offset:2048
    buffer_load_dword v39, v2, s[40:43], s60 offen offset:3072
    s_waitcnt vmcnt(48)
    v_perm_b32 v4, v49, v48, s56
    v_perm_b32 v5, v51, v50, s56
    v_perm_b32 v6, v53, v52, s56
    v_perm_b32 v7, v55, v54, s56
    v_perm_b32 v8, v49, v48, s57
    v_perm_b32 v9, v51, v50, s57
    v_perm_b32 v10, v53, v52, s57
    v_perm_b32 v11, v55, v54, s57
    v_accvgpr_write_b32 a48, v4
    v_accvgpr_write_b32 a49, v5
    v_accvgpr_write_b32 a50, v6
    v_accvgpr_write_b32 a51, v7
    v_accvgpr_write_b32 a52, v8
    v_accvgpr_write_b32 a53, v9
    v_accvgpr_write_b32 a54, v10
    v_accvgpr_write_b32 a55, v11
    s_mov_b32 s60, 425984
    buffer_load_dword v40, v2, s[40:43], s60 offen offset:0
    buffer_load_dword v41, v2, s[40:43], s60 offen offset:1024
    buffer_load_dword v42, v2, s[40:43], s60 offen offset:2048
    buffer_load_dword v43, v2, s[40:43], s60 offen offset:3072
    s_mov_b32 s60, 430080
    buffer_load_dword v44, v2, s[40:43], s60 offen offset:0
    buffer_load_dword v45, v2, s[40:43], s60 offen offset:1024
    buffer_load_dword v46, v2, s[40:43], s60 offen offset:2048
    buffer_load_dword v47, v2, s[40:43], s60 offen offset:3072
    s_waitcnt vmcnt(48)
    v_perm_b32 v4, v57, v56, s56
    v_perm_b32 v5, v59, v58, s56
    v_perm_b32 v6, v61, v60, s56
    v_perm_b32 v7, v63, v62, s56
    v_perm_b32 v8, v57, v56, s57
    v_perm_b32 v9, v59, v58, s57
    v_perm_b32 v10, v61, v60, s57
    v_perm_b32 v11, v63, v62, s57
    v_accvgpr_write_b32 a56, v4
    v_accvgpr_write_b32 a57, v5
    v_accvgpr_write_b32 a58, v6
    v_accvgpr_write_b32 a59, v7
    v_accvgpr_write_b32 a60, v8
    v_accvgpr_write_b32 a61, v9
    v_accvgpr_write_b32 a62, v10
    v_accvgpr_write_b32 a63, v11
    s_mov_b32 s60, 458752
    buffer_load_dword v48, v2, s[40:43], s60 offen offset:0
    buffer_load_dword v49, v2, s[40:43], s60 offen offset:1024
    buffer_load_dword v50, v2, s[40:43], s60 offen offset:2048
    buffer_load_dword v51, v2, s[40:43], s60 offen offset:3072
    s_mov_b32 s60, 462848
    buffer_load_dword v52, v2, s[40:43], s60 offen offset:0
    buffer_load_dword v53, v2, s[40:43], s60 offen offset:1024
    buffer_load_dword v54, v2, s[40:43], s60 offen offset:2048
    buffer_load_dword v55, v2, s[40:43], s60 offen offset:3072
    s_waitcnt vmcnt(48)
    v_perm_b32 v4, v65, v64, s56
    v_perm_b32 v5, v67, v66, s56
    v_perm_b32 v6, v69, v68, s56
    v_perm_b32 v7, v71, v70, s56
    v_perm_b32 v8, v65, v64, s57
    v_perm_b32 v9, v67, v66, s57
    v_perm_b32 v10, v69, v68, s57
    v_perm_b32 v11, v71, v70, s57
    v_accvgpr_write_b32 a64, v4
    v_accvgpr_write_b32 a65, v5
    v_accvgpr_write_b32 a66, v6
    v_accvgpr_write_b32 a67, v7
    v_accvgpr_write_b32 a68, v8
    v_accvgpr_write_b32 a69, v9
    v_accvgpr_write_b32 a70, v10
    v_accvgpr_write_b32 a71, v11
    s_mov_b32 s60, 491520
    buffer_load_dword v56, v2, s[40:43], s60 offen offset:0
    buffer_load_dword v57, v2, s[40:43], s60 offen offset:1024
    buffer_load_dword v58, v2, s[40:43], s60 offen offset:2048
    buffer_load_dword v59, v2, s[40:43], s60 offen offset:3072
    s_mov_b32 s60, 495616
    buffer_load_dword v60, v2, s[40:43], s60 offen offset:0
    buffer_load_dword v61, v2, s[40:43], s60 offen offset:1024
    buffer_load_dword v62, v2, s[40:43], s60 offen offset:2048
    buffer_load_dword v63, v2, s[40:43], s60 offen offset:3072
    s_waitcnt vmcnt(48)
    v_perm_b32 v4, v73, v72, s56
    v_perm_b32 v5, v75, v74, s56
    v_perm_b32 v6, v77, v76, s56
    v_perm_b32 v7, v79, v78, s56
    v_perm_b32 v8, v73, v72, s57
    v_perm_b32 v9, v75, v74, s57
    v_perm_b32 v10, v77, v76, s57
    v_perm_b32 v11, v79, v78, s57
    v_accvgpr_write_b32 a72, v4
    v_accvgpr_write_b32 a73, v5
    v_accvgpr_write_b32 a74, v6
    v_accvgpr_write_b32 a75, v7
    v_accvgpr_write_b32 a76, v8
    v_accvgpr_write_b32 a77, v9
    v_accvgpr_write_b32 a78, v10
    v_accvgpr_write_b32 a79, v11
    s_mov_b32 s60, 524288
    buffer_load_dword v64, v2, s[40:43], s60 offen offset:0
    buffer_load_dword v65, v2, s[40:43], s60 offen offset:1024
    buffer_load_dword v66, v2, s[40:43], s60 offen offset:2048
    buffer_load_dword v67, v2, s[40:43], s60 offen offset:3072
    s_mov_b32 s60, 528384
    buffer_load_dword v68, v2, s[40:43], s60 offen offset:0
    buffer_load_dword v69, v2, s[40:43], s60 offen offset:1024
    buffer_load_dword v70, v2, s[40:43], s60 offen offset:2048
    buffer_load_dword v71, v2, s[40:43], s60 offen offset:3072
    s_waitcnt vmcnt(48)
    v_perm_b32 v4, v17, v16, s56
    v_perm_b32 v5, v19, v18, s56
    v_perm_b32 v6, v21, v20, s56
    v_perm_b32 v7, v23, v22, s56
    v_perm_b32 v8, v17, v16, s57
    v_perm_b32 v9, v19, v18, s57
    v_perm_b32 v10, v21, v20, s57
    v_perm_b32 v11, v23, v22, s57
    v_accvgpr_write_b32 a80, v4
    v_accvgpr_write_b32 a81, v5
    v_accvgpr_write_b32 a82, v6
    v_accvgpr_write_b32 a83, v7
    v_accvgpr_write_b32 a84, v8
    v_accvgpr_write_b32 a85, v9
    v_accvgpr_write_b32 a86, v10
    v_accvgpr_write_b32 a87, v11
    s_mov_b32 s60, 557056
    buffer_load_dword v72, v2, s[40:43], s60 offen offset:0
    buffer_load_dword v73, v2, s[40:43], s60 offen offset:1024
    buffer_load_dword v74, v2, s[40:43], s60 offen offset:2048
    buffer_load_dword v75, v2, s[40:43], s60 offen offset:3072
    s_mov_b32 s60, 561152
    buffer_load_dword v76, v2, s[40:43], s60 offen offset:0
    buffer_load_dword v77, v2, s[40:43], s60 offen offset:1024
    buffer_load_dword v78, v2, s[40:43], s60 offen offset:2048
    buffer_load_dword v79, v2, s[40:43], s60 offen offset:3072
    s_waitcnt vmcnt(48)
    v_perm_b32 v4, v25, v24, s56
    v_perm_b32 v5, v27, v26, s56
    v_perm_b32 v6, v29, v28, s56
    v_perm_b32 v7, v31, v30, s56
    v_perm_b32 v8, v25, v24, s57
    v_perm_b32 v9, v27, v26, s57
    v_perm_b32 v10, v29, v28, s57
    v_perm_b32 v11, v31, v30, s57
    v_accvgpr_write_b32 a88, v4
    v_accvgpr_write_b32 a89, v5
    v_accvgpr_write_b32 a90, v6
    v_accvgpr_write_b32 a91, v7
    v_accvgpr_write_b32 a92, v8
    v_accvgpr_write_b32 a93, v9
    v_accvgpr_write_b32 a94, v10
    v_accvgpr_write_b32 a95, v11
    s_mov_b32 s60, 589824
    buffer_load_dword v16, v2, s[40:43], s60 offen offset:0
    buffer_load_dword v17, v2, s[40:43], s60 offen offset:1024
    buffer_load_dword v18, v2, s[40:43], s60 offen offset:2048
    buffer_load_dword v19, v2, s[40:43], s60 offen offset:3072
    s_mov_b32 s60, 593920
    buffer_load_dword v20, v2, s[40:43], s60 offen offset:0
    buffer_load_dword v21, v2, s[40:43], s60 offen offset:1024
    buffer_load_dword v22, v2, s[40:43], s60 offen offset:2048
    buffer_load_dword v23, v2, s[40:43], s60 offen offset:3072
    s_waitcnt vmcnt(48)
    v_perm_b32 v4, v33, v32, s56
    v_perm_b32 v5, v35, v34, s56
    v_perm_b32 v6, v37, v36, s56
    v_perm_b32 v7, v39, v38, s56
    v_perm_b32 v8, v33, v32, s57
    v_perm_b32 v9, v35, v34, s57
    v_perm_b32 v10, v37, v36, s57
    v_perm_b32 v11, v39, v38, s57
    v_accvgpr_write_b32 a96, v4
    v_accvgpr_write_b32 a97, v5
    v_accvgpr_write_b32 a98, v6
    v_accvgpr_write_b32 a99, v7
    v_accvgpr_write_b32 a100, v8
    v_accvgpr_write_b32 a101, v9
    v_accvgpr_write_b32 a102, v10
    v_accvgpr_write_b32 a103, v11
    s_mov_b32 s60, 622592
    buffer_load_dword v24, v2, s[40:43], s60 offen offset:0
    buffer_load_dword v25, v2, s[40:43], s60 offen offset:1024
    buffer_load_dword v26, v2, s[40:43], s60 offen offset:2048
    buffer_load_dword v27, v2, s[40:43], s60 offen offset:3072
    s_mov_b32 s60, 626688
    buffer_load_dword v28, v2, s[40:43], s60 offen offset:0
    buffer_load_dword v29, v2, s[40:43], s60 offen offset:1024
    buffer_load_dword v30, v2, s[40:43], s60 offen offset:2048
    buffer_load_dword v31, v2, s[40:43], s60 offen offset:3072
    s_waitcnt vmcnt(48)
    v_perm_b32 v4, v41, v40, s56
    v_perm_b32 v5, v43, v42, s56
    v_perm_b32 v6, v45, v44, s56
    v_perm_b32 v7, v47, v46, s56
    v_perm_b32 v8, v41, v40, s57
    v_perm_b32 v9, v43, v42, s57
    v_perm_b32 v10, v45, v44, s57
    v_perm_b32 v11, v47, v46, s57
    v_accvgpr_write_b32 a104, v4
    v_accvgpr_write_b32 a105, v5
    v_accvgpr_write_b32 a106, v6
    v_accvgpr_write_b32 a107, v7
    v_accvgpr_write_b32 a108, v8
    v_accvgpr_write_b32 a109, v9
    v_accvgpr_write_b32 a110, v10
    v_accvgpr_write_b32 a111, v11
    s_mov_b32 s60, 655360
    buffer_load_dword v32, v2, s[40:43], s60 offen offset:0
    buffer_load_dword v33, v2, s[40:43], s60 offen offset:1024
    buffer_load_dword v34, v2, s[40:43], s60 offen offset:2048
    buffer_load_dword v35, v2, s[40:43], s60 offen offset:3072
    s_mov_b32 s60, 659456
    buffer_load_dword v36, v2, s[40:43], s60 offen offset:0
    buffer_load_dword v37, v2, s[40:43], s60 offen offset:1024
    buffer_load_dword v38, v2, s[40:43], s60 offen offset:2048
    buffer_load_dword v39, v2, s[40:43], s60 offen offset:3072
    s_waitcnt vmcnt(48)
    v_perm_b32 v4, v49, v48, s56
    v_perm_b32 v5, v51, v50, s56
    v_perm_b32 v6, v53, v52, s56
    v_perm_b32 v7, v55, v54, s56
    v_perm_b32 v8, v49, v48, s57
    v_perm_b32 v9, v51, v50, s57
    v_perm_b32 v10, v53, v52, s57
    v_perm_b32 v11, v55, v54, s57
    v_accvgpr_write_b32 a112, v4
    v_accvgpr_write_b32 a113, v5
    v_accvgpr_write_b32 a114, v6
    v_accvgpr_write_b32 a115, v7
    v_accvgpr_write_b32 a116, v8
    v_accvgpr_write_b32 a117, v9
    v_accvgpr_write_b32 a118, v10
    v_accvgpr_write_b32 a119, v11
    s_mov_b32 s60, 688128
    buffer_load_dword v40, v2, s[40:43], s60 offen offset:0
    buffer_load_dword v41, v2, s[40:43], s60 offen offset:1024
    buffer_load_dword v42, v2, s[40:43], s60 offen offset:2048
    buffer_load_dword v43, v2, s[40:43], s60 offen offset:3072
    s_mov_b32 s60, 692224
    buffer_load_dword v44, v2, s[40:43], s60 offen offset:0
    buffer_load_dword v45, v2, s[40:43], s60 offen offset:1024
    buffer_load_dword v46, v2, s[40:43], s60 offen offset:2048
    buffer_load_dword v47, v2, s[40:43], s60 offen offset:3072
    s_waitcnt vmcnt(48)
    v_perm_b32 v4, v57, v56, s56
    v_perm_b32 v5, v59, v58, s56
    v_perm_b32 v6, v61, v60, s56
    v_perm_b32 v7, v63, v62, s56
    v_perm_b32 v8, v57, v56, s57
    v_perm_b32 v9, v59, v58, s57
    v_perm_b32 v10, v61, v60, s57
    v_perm_b32 v11, v63, v62, s57
    v_accvgpr_write_b32 a120, v4
    v_accvgpr_write_b32 a121, v5
    v_accvgpr_write_b32 a122, v6
    v_accvgpr_write_b32 a123, v7
    v_accvgpr_write_b32 a124, v8
    v_accvgpr_write_b32 a125, v9
    v_accvgpr_write_b32 a126, v10
    v_accvgpr_write_b32 a127, v11
    s_mov_b32 s60, 720896
    buffer_load_dword v48, v2, s[40:43], s60 offen offset:0
    buffer_load_dword v49, v2, s[40:43], s60 offen offset:1024
    buffer_load_dword v50, v2, s[40:43], s60 offen offset:2048
    buffer_load_dword v51, v2, s[40:43], s60 offen offset:3072
    s_mov_b32 s60, 724992
    buffer_load_dword v52, v2, s[40:43], s60 offen offset:0
    buffer_load_dword v53, v2, s[40:43], s60 offen offset:1024
    buffer_load_dword v54, v2, s[40:43], s60 offen offset:2048
    buffer_load_dword v55, v2, s[40:43], s60 offen offset:3072
    s_waitcnt vmcnt(48)
    v_perm_b32 v4, v65, v64, s56
    v_perm_b32 v5, v67, v66, s56
    v_perm_b32 v6, v69, v68, s56
    v_perm_b32 v7, v71, v70, s56
    v_perm_b32 v8, v65, v64, s57
    v_perm_b32 v9, v67, v66, s57
    v_perm_b32 v10, v69, v68, s57
    v_perm_b32 v11, v71, v70, s57
    v_accvgpr_write_b32 a128, v4
    v_accvgpr_write_b32 a129, v5
    v_accvgpr_write_b32 a130, v6
    v_accvgpr_write_b32 a131, v7
    v_accvgpr_write_b32 a132, v8
    v_accvgpr_write_b32 a133, v9
    v_accvgpr_write_b32 a134, v10
    v_accvgpr_write_b32 a135, v11
    s_mov_b32 s60, 753664
    buffer_load_dword v56, v2, s[40:43], s60 offen offset:0
    buffer_load_dword v57, v2, s[40:43], s60 offen offset:1024
    buffer_load_dword v58, v2, s[40:43], s60 offen offset:2048
    buffer_load_dword v59, v2, s[40:43], s60 offen offset:3072
    s_mov_b32 s60, 757760
    buffer_load_dword v60, v2, s[40:43], s60 offen offset:0
    buffer_load_dword v61, v2, s[40:43], s60 offen offset:1024
    buffer_load_dword v62, v2, s[40:43], s60 offen offset:2048
    buffer_load_dword v63, v2, s[40:43], s60 offen offset:3072
    s_waitcnt vmcnt(48)
    v_perm_b32 v4, v73, v72, s56
    v_perm_b32 v5, v75, v74, s56
    v_perm_b32 v6, v77, v76, s56
    v_perm_b32 v7, v79, v78, s56
    v_perm_b32 v8, v73, v72, s57
    v_perm_b32 v9, v75, v74, s57
    v_perm_b32 v10, v77, v76, s57
    v_perm_b32 v11, v79, v78, s57
    v_accvgpr_write_b32 a136, v4
    v_accvgpr_write_b32 a137, v5
    v_accvgpr_write_b32 a138, v6
    v_accvgpr_write_b32 a139, v7
    v_accvgpr_write_b32 a140, v8
    v_accvgpr_write_b32 a141, v9
    v_accvgpr_write_b32 a142, v10
    v_accvgpr_write_b32 a143, v11
    s_mov_b32 s60, 786432
    buffer_load_dword v64, v2, s[40:43], s60 offen offset:0
    buffer_load_dword v65, v2, s[40:43], s60 offen offset:1024
    buffer_load_dword v66, v2, s[40:43], s60 offen offset:2048
    buffer_load_dword v67, v2, s[40:43], s60 offen offset:3072
    s_mov_b32 s60, 790528
    buffer_load_dword v68, v2, s[40:43], s60 offen offset:0
    buffer_load_dword v69, v2, s[40:43], s60 offen offset:1024
    buffer_load_dword v70, v2, s[40:43], s60 offen offset:2048
    buffer_load_dword v71, v2, s[40:43], s60 offen offset:3072
    s_waitcnt vmcnt(48)
    v_perm_b32 v4, v17, v16, s56
    v_perm_b32 v5, v19, v18, s56
    v_perm_b32 v6, v21, v20, s56
    v_perm_b32 v7, v23, v22, s56
    v_perm_b32 v8, v17, v16, s57
    v_perm_b32 v9, v19, v18, s57
    v_perm_b32 v10, v21, v20, s57
    v_perm_b32 v11, v23, v22, s57
    v_accvgpr_write_b32 a144, v4
    v_accvgpr_write_b32 a145, v5
    v_accvgpr_write_b32 a146, v6
    v_accvgpr_write_b32 a147, v7
    v_accvgpr_write_b32 a148, v8
    v_accvgpr_write_b32 a149, v9
    v_accvgpr_write_b32 a150, v10
    v_accvgpr_write_b32 a151, v11
    s_mov_b32 s60, 819200
    buffer_load_dword v72, v2, s[40:43], s60 offen offset:0
    buffer_load_dword v73, v2, s[40:43], s60 offen offset:1024
    buffer_load_dword v74, v2, s[40:43], s60 offen offset:2048
    buffer_load_dword v75, v2, s[40:43], s60 offen offset:3072
    s_mov_b32 s60, 823296
    buffer_load_dword v76, v2, s[40:43], s60 offen offset:0
    buffer_load_dword v77, v2, s[40:43], s60 offen offset:1024
    buffer_load_dword v78, v2, s[40:43], s60 offen offset:2048
    buffer_load_dword v79, v2, s[40:43], s60 offen offset:3072
    s_waitcnt vmcnt(48)
    v_perm_b32 v4, v25, v24, s56
    v_perm_b32 v5, v27, v26, s56
    v_perm_b32 v6, v29, v28, s56
    v_perm_b32 v7, v31, v30, s56
    v_perm_b32 v8, v25, v24, s57
    v_perm_b32 v9, v27, v26, s57
    v_perm_b32 v10, v29, v28, s57
    v_perm_b32 v11, v31, v30, s57
    v_accvgpr_write_b32 a152, v4
    v_accvgpr_write_b32 a153, v5
    v_accvgpr_write_b32 a154, v6
    v_accvgpr_write_b32 a155, v7
    v_accvgpr_write_b32 a156, v8
    v_accvgpr_write_b32 a157, v9
    v_accvgpr_write_b32 a158, v10
    v_accvgpr_write_b32 a159, v11
    s_mov_b32 s60, 851968
    buffer_load_dword v16, v2, s[40:43], s60 offen offset:0
    buffer_load_dword v17, v2, s[40:43], s60 offen offset:1024
    buffer_load_dword v18, v2, s[40:43], s60 offen offset:2048
    buffer_load_dword v19, v2, s[40:43], s60 offen offset:3072
    s_mov_b32 s60, 856064
    buffer_load_dword v20, v2, s[40:43], s60 offen offset:0
    buffer_load_dword v21, v2, s[40:43], s60 offen offset:1024
    buffer_load_dword v22, v2, s[40:43], s60 offen offset:2048
    buffer_load_dword v23, v2, s[40:43], s60 offen offset:3072
    s_waitcnt vmcnt(48)
    v_perm_b32 v4, v33, v32, s56
    v_perm_b32 v5, v35, v34, s56
    v_perm_b32 v6, v37, v36, s56
    v_perm_b32 v7, v39, v38, s56
    v_perm_b32 v8, v33, v32, s57
    v_perm_b32 v9, v35, v34, s57
    v_perm_b32 v10, v37, v36, s57
    v_perm_b32 v11, v39, v38, s57
    v_accvgpr_write_b32 a160, v4
    v_accvgpr_write_b32 a161, v5
    v_accvgpr_write_b32 a162, v6
    v_accvgpr_write_b32 a163, v7
    v_accvgpr_write_b32 a164, v8
    v_accvgpr_write_b32 a165, v9
    v_accvgpr_write_b32 a166, v10
    v_accvgpr_write_b32 a167, v11
    s_mov_b32 s60, 884736
    buffer_load_dword v24, v2, s[40:43], s60 offen offset:0
    buffer_load_dword v25, v2, s[40:43], s60 offen offset:1024
    buffer_load_dword v26, v2, s[40:43], s60 offen offset:2048
    buffer_load_dword v27, v2, s[40:43], s60 offen offset:3072
    s_mov_b32 s60, 888832
    buffer_load_dword v28, v2, s[40:43], s60 offen offset:0
    buffer_load_dword v29, v2, s[40:43], s60 offen offset:1024
    buffer_load_dword v30, v2, s[40:43], s60 offen offset:2048
    buffer_load_dword v31, v2, s[40:43], s60 offen offset:3072
    s_waitcnt vmcnt(48)
    v_perm_b32 v4, v41, v40, s56
    v_perm_b32 v5, v43, v42, s56
    v_perm_b32 v6, v45, v44, s56
    v_perm_b32 v7, v47, v46, s56
    v_perm_b32 v8, v41, v40, s57
    v_perm_b32 v9, v43, v42, s57
    v_perm_b32 v10, v45, v44, s57
    v_perm_b32 v11, v47, v46, s57
    v_accvgpr_write_b32 a168, v4
    v_accvgpr_write_b32 a169, v5
    v_accvgpr_write_b32 a170, v6
    v_accvgpr_write_b32 a171, v7
    v_accvgpr_write_b32 a172, v8
    v_accvgpr_write_b32 a173, v9
    v_accvgpr_write_b32 a174, v10
    v_accvgpr_write_b32 a175, v11
    s_mov_b32 s60, 917504
    buffer_load_dword v32, v2, s[40:43], s60 offen offset:0
    buffer_load_dword v33, v2, s[40:43], s60 offen offset:1024
    buffer_load_dword v34, v2, s[40:43], s60 offen offset:2048
    buffer_load_dword v35, v2, s[40:43], s60 offen offset:3072
    s_mov_b32 s60, 921600
    buffer_load_dword v36, v2, s[40:43], s60 offen offset:0
    buffer_load_dword v37, v2, s[40:43], s60 offen offset:1024
    buffer_load_dword v38, v2, s[40:43], s60 offen offset:2048
    buffer_load_dword v39, v2, s[40:43], s60 offen offset:3072
    s_waitcnt vmcnt(48)
    v_perm_b32 v4, v49, v48, s56
    v_perm_b32 v5, v51, v50, s56
    v_perm_b32 v6, v53, v52, s56
    v_perm_b32 v7, v55, v54, s56
    v_perm_b32 v8, v49, v48, s57
    v_perm_b32 v9, v51, v50, s57
    v_perm_b32 v10, v53, v52, s57
    v_perm_b32 v11, v55, v54, s57
    v_accvgpr_write_b32 a176, v4
    v_accvgpr_write_b32 a177, v5
    v_accvgpr_write_b32 a178, v6
    v_accvgpr_write_b32 a179, v7
    v_accvgpr_write_b32 a180, v8
    v_accvgpr_write_b32 a181, v9
    v_accvgpr_write_b32 a182, v10
    v_accvgpr_write_b32 a183, v11
    s_mov_b32 s60, 950272
    buffer_load_dword v40, v2, s[40:43], s60 offen offset:0
    buffer_load_dword v41, v2, s[40:43], s60 offen offset:1024
    buffer_load_dword v42, v2, s[40:43], s60 offen offset:2048
    buffer_load_dword v43, v2, s[40:43], s60 offen offset:3072
    s_mov_b32 s60, 954368
    buffer_load_dword v44, v2, s[40:43], s60 offen offset:0
    buffer_load_dword v45, v2, s[40:43], s60 offen offset:1024
    buffer_load_dword v46, v2, s[40:43], s60 offen offset:2048
    buffer_load_dword v47, v2, s[40:43], s60 offen offset:3072
    s_waitcnt vmcnt(48)
    v_perm_b32 v4, v57, v56, s56
    v_perm_b32 v5, v59, v58, s56
    v_perm_b32 v6, v61, v60, s56
    v_perm_b32 v7, v63, v62, s56
    v_perm_b32 v8, v57, v56, s57
    v_perm_b32 v9, v59, v58, s57
    v_perm_b32 v10, v61, v60, s57
    v_perm_b32 v11, v63, v62, s57
    v_accvgpr_write_b32 a184, v4
    v_accvgpr_write_b32 a185, v5
    v_accvgpr_write_b32 a186, v6
    v_accvgpr_write_b32 a187, v7
    v_accvgpr_write_b32 a188, v8
    v_accvgpr_write_b32 a189, v9
    v_accvgpr_write_b32 a190, v10
    v_accvgpr_write_b32 a191, v11
    s_mov_b32 s60, 983040
    buffer_load_dword v48, v2, s[40:43], s60 offen offset:0
    buffer_load_dword v49, v2, s[40:43], s60 offen offset:1024
    buffer_load_dword v50, v2, s[40:43], s60 offen offset:2048
    buffer_load_dword v51, v2, s[40:43], s60 offen offset:3072
    s_mov_b32 s60, 987136
    buffer_load_dword v52, v2, s[40:43], s60 offen offset:0
    buffer_load_dword v53, v2, s[40:43], s60 offen offset:1024
    buffer_load_dword v54, v2, s[40:43], s60 offen offset:2048
    buffer_load_dword v55, v2, s[40:43], s60 offen offset:3072
    s_waitcnt vmcnt(48)
    v_perm_b32 v4, v65, v64, s56
    v_perm_b32 v5, v67, v66, s56
    v_perm_b32 v6, v69, v68, s56
    v_perm_b32 v7, v71, v70, s56
    v_perm_b32 v8, v65, v64, s57
    v_perm_b32 v9, v67, v66, s57
    v_perm_b32 v10, v69, v68, s57
    v_perm_b32 v11, v71, v70, s57
    v_accvgpr_write_b32 a192, v4
    v_accvgpr_write_b32 a193, v5
    v_accvgpr_write_b32 a194, v6
    v_accvgpr_write_b32 a195, v7
    v_accvgpr_write_b32 a196, v8
    v_accvgpr_write_b32 a197, v9
    v_accvgpr_write_b32 a198, v10
    v_accvgpr_write_b32 a199, v11
    s_mov_b32 s60, 1015808
    buffer_load_dword v56, v2, s[40:43], s60 offen offset:0
    buffer_load_dword v57, v2, s[40:43], s60 offen offset:1024
    buffer_load_dword v58, v2, s[40:43], s60 offen offset:2048
    buffer_load_dword v59, v2, s[40:43], s60 offen offset:3072
    s_mov_b32 s60, 1019904
    buffer_load_dword v60, v2, s[40:43], s60 offen offset:0
    buffer_load_dword v61, v2, s[40:43], s60 offen offset:1024
    buffer_load_dword v62, v2, s[40:43], s60 offen offset:2048
    buffer_load_dword v63, v2, s[40:43], s60 offen offset:3072
    s_waitcnt vmcnt(48)
    v_perm_b32 v4, v73, v72, s56
    v_perm_b32 v5, v75, v74, s56
    v_perm_b32 v6, v77, v76, s56
    v_perm_b32 v7, v79, v78, s56
    v_perm_b32 v8, v73, v72, s57
    v_perm_b32 v9, v75, v74, s57
    v_perm_b32 v10, v77, v76, s57
    v_perm_b32 v11, v79, v78, s57
    v_accvgpr_write_b32 a200, v4
    v_accvgpr_write_b32 a201, v5
    v_accvgpr_write_b32 a202, v6
    v_accvgpr_write_b32 a203, v7
    v_accvgpr_write_b32 a204, v8
    v_accvgpr_write_b32 a205, v9
    v_accvgpr_write_b32 a206, v10
    v_accvgpr_write_b32 a207, v11
    s_waitcnt vmcnt(40)
    v_perm_b32 v4, v17, v16, s56
    v_perm_b32 v5, v19, v18, s56
    v_perm_b32 v6, v21, v20, s56
    v_perm_b32 v7, v23, v22, s56
    v_perm_b32 v8, v17, v16, s57
    v_perm_b32 v9, v19, v18, s57
    v_perm_b32 v10, v21, v20, s57
    v_perm_b32 v11, v23, v22, s57
    v_accvgpr_write_b32 a208, v4
    v_accvgpr_write_b32 a209, v5
    v_accvgpr_write_b32 a210, v6
    v_accvgpr_write_b32 a211, v7
    v_accvgpr_write_b32 a212, v8
    v_accvgpr_write_b32 a213, v9
    v_accvgpr_write_b32 a214, v10
    v_accvgpr_write_b32 a215, v11
    s_waitcnt vmcnt(32)
    v_perm_b32 v4, v25, v24, s56
    v_perm_b32 v5, v27, v26, s56
    v_perm_b32 v6, v29, v28, s56
    v_perm_b32 v7, v31, v30, s56
    v_perm_b32 v8, v25, v24, s57
    v_perm_b32 v9, v27, v26, s57
    v_perm_b32 v10, v29, v28, s57
    v_perm_b32 v11, v31, v30, s57
    v_accvgpr_write_b32 a216, v4
    v_accvgpr_write_b32 a217, v5
    v_accvgpr_write_b32 a218, v6
    v_accvgpr_write_b32 a219, v7
    v_accvgpr_write_b32 a220, v8
    v_accvgpr_write_b32 a221, v9
    v_accvgpr_write_b32 a222, v10
    v_accvgpr_write_b32 a223, v11
    s_waitcnt vmcnt(24)
    v_perm_b32 v4, v33, v32, s56
    v_perm_b32 v5, v35, v34, s56
    v_perm_b32 v6, v37, v36, s56
    v_perm_b32 v7, v39, v38, s56
    v_perm_b32 v8, v33, v32, s57
    v_perm_b32 v9, v35, v34, s57
    v_perm_b32 v10, v37, v36, s57
    v_perm_b32 v11, v39, v38, s57
    v_accvgpr_write_b32 a224, v4
    v_accvgpr_write_b32 a225, v5
    v_accvgpr_write_b32 a226, v6
    v_accvgpr_write_b32 a227, v7
    v_accvgpr_write_b32 a228, v8
    v_accvgpr_write_b32 a229, v9
    v_accvgpr_write_b32 a230, v10
    v_accvgpr_write_b32 a231, v11
    s_waitcnt vmcnt(16)
    v_perm_b32 v4, v41, v40, s56
    v_perm_b32 v5, v43, v42, s56
    v_perm_b32 v6, v45, v44, s56
    v_perm_b32 v7, v47, v46, s56
    v_perm_b32 v8, v41, v40, s57
    v_perm_b32 v9, v43, v42, s57
    v_perm_b32 v10, v45, v44, s57
    v_perm_b32 v11, v47, v46, s57
    v_accvgpr_write_b32 a232, v4
    v_accvgpr_write_b32 a233, v5
    v_accvgpr_write_b32 a234, v6
    v_accvgpr_write_b32 a235, v7
    v_accvgpr_write_b32 a236, v8
    v_accvgpr_write_b32 a237, v9
    v_accvgpr_write_b32 a238, v10
    v_accvgpr_write_b32 a239, v11
    s_waitcnt vmcnt(8)
    v_perm_b32 v4, v49, v48, s56
    v_perm_b32 v5, v51, v50, s56
    v_perm_b32 v6, v53, v52, s56
    v_perm_b32 v7, v55, v54, s56
    v_perm_b32 v8, v49, v48, s57
    v_perm_b32 v9, v51, v50, s57
    v_perm_b32 v10, v53, v52, s57
    v_perm_b32 v11, v55, v54, s57
    v_accvgpr_write_b32 a240, v4
    v_accvgpr_write_b32 a241, v5
    v_accvgpr_write_b32 a242, v6
    v_accvgpr_write_b32 a243, v7
    v_accvgpr_write_b32 a244, v8
    v_accvgpr_write_b32 a245, v9
    v_accvgpr_write_b32 a246, v10
    v_accvgpr_write_b32 a247, v11
    s_waitcnt vmcnt(0)
    v_perm_b32 v4, v57, v56, s56
    v_perm_b32 v5, v59, v58, s56
    v_perm_b32 v6, v61, v60, s56
    v_perm_b32 v7, v63, v62, s56
    v_perm_b32 v8, v57, v56, s57
    v_perm_b32 v9, v59, v58, s57
    v_perm_b32 v10, v61, v60, s57
    v_perm_b32 v11, v63, v62, s57
    v_accvgpr_write_b32 a248, v4
    v_accvgpr_write_b32 a249, v5
    v_accvgpr_write_b32 a250, v6
    v_accvgpr_write_b32 a251, v7
    v_accvgpr_write_b32 a252, v8
    v_accvgpr_write_b32 a253, v9
    v_accvgpr_write_b32 a254, v10
    v_accvgpr_write_b32 a255, v11
    v_lshlrev_b32 v1, 4, v0
    v_lshrrev_b32 v20, 4, v0
    v_and_b32 v21, 15, v0
    v_lshrrev_b32 v22, 2, v21
    v_and_b32 v23, 1, v0
    v_lshl_add_u32 v22, v22, 1, v23
    v_lshlrev_b32 v22, 6, v22
    v_lshl_add_u32 v2, v20, 4, v22
    v_lshlrev_b32 v22, 2, v20
    v_sub_u32 v3, v22, v21
    v_lshlrev_b32 v22, 10, v21
    v_lshl_add_u32 v22, v20, 4, v22
    s_lshl_b32 s60, s64, 6
    s_lshl_b32 s61, s3, 2
    s_add_u32 s60, s60, s61
    v_add_u32 v4, s60, v22
    v_lshlrev_b32 v7, 7, v0
    s_add_u32 s61, s61, 122880
    v_add_u32 v9, s61, v1
    v_mov_b32 v11, 0
    v_mov_b32 v12, 0
    s_lshr_b32 s60, s3, 1
    s_lshl_b32 s66, s64, 1
    s_add_u32 s66, s66, s60
    s_and_b32 s67, s3, 1
    s_mov_b32 s68, 0
    s_mov_b32 s69, 0x3e0293ee
    s_mul_i32 s73, s3, 30720
    v_add_u32 v14, s73, v1
    s_mul_i32 s74, s65, 393216
    s_add_u32 s74, s74, 60817408
    s_add_i32 s65, s65, 4
    s_sub_u32 s60, s65, 12
    s_cmp_ge_u32 s65, 12
    s_cselect_b32 s65, s60, s65
    s_mov_b32 s72, 0
    s_lshr_b32 s60, s4, 5
    s_lshl_b32 s60, s60, 2
    v_mov_b32 v21, s60
    global_load_dword v20, v21, s[32:33] sc1
    s_and_b32 s60, s4, 16
    s_add_u32 s60, s60, 16
    s_waitcnt vmcnt(0)
    v_readfirstlane_b32 s61, v20
    s_cmp_ge_u32 s61, s60
    s_cselect_b32 s71, 1, 0
    s_cmp_lg_u32 s3, 0
    s_cbranch_scc1 WDD_35
    v_mov_b32 v6, 160
    s_mov_b32 s60, 0
WD_34:
    global_load_dword v5, v6, s[32:33] sc1
    s_waitcnt vmcnt(0)
WD_34_F:
    v_readfirstlane_b32 s61, v5
    s_and_b32 s61, s61, 0xffff
    s_cmp_ge_u32 s61, 224
    s_cbranch_scc1 WDD_35
    s_add_u32 s60, s60, 1
    s_cmp_lt_u32 s60, 200000
    s_cbranch_scc1 WD_34
    v_mov_b32 v1, 256
    v_mov_b32 v2, 224
    global_atomic_or v2, v1, s[32:33] sc1
    s_waitcnt vmcnt(0)
    s_endpgm
WDD_35:
    s_barrier
    s_lshr_b32 s62, s65, 1
    s_lshl_b32 s62, s62, 5
    s_add_u32 s62, s62, s66
    s_mul_i32 s60, s65, 57344
    s_mul_i32 s61, s3, 14336
    s_add_u32 s60, s60, s61
    s_add_u32 s60, s60, 53477376
    s_and_b32 s61, s65, 1
    s_lshl_b32 s59, s62, 1
    s_add_u32 s59, s59, s61
    s_lshl_b32 s59, s59, 12
    s_add_u32 s59, s59, 36700160
    s_lshl_b32 s63, s62, 14
    s_add_u32 s63, s63, 2097152
    s_add_u32 m0, s73, 14336
    s_nop 0
    buffer_load_dwordx4 v1, s[36:39], s59 offen offset:0 lds
    buffer_load_dwordx4 v1, s[36:39], s59 offen offset:1024 lds
    buffer_load_dwordx4 v1, s[36:39], s59 offen offset:2048 lds
    buffer_load_dwordx4 v1, s[36:39], s59 offen offset:3072 lds
    s_add_u32 m0, s73, 18432
    s_nop 0
    buffer_load_dwordx4 v1, s[36:39], s63 offen offset:0 lds
    buffer_load_dwordx4 v1, s[36:39], s63 offen offset:1024 lds
    buffer_load_dwordx4 v1, s[36:39], s63 offen offset:2048 lds
    buffer_load_dwordx4 v1, s[36:39], s63 offen offset:3072 lds
    s_add_u32 s59, s63, 4096
    s_add_u32 m0, s73, 22528
    s_nop 0
    buffer_load_dwordx4 v1, s[36:39], s59 offen offset:0 lds
    buffer_load_dwordx4 v1, s[36:39], s59 offen offset:1024 lds
    buffer_load_dwordx4 v1, s[36:39], s59 offen offset:2048 lds
    buffer_load_dwordx4 v1, s[36:39], s59 offen offset:3072 lds
    s_lshl_b32 s59, s67, 12
    s_add_u32 s59, s59, s63
    s_add_u32 s59, s59, 8192
    s_add_u32 m0, s73, 26624
    s_nop 0
    buffer_load_dwordx4 v1, s[36:39], s59 offen offset:0 lds
    buffer_load_dwordx4 v1, s[36:39], s59 offen offset:1024 lds
    buffer_load_dwordx4 v1, s[36:39], s59 offen offset:2048 lds
    buffer_load_dwordx4 v1, s[36:39], s59 offen offset:3072 lds
    s_add_u32 m0, s73, 0
    s_nop 0
    buffer_load_dwordx4 v1, s[36:39], s60 offen offset:0 lds
    buffer_load_dwordx4 v1, s[36:39], s60 offen offset:1024 lds
    buffer_load_dwordx4 v1, s[36:39], s60 offen offset:2048 lds
    buffer_load_dwordx4 v1, s[36:39], s60 offen offset:3072 lds
    s_add_u32 s60, s60, 4096
    s_add_u32 m0, s73, 4096
    s_nop 0
    buffer_load_dwordx4 v1, s[36:39], s60 offen offset:0 lds
    buffer_load_dwordx4 v1, s[36:39], s60 offen offset:1024 lds
    buffer_load_dwordx4 v1, s[36:39], s60 offen offset:2048 lds
    buffer_load_dwordx4 v1, s[36:39], s60 offen offset:3072 lds
    s_add_u32 s60, s60, 4096
    s_add_u32 m0, s73, 8192
    s_nop 0
    buffer_load_dwordx4 v1, s[36:39], s60 offen offset:0 lds
    buffer_load_dwordx4 v1, s[36:39], s60 offen offset:1024 lds
    buffer_load_dwordx4 v1, s[36:39], s60 offen offset:2048 lds
    buffer_load_dwordx4 v1, s[36:39], s60 offen offset:3072 lds
    s_add_u32 s60, s60, 4096
    s_add_u32 m0, s73, 12288
    s_nop 0
    buffer_load_dwordx4 v1, s[36:39], s60 offen offset:0 lds
    buffer_load_dwordx4 v1, s[36:39], s60 offen offset:1024 lds
P3_TOP:
    s_lshr_b32 s62, s65, 1
    s_lshl_b32 s62, s62, 5
    s_add_u32 s62, s62, s66
    s_and_b32 s70, s65, 1
    s_mul_i32 s75, s62, 4096
    s_add_u32 s75, s75, 89128960
    s_lshl_b32 s58, s67, 10
    s_add_u32 s58, s58, s75
    buffer_load_dwordx4 v[88:91], v2, s[36:39], s75 offen offset:0 sc1
    buffer_load_dwordx4 v[92:95], v2, s[36:39], s75 offen offset:512 sc1
    buffer_load_dwordx4 v[96:99], v2, s[36:39], s75 offen offset:1024 sc1
    buffer_load_dwordx4 v[100:103], v2, s[36:39], s75 offen offset:1536 sc1
    buffer_load_dwordx4 v[128:131], v1, s[36:39], s58 offen offset:2048 sc1
    s_lshl_b32 s60, s65, 14
    buffer_load_dword v8, v4, s[52:55], s60 offen
    s_add_u32 s76, s65, 12
    s_min_u32 s76, s76, 127
    s_lshr_b32 s62, s76, 1
    s_lshl_b32 s62, s62, 5
    s_add_u32 s62, s62, s66
    s_mul_i32 s60, s76, 57344
    s_mul_i32 s61, s3, 14336
    s_add_u32 s60, s60, s61
    s_add_u32 s60, s60, 53477376
    s_and_b32 s61, s76, 1
    s_lshl_b32 s59, s62, 1
    s_add_u32 s59, s59, s61
    s_lshl_b32 s59, s59, 12
    s_add_u32 s59, s59, 36700160
    s_lshl_b32 s63, s62, 14
    s_add_u32 s63, s63, 2097152
    s_lshl_b32 s61, s67, 13
    s_add_u32 s63, s63, s61
    s_add_u32 s61, s60, 8192
    v_lshrrev_b32 v5, 1, v7
    buffer_load_dword v15, v7, s[36:39], s63 offen
    buffer_load_dword v15, v5, s[36:39], s59 offen
    buffer_load_dword v15, v7, s[36:39], s60 offen
    buffer_load_dword v15, v7, s[36:39], s61 offen
    s_waitcnt vmcnt(10)
    ds_read_b128 v[72:75], v14 offset:14336
    ds_read_b128 v[16:19], v14 offset:18432
    ds_read_b128 v[32:35], v14 offset:22528
    ds_read_b128 v[76:79], v14 offset:15360
    ds_read_b128 v[20:23], v14 offset:19456
    ds_read_b128 v[36:39], v14 offset:23552
    ds_read_b128 v[80:83], v14 offset:16384
    ds_read_b128 v[24:27], v14 offset:20480
    ds_read_b128 v[40:43], v14 offset:24576
    ds_read_b128 v[84:87], v14 offset:17408
    ds_read_b128 v[28:31], v14 offset:21504
    ds_read_b128 v[44:47], v14 offset:25600
    s_waitcnt lgkmcnt(9)
    v_mfma_f32_16x16x32_bf16 v[120:123], v[16:19], v[72:75], 0
    v_mfma_f32_16x16x32_bf16 v[124:127], v[32:35], v[72:75], 0
    ds_read_b128 v[104:107], v14 offset:26624
    s_waitcnt lgkmcnt(7)
    v_mfma_f32_16x16x32_bf16 v[120:123], v[20:23], v[76:79], v[120:123]
    v_mfma_f32_16x16x32_bf16 v[124:127], v[36:39], v[76:79], v[124:127]
    ds_read_b128 v[108:111], v14 offset:27648
    s_waitcnt lgkmcnt(5)
    v_mfma_f32_16x16x32_bf16 v[120:123], v[24:27], v[80:83], v[120:123]
    v_mfma_f32_16x16x32_bf16 v[124:127], v[40:43], v[80:83], v[124:127]
    ds_read_b128 v[112:115], v14 offset:28672
    s_waitcnt lgkmcnt(3)
    v_mfma_f32_16x16x32_bf16 v[120:123], v[28:31], v[84:87], v[120:123]
    v_mfma_f32_16x16x32_bf16 v[124:127], v[44:47], v[84:87], v[124:127]
    ds_read_b128 v[116:119], v14 offset:29696
    s_lshl_b32 s60, s70, 4
    v_mov_b32 v6, 0xff800000
    s_nop 4
    s_sub_i32 s61, s60, 0
    v_cmp_ge_i32 vcc, s61, v3
    s_nop 1
    v_cndmask_b32 v120, v6, v120, vcc
    s_sub_i32 s61, s60, 1
    v_cmp_ge_i32 vcc, s61, v3
    s_nop 1
    v_cndmask_b32 v121, v6, v121, vcc
    s_sub_i32 s61, s60, 2
    v_cmp_ge_i32 vcc, s61, v3
    s_nop 1
    v_cndmask_b32 v122, v6, v122, vcc
    s_sub_i32 s61, s60, 3
    v_cmp_ge_i32 vcc, s61, v3
    s_nop 1
    v_cndmask_b32 v123, v6, v123, vcc
    s_sub_i32 s61, s60, 16
    v_cmp_ge_i32 vcc, s61, v3
    s_nop 1
    v_cndmask_b32 v124, v6, v124, vcc
    s_sub_i32 s61, s60, 17
    v_cmp_ge_i32 vcc, s61, v3
    s_nop 1
    v_cndmask_b32 v125, v6, v125, vcc
    s_sub_i32 s61, s60, 18
    v_cmp_ge_i32 vcc, s61, v3
    s_nop 1
    v_cndmask_b32 v126, v6, v126, vcc
    s_sub_i32 s61, s60, 19
    v_cmp_ge_i32 vcc, s61, v3
    s_nop 1
    v_cndmask_b32 v127, v6, v127, vcc
    v_max3_f32 v10, v120, v121, v122
    v_max3_f32 v13, v124, v125, v126
    v_max3_f32 v10, v10, v123, v127
    v_max_f32 v10, v10, v13
    s_waitcnt lgkmcnt(0)
    ds_read_b128 v[16:19], v14 offset:0
    ds_read_b128 v[20:23], v14 offset:1024
    ds_read_b128 v[24:27], v14 offset:2048
    ds_read_b128 v[28:31], v14 offset:3072
    ds_read_b128 v[32:35], v14 offset:4096
    ds_read_b128 v[36:39], v14 offset:5120
    ds_read_b128 v[40:43], v14 offset:6144
    ds_read_b128 v[44:47], v14 offset:7168
    ds_read_b128 v[48:51], v14 offset:8192
    ds_read_b128 v[52:55], v14 offset:9216
    ds_read_b128 v[56:59], v14 offset:10240
    ds_read_b128 v[60:63], v14 offset:11264
    ds_read_b128 v[64:67], v14 offset:12288
    ds_read_b128 v[68:71], v14 offset:13312
    s_waitcnt lgkmcnt(13)
    v_mfma_f32_16x16x32_bf16 v[136:139], v[144:147], v[16:19], 0
    v_mfma_f32_16x16x32_bf16 v[140:143], v[148:151], v[16:19], 0
    s_waitcnt lgkmcnt(12)
    v_mfma_f32_16x16x32_bf16 v[136:139], v[152:155], v[20:23], v[136:139]
    v_mfma_f32_16x16x32_bf16 v[140:143], v[156:159], v[20:23], v[140:143]
    s_waitcnt lgkmcnt(11)
    v_mfma_f32_16x16x32_bf16 v[136:139], v[160:163], v[24:27], v[136:139]
    v_mfma_f32_16x16x32_bf16 v[140:143], v[164:167], v[24:27], v[140:143]
    s_waitcnt lgkmcnt(10)
    v_mfma_f32_16x16x32_bf16 v[136:139], v[168:171], v[28:31], v[136:139]
    v_mfma_f32_16x16x32_bf16 v[140:143], v[172:175], v[28:31], v[140:143]
    s_waitcnt lgkmcnt(9)
    v_mfma_f32_16x16x32_bf16 v[136:139], v[176:179], v[32:35], v[136:139]
    v_mfma_f32_16x16x32_bf16 v[140:143], v[180:183], v[32:35], v[140:143]
    s_waitcnt lgkmcnt(8)
    v_mfma_f32_16x16x32_bf16 v[136:139], v[184:187], v[36:39], v[136:139]
    v_mfma_f32_16x16x32_bf16 v[140:143], v[188:191], v[36:39], v[140:143]
    s_waitcnt lgkmcnt(7)
    v_mfma_f32_16x16x32_bf16 v[136:139], v[192:195], v[40:43], v[136:139]
    v_mfma_f32_16x16x32_bf16 v[140:143], v[196:199], v[40:43], v[140:143]
    s_waitcnt lgkmcnt(6)
    v_mfma_f32_16x16x32_bf16 v[136:139], v[200:203], v[44:47], v[136:139]
    v_mfma_f32_16x16x32_bf16 v[140:143], v[204:207], v[44:47], v[140:143]
    s_waitcnt lgkmcnt(5)
    v_mfma_f32_16x16x32_bf16 v[136:139], v[208:211], v[48:51], v[136:139]
    v_mfma_f32_16x16x32_bf16 v[140:143], v[212:215], v[48:51], v[140:143]
    s_waitcnt lgkmcnt(4)
    v_mfma_f32_16x16x32_bf16 v[136:139], v[216:219], v[52:55], v[136:139]
    v_mfma_f32_16x16x32_bf16 v[140:143], v[220:223], v[52:55], v[140:143]
    s_waitcnt lgkmcnt(3)
    v_mfma_f32_16x16x32_bf16 v[136:139], v[224:227], v[56:59], v[136:139]
    v_mfma_f32_16x16x32_bf16 v[140:143], v[228:231], v[56:59], v[140:143]
    s_waitcnt lgkmcnt(2)
    v_mfma_f32_16x16x32_bf16 v[136:139], v[232:235], v[60:63], v[136:139]
    v_mfma_f32_16x16x32_bf16 v[140:143], v[236:239], v[60:63], v[140:143]
    s_waitcnt lgkmcnt(1)
    v_mfma_f32_16x16x32_bf16 v[136:139], v[240:243], v[64:67], v[136:139]
    v_mfma_f32_16x16x32_bf16 v[140:143], v[244:247], v[64:67], v[140:143]
    s_waitcnt lgkmcnt(0)
    v_mfma_f32_16x16x32_bf16 v[136:139], v[248:251], v[68:71], v[136:139]
    v_mfma_f32_16x16x32_bf16 v[140:143], v[252:255], v[68:71], v[140:143]
    s_waitcnt vmcnt(5)
    v_max3_u32 v5, v88, v92, v96
    v_max3_u32 v5, v5, v100, v128
    v_cmp_eq_u32 vcc, -1, v5
    s_cbranch_vccz P3_G
    s_sub_u32 s60, s75, 131072
    s_max_u32 s60, s60, 89128960
    s_mov_b32 s61, 0
    s_cmp_lt_u32 s65, 126
    s_cselect_b32 s60, s75, s60
    s_cmp_lg_u32 s3, 0
    s_cbranch_scc1 P3_W3
P3_W1:
    buffer_load_dword v5, off, s[36:39], s60 sc1
    s_add_u32 s61, s61, 1
    s_waitcnt vmcnt(0)
    v_cmp_eq_u32 vcc, -1, v5
    s_cbranch_vccz P3_W3
    s_cmp_lt_u32 s61, 200000
    s_cbranch_scc1 P3_W1
P3_FAIL:
    v_mov_b32 v1, 512
    v_mov_b32 v2, 224
    global_atomic_or v2, v1, s[32:33] sc1
    s_waitcnt vmcnt(0)
    s_endpgm
P3_G:
    s_barrier
    s_branch P3_KM
P3_W3:
    s_waitcnt vmcnt(0)
    s_barrier
P3_W2:
    buffer_load_dwordx4 v[88:91], v2, s[36:39], s75 offen offset:0 sc1
    buffer_load_dwordx4 v[92:95], v2, s[36:39], s75 offen offset:512 sc1
    buffer_load_dwordx4 v[96:99], v2, s[36:39], s75 offen offset:1024 sc1
    buffer_load_dwordx4 v[100:103], v2, s[36:39], s75 offen offset:1536 sc1
    buffer_load_dwordx4 v[128:131], v1, s[36:39], s58 offen offset:2048 sc1
    s_add_u32 s61, s61, 1
    s_cmp_lt_u32 s61, 200000
    s_cbranch_scc0 P3_FAIL
    s_waitcnt vmcnt(0)
    v_max3_u32 v5, v88, v92, v96
    v_max3_u32 v5, v5, v100, v128
    v_cmp_eq_u32 vcc, -1, v5
    s_cbranch_vccnz P3_W2
P3_KM:
    v_mfma_f32_16x16x32_bf16 v[132:135], v[88:91], v[72:75], 0
    v_mfma_f32_16x16x32_bf16 v[132:135], v[92:95], v[76:79], v[132:135]
    v_mfma_f32_16x16x32_bf16 v[132:135], v[96:99], v[80:83], v[132:135]
    v_mfma_f32_16x16x32_bf16 v[132:135], v[100:103], v[84:87], v[132:135]
    s_add_u32 s63, s74, s72
    s_lshl_b32 s60, s66, 12
    s_lshl_b32 s61, s67, 11
    s_add_u32 s58, s60, s61
    s_add_u32 s60, s58, s63
    s_nop 3
    v_max3_f32 v5, v10, v132, v133
    v_mov_b32 v6, v5
    s_nop 1
    v_permlane16_swap_b32 v5, v6
    s_nop 1
    v_max_f32 v5, v5, v6
    v_mov_b32 v6, v5
    s_nop 1
    v_permlane32_swap_b32 v5, v6
    s_nop 1
    v_max_f32 v5, v5, v6
    v_mul_f32 v5, s69, v5
    v_fma_f32 v120, v120, s69, -v5
    v_fma_f32 v121, v121, s69, -v5
    v_fma_f32 v122, v122, s69, -v5
    v_fma_f32 v123, v123, s69, -v5
    v_fma_f32 v124, v124, s69, -v5
    v_fma_f32 v125, v125, s69, -v5
    v_fma_f32 v126, v126, s69, -v5
    v_fma_f32 v127, v127, s69, -v5
    v_fma_f32 v132, v132, s69, -v5
    v_fma_f32 v133, v133, s69, -v5
    v_exp_f32 v120, v120
    v_exp_f32 v121, v121
    v_exp_f32 v122, v122
    v_exp_f32 v123, v123
    v_exp_f32 v124, v124
    v_exp_f32 v125, v125
    v_exp_f32 v126, v126
    v_exp_f32 v127, v127
    v_exp_f32 v132, v132
    v_exp_f32 v133, v133
    v_add_f32 v5, v120, v121
    v_add_f32 v5, v5, v122
    v_add_f32 v5, v5, v123
    v_add_f32 v5, v5, v124
    v_add_f32 v5, v5, v125
    v_add_f32 v5, v5, v126
    v_add_f32 v5, v5, v127
    v_add_f32 v5, v5, v132
    v_add_f32 v5, v5, v133
    v_mov_b32 v6, v5
    s_nop 1
    v_permlane16_swap_b32 v5, v6
    s_nop 1
    v_add_f32 v5, v5, v6
    v_mov_b32 v6, v5
    s_nop 1
    v_permlane32_swap_b32 v5, v6
    s_nop 1
    v_add_f32 v5, v5, v6
    v_rcp_f32 v5, v5
    s_nop 0
    v_mul_f32 v120, v120, v5
    v_mul_f32 v121, v121, v5
    v_mul_f32 v122, v122, v5
    v_mul_f32 v123, v123, v5
    v_mul_f32 v124, v124, v5
    v_mul_f32 v125, v125, v5
    v_mul_f32 v126, v126, v5
    v_mul_f32 v127, v127, v5
    v_mul_f32 v132, v132, v5
    v_mul_f32 v133, v133, v5
    v_cvt_pk_bf16_f32 v80, v120, v121
    v_cvt_pk_bf16_f32 v81, v122, v123
    v_cvt_pk_bf16_f32 v82, v124, v125
    v_cvt_pk_bf16_f32 v83, v126, v127
    v_cvt_pk_bf16_f32 v10, v132, v133
    v_cvt_pk_bf16_f32 v13, v132, v133
    s_nop 1
    v_mfma_f32_16x16x32_bf16 v[88:91], v[104:107], v[80:83], 0
    v_mfma_f32_16x16x32_bf16 v[92:95], v[108:111], v[80:83], 0
    v_mfma_f32_16x16x32_bf16 v[96:99], v[112:115], v[80:83], 0
    v_mfma_f32_16x16x32_bf16 v[100:103], v[116:119], v[80:83], 0
    v_mfma_f32_16x16x16_bf16 v[88:91], v[128:129], v[10:11], v[88:91]
    v_mfma_f32_16x16x16_bf16 v[92:95], v[128:129], v[12:13], v[92:95]
    v_mfma_f32_16x16x16_bf16 v[96:99], v[130:131], v[10:11], v[96:99]
    v_mfma_f32_16x16x16_bf16 v[100:103], v[130:131], v[12:13], v[100:103]
    s_nop 7
    v_cvt_pk_bf16_f32 v72, v88, v92
    v_cvt_pk_bf16_f32 v73, v89, v93
    v_cvt_pk_bf16_f32 v74, v90, v94
    v_cvt_pk_bf16_f32 v75, v91, v95
    v_cvt_pk_bf16_f32 v76, v96, v100
    v_cvt_pk_bf16_f32 v77, v97, v101
    v_cvt_pk_bf16_f32 v78, v98, v102
    v_cvt_pk_bf16_f32 v79, v99, v103
    s_cmp_eq_u32 s71, 0
    s_cbranch_scc1 SA_36
    buffer_store_dwordx4 v[72:75], v1, s[36:39], s60 offen offset:0
    buffer_store_dwordx4 v[76:79], v1, s[36:39], s60 offen offset:1024
    s_branch SB_37
SA_36:
    buffer_store_dwordx4 v[72:75], v1, s[36:39], s60 offen offset:0 sc1
    buffer_store_dwordx4 v[76:79], v1, s[36:39], s60 offen offset:1024 sc1
SB_37:
    s_lshl_b32 s60, s3, 15
    s_add_u32 s63, s60, s63
    s_mov_b32 s60, s63
    s_mov_b32 s61, 0
    v_and_b32 v6, 0xf0, v1
    v_lshlrev_b32 v6, 7, v6
    buffer_load_dword v6, v6, s[36:39], s63 offen offset:2032 sc1
    s_branch P3_GE
P3_GL:
    v_and_b32 v6, 0xf0, v1
    v_lshlrev_b32 v6, 7, v6
    buffer_load_dword v6, v6, s[36:39], s63 offen offset:2032 sc1
    s_add_u32 s61, s61, 1
    s_cmp_lt_u32 s61, 200000
    s_cbranch_scc0 P3_FAIL
P3_GE:
    s_waitcnt vmcnt(0)
    v_cmp_eq_u32 vcc, -1, v6
    s_nop 3
    s_and_b32 s78, vcc_lo, 0xffff
    s_bcnt1_i32_b32 s78, s78
    s_cmp_gt_u32 s78, 4
    s_cbranch_scc1 P3_GL
    buffer_load_dwordx4 v[72:75], v1, s[36:39], s60 offen offset:0 sc1
    buffer_load_dwordx4 v[76:79], v1, s[36:39], s60 offen offset:1024 sc1
    buffer_load_dwordx4 v[80:83], v1, s[36:39], s60 offen offset:2048 sc1
    buffer_load_dwordx4 v[84:87], v1, s[36:39], s60 offen offset:3072 sc1
    s_add_u32 s60, s60, 4096
    buffer_load_dwordx4 v[88:91], v1, s[36:39], s60 offen offset:0 sc1
    buffer_load_dwordx4 v[92:95], v1, s[36:39], s60 offen offset:1024 sc1
    buffer_load_dwordx4 v[96:99], v1, s[36:39], s60 offen offset:2048 sc1
    buffer_load_dwordx4 v[100:103], v1, s[36:39], s60 offen offset:3072 sc1
    s_add_u32 s60, s60, 4096
    buffer_load_dwordx4 v[104:107], v1, s[36:39], s60 offen offset:0 sc1
    buffer_load_dwordx4 v[108:111], v1, s[36:39], s60 offen offset:1024 sc1
    buffer_load_dwordx4 v[112:115], v1, s[36:39], s60 offen offset:2048 sc1
    buffer_load_dwordx4 v[116:119], v1, s[36:39], s60 offen offset:3072 sc1
    s_add_u32 s60, s60, 4096
    buffer_load_dwordx4 v[120:123], v1, s[36:39], s60 offen offset:0 sc1
    buffer_load_dwordx4 v[124:127], v1, s[36:39], s60 offen offset:1024 sc1
    buffer_load_dwordx4 v[16:19], v1, s[36:39], s60 offen offset:2048 sc1
    buffer_load_dwordx4 v[20:23], v1, s[36:39], s60 offen offset:3072 sc1
    s_add_u32 s60, s60, 4096
    buffer_load_dwordx4 v[24:27], v1, s[36:39], s60 offen offset:0 sc1
    buffer_load_dwordx4 v[28:31], v1, s[36:39], s60 offen offset:1024 sc1
    buffer_load_dwordx4 v[32:35], v1, s[36:39], s60 offen offset:2048 sc1
    buffer_load_dwordx4 v[36:39], v1, s[36:39], s60 offen offset:3072 sc1
    s_add_u32 s60, s60, 4096
    buffer_load_dwordx4 v[40:43], v1, s[36:39], s60 offen offset:0 sc1
    buffer_load_dwordx4 v[44:47], v1, s[36:39], s60 offen offset:1024 sc1
    buffer_load_dwordx4 v[48:51], v1, s[36:39], s60 offen offset:2048 sc1
    buffer_load_dwordx4 v[52:55], v1, s[36:39], s60 offen offset:3072 sc1
    s_add_u32 s60, s60, 4096
    buffer_load_dwordx4 v[56:59], v1, s[36:39], s60 offen offset:0 sc1
    buffer_load_dwordx4 v[60:63], v1, s[36:39], s60 offen offset:1024 sc1
    buffer_load_dwordx4 v[64:67], v1, s[36:39], s60 offen offset:2048 sc1
    buffer_load_dwordx4 v[68:71], v1, s[36:39], s60 offen offset:3072 sc1
    s_add_u32 s60, s60, 4096
    s_mov_b32 s78, 0
    v_mov_b64 v[128:129], 0
    v_mov_b64 v[130:131], 0
    v_mov_b64 v[132:133], 0
    v_mov_b64 v[134:135], 0
    s_waitcnt vmcnt(26)
    v_max_u32 v5, v72, v76
    v_cmp_eq_u32 vcc, -1, v5
    s_cbranch_vccnz P3_OR0
    v_mfma_f32_16x16x32_bf16 v[128:131], a[0:3], v[72:75], v[128:131]
    v_mfma_f32_16x16x32_bf16 v[132:135], a[4:7], v[72:75], v[132:135]
    v_mfma_f32_16x16x32_bf16 v[128:131], a[8:11], v[76:79], v[128:131]
    v_mfma_f32_16x16x32_bf16 v[132:135], a[12:15], v[76:79], v[132:135]
    s_add_u32 s59, s63, 28672
    buffer_load_dwordx4 v[72:75], v1, s[36:39], s59 offen offset:0 sc1
    buffer_load_dwordx4 v[76:79], v1, s[36:39], s59 offen offset:1024 sc1
P3_NX0:
    s_waitcnt vmcnt(26)
    v_max_u32 v5, v80, v84
    v_cmp_eq_u32 vcc, -1, v5
    s_cbranch_vccnz P3_OR2
    v_mfma_f32_16x16x32_bf16 v[128:131], a[16:19], v[80:83], v[128:131]
    v_mfma_f32_16x16x32_bf16 v[132:135], a[20:23], v[80:83], v[132:135]
    v_mfma_f32_16x16x32_bf16 v[128:131], a[24:27], v[84:87], v[128:131]
    v_mfma_f32_16x16x32_bf16 v[132:135], a[28:31], v[84:87], v[132:135]
    s_add_u32 s59, s63, 28672
    buffer_load_dwordx4 v[80:83], v1, s[36:39], s59 offen offset:2048 sc1
    buffer_load_dwordx4 v[84:87], v1, s[36:39], s59 offen offset:3072 sc1
P3_NX2:
    s_waitcnt vmcnt(26)
    v_max_u32 v5, v88, v92
    v_cmp_eq_u32 vcc, -1, v5
    s_cbranch_vccnz P3_OR4
    v_mfma_f32_16x16x32_bf16 v[128:131], a[32:35], v[88:91], v[128:131]
    v_mfma_f32_16x16x32_bf16 v[132:135], a[36:39], v[88:91], v[132:135]
    v_mfma_f32_16x16x32_bf16 v[128:131], a[40:43], v[92:95], v[128:131]
    v_mfma_f32_16x16x32_bf16 v[132:135], a[44:47], v[92:95], v[132:135]
P3_NX4:
    s_waitcnt vmcnt(24)
    v_max_u32 v5, v96, v100
    v_cmp_eq_u32 vcc, -1, v5
    s_cbranch_vccnz P3_OR6
    v_mfma_f32_16x16x32_bf16 v[128:131], a[48:51], v[96:99], v[128:131]
    v_mfma_f32_16x16x32_bf16 v[132:135], a[52:55], v[96:99], v[132:135]
    v_mfma_f32_16x16x32_bf16 v[128:131], a[56:59], v[100:103], v[128:131]
    v_mfma_f32_16x16x32_bf16 v[132:135], a[60:63], v[100:103], v[132:135]
P3_NX6:
    s_waitcnt vmcnt(22)
    v_max_u32 v5, v104, v108
    v_cmp_eq_u32 vcc, -1, v5
    s_cbranch_vccnz P3_OR8
    v_mfma_f32_16x16x32_bf16 v[128:131], a[64:67], v[104:107], v[128:131]
    v_mfma_f32_16x16x32_bf16 v[132:135], a[68:71], v[104:107], v[132:135]
    v_mfma_f32_16x16x32_bf16 v[128:131], a[72:75], v[108:111], v[128:131]
    v_mfma_f32_16x16x32_bf16 v[132:135], a[76:79], v[108:111], v[132:135]
P3_NX8:
    s_waitcnt vmcnt(20)
    v_max_u32 v5, v112, v116
    v_cmp_eq_u32 vcc, -1, v5
    s_cbranch_vccnz P3_OR10
    v_mfma_f32_16x16x32_bf16 v[128:131], a[80:83], v[112:115], v[128:131]
    v_mfma_f32_16x16x32_bf16 v[132:135], a[84:87], v[112:115], v[132:135]
    v_mfma_f32_16x16x32_bf16 v[128:131], a[88:91], v[116:119], v[128:131]
    v_mfma_f32_16x16x32_bf16 v[132:135], a[92:95], v[116:119], v[132:135]
P3_NX10:
    s_waitcnt vmcnt(18)
    v_max_u32 v5, v120, v124
    v_cmp_eq_u32 vcc, -1, v5
    s_cbranch_vccnz P3_OR12
    v_mfma_f32_16x16x32_bf16 v[128:131], a[96:99], v[120:123], v[128:131]
    v_mfma_f32_16x16x32_bf16 v[132:135], a[100:103], v[120:123], v[132:135]
    v_mfma_f32_16x16x32_bf16 v[128:131], a[104:107], v[124:127], v[128:131]
    v_mfma_f32_16x16x32_bf16 v[132:135], a[108:111], v[124:127], v[132:135]
P3_NX12:
    s_waitcnt vmcnt(16)
    v_max_u32 v5, v16, v20
    v_cmp_eq_u32 vcc, -1, v5
    s_cbranch_vccnz P3_OR14
    v_mfma_f32_16x16x32_bf16 v[128:131], a[112:115], v[16:19], v[128:131]
    v_mfma_f32_16x16x32_bf16 v[132:135], a[116:119], v[16:19], v[132:135]
    v_mfma_f32_16x16x32_bf16 v[128:131], a[120:123], v[20:23], v[128:131]
    v_mfma_f32_16x16x32_bf16 v[132:135], a[124:127], v[20:23], v[132:135]
P3_NX14:
    s_waitcnt vmcnt(14)
    v_max_u32 v5, v24, v28
    v_cmp_eq_u32 vcc, -1, v5
    s_cbranch_vccnz P3_OR16
    v_mfma_f32_16x16x32_bf16 v[128:131], a[128:131], v[24:27], v[128:131]
    v_mfma_f32_16x16x32_bf16 v[132:135], a[132:135], v[24:27], v[132:135]
    v_mfma_f32_16x16x32_bf16 v[128:131], a[136:139], v[28:31], v[128:131]
    v_mfma_f32_16x16x32_bf16 v[132:135], a[140:143], v[28:31], v[132:135]
P3_NX16:
    s_waitcnt vmcnt(12)
    v_max_u32 v5, v32, v36
    v_cmp_eq_u32 vcc, -1, v5
    s_cbranch_vccnz P3_OR18
    v_mfma_f32_16x16x32_bf16 v[128:131], a[144:147], v[32:35], v[128:131]
    v_mfma_f32_16x16x32_bf16 v[132:135], a[148:151], v[32:35], v[132:135]
    v_mfma_f32_16x16x32_bf16 v[128:131], a[152:155], v[36:39], v[128:131]
    v_mfma_f32_16x16x32_bf16 v[132:135], a[156:159], v[36:39], v[132:135]
P3_NX18:
    s_waitcnt vmcnt(10)
    v_max_u32 v5, v40, v44
    v_cmp_eq_u32 vcc, -1, v5
    s_cbranch_vccnz P3_OR20
    v_mfma_f32_16x16x32_bf16 v[128:131], a[160:163], v[40:43], v[128:131]
    v_mfma_f32_16x16x32_bf16 v[132:135], a[164:167], v[40:43], v[132:135]
    v_mfma_f32_16x16x32_bf16 v[128:131], a[168:171], v[44:47], v[128:131]
    v_mfma_f32_16x16x32_bf16 v[132:135], a[172:175], v[44:47], v[132:135]
P3_NX20:
    s_waitcnt vmcnt(8)
    v_max_u32 v5, v48, v52
    v_cmp_eq_u32 vcc, -1, v5
    s_cbranch_vccnz P3_OR22
    v_mfma_f32_16x16x32_bf16 v[128:131], a[176:179], v[48:51], v[128:131]
    v_mfma_f32_16x16x32_bf16 v[132:135], a[180:183], v[48:51], v[132:135]
    v_mfma_f32_16x16x32_bf16 v[128:131], a[184:187], v[52:55], v[128:131]
    v_mfma_f32_16x16x32_bf16 v[132:135], a[188:191], v[52:55], v[132:135]
P3_NX22:
    s_waitcnt vmcnt(6)
    v_max_u32 v5, v56, v60
    v_cmp_eq_u32 vcc, -1, v5
    s_cbranch_vccnz P3_OR24
    v_mfma_f32_16x16x32_bf16 v[128:131], a[192:195], v[56:59], v[128:131]
    v_mfma_f32_16x16x32_bf16 v[132:135], a[196:199], v[56:59], v[132:135]
    v_mfma_f32_16x16x32_bf16 v[128:131], a[200:203], v[60:63], v[128:131]
    v_mfma_f32_16x16x32_bf16 v[132:135], a[204:207], v[60:63], v[132:135]
P3_NX24:
    s_waitcnt vmcnt(4)
    v_max_u32 v5, v64, v68
    v_cmp_eq_u32 vcc, -1, v5
    s_cbranch_vccnz P3_OR26
    v_mfma_f32_16x16x32_bf16 v[128:131], a[208:211], v[64:67], v[128:131]
    v_mfma_f32_16x16x32_bf16 v[132:135], a[212:215], v[64:67], v[132:135]
    v_mfma_f32_16x16x32_bf16 v[128:131], a[216:219], v[68:71], v[128:131]
    v_mfma_f32_16x16x32_bf16 v[132:135], a[220:223], v[68:71], v[132:135]
P3_NX26:
    s_bitcmp1_b32 s78, 0
    s_cbranch_scc1 P3_NX28
    s_waitcnt vmcnt(2)
    v_max_u32 v5, v72, v76
    v_cmp_eq_u32 vcc, -1, v5
    s_cbranch_vccnz P3_OR28
    v_mfma_f32_16x16x32_bf16 v[128:131], a[224:227], v[72:75], v[128:131]
    v_mfma_f32_16x16x32_bf16 v[132:135], a[228:231], v[72:75], v[132:135]
    v_mfma_f32_16x16x32_bf16 v[128:131], a[232:235], v[76:79], v[128:131]
    v_mfma_f32_16x16x32_bf16 v[132:135], a[236:239], v[76:79], v[132:135]
P3_NX28:
    s_bitcmp1_b32 s78, 1
    s_cbranch_scc1 P3_NX30
    s_waitcnt vmcnt(0)
    v_max_u32 v5, v80, v84
    v_cmp_eq_u32 vcc, -1, v5
    s_cbranch_vccnz P3_OR30
    v_mfma_f32_16x16x32_bf16 v[128:131], a[240:243], v[80:83], v[128:131]
    v_mfma_f32_16x16x32_bf16 v[132:135], a[244:247], v[80:83], v[132:135]
    v_mfma_f32_16x16x32_bf16 v[128:131], a[248:251], v[84:87], v[128:131]
    v_mfma_f32_16x16x32_bf16 v[132:135], a[252:255], v[84:87], v[132:135]
P3_NX30:
P3_RR:
    s_cmp_eq_u32 s78, 0
    s_cbranch_scc1 P3_RD
    s_add_u32 s61, s61, 1
    s_cmp_lt_u32 s61, 200000
    s_cbranch_scc0 P3_FAIL
    s_waitcnt vmcnt(0)
    s_bitcmp1_b32 s78, 15
    s_cbranch_scc0 P3_RN30
    v_max_u32 v5, v80, v84
    v_cmp_eq_u32 vcc, -1, v5
    s_cbranch_vccz P3_RM30
    s_add_u32 s59, s63, 28672
    buffer_load_dwordx4 v[80:83], v1, s[36:39], s59 offen offset:2048 sc1
    buffer_load_dwordx4 v[84:87], v1, s[36:39], s59 offen offset:3072 sc1
    s_branch P3_RN30
P3_RM30:
    s_bitset0_b32 s78, 15
    v_mfma_f32_16x16x32_bf16 v[128:131], a[240:243], v[80:83], v[128:131]
    v_mfma_f32_16x16x32_bf16 v[132:135], a[244:247], v[80:83], v[132:135]
    v_mfma_f32_16x16x32_bf16 v[128:131], a[248:251], v[84:87], v[128:131]
    v_mfma_f32_16x16x32_bf16 v[132:135], a[252:255], v[84:87], v[132:135]
P3_RN30:
    s_bitcmp1_b32 s78, 14
    s_cbranch_scc0 P3_RN28
    v_max_u32 v5, v72, v76
    v_cmp_eq_u32 vcc, -1, v5
    s_cbranch_vccz P3_RM28
    s_add_u32 s59, s63, 28672
    buffer_load_dwordx4 v[72:75], v1, s[36:39], s59 offen offset:0 sc1
    buffer_load_dwordx4 v[76:79], v1, s[36:39], s59 offen offset:1024 sc1
    s_branch P3_RN28
P3_RM28:
    s_bitset0_b32 s78, 14
    v_mfma_f32_16x16x32_bf16 v[128:131], a[224:227], v[72:75], v[128:131]
    v_mfma_f32_16x16x32_bf16 v[132:135], a[228:231], v[72:75], v[132:135]
    v_mfma_f32_16x16x32_bf16 v[128:131], a[232:235], v[76:79], v[128:131]
    v_mfma_f32_16x16x32_bf16 v[132:135], a[236:239], v[76:79], v[132:135]
P3_RN28:
    s_bitcmp1_b32 s78, 13
    s_cbranch_scc0 P3_RN26
    v_max_u32 v5, v64, v68
    v_cmp_eq_u32 vcc, -1, v5
    s_cbranch_vccz P3_RM26
    s_add_u32 s59, s63, 24576
    buffer_load_dwordx4 v[64:67], v1, s[36:39], s59 offen offset:2048 sc1
    buffer_load_dwordx4 v[68:71], v1, s[36:39], s59 offen offset:3072 sc1
    s_branch P3_RN26
P3_RM26:
    s_bitset0_b32 s78, 13
    v_mfma_f32_16x16x32_bf16 v[128:131], a[208:211], v[64:67], v[128:131]
    v_mfma_f32_16x16x32_bf16 v[132:135], a[212:215], v[64:67], v[132:135]
    v_mfma_f32_16x16x32_bf16 v[128:131], a[216:219], v[68:71], v[128:131]
    v_mfma_f32_16x16x32_bf16 v[132:135], a[220:223], v[68:71], v[132:135]
P3_RN26:
    s_bitcmp1_b32 s78, 12
    s_cbranch_scc0 P3_RN24
    v_max_u32 v5, v56, v60
    v_cmp_eq_u32 vcc, -1, v5
    s_cbranch_vccz P3_RM24
    s_add_u32 s59, s63, 24576
    buffer_load_dwordx4 v[56:59], v1, s[36:39], s59 offen offset:0 sc1
    buffer_load_dwordx4 v[60:63], v1, s[36:39], s59 offen offset:1024 sc1
    s_branch P3_RN24
P3_RM24:
    s_bitset0_b32 s78, 12
    v_mfma_f32_16x16x32_bf16 v[128:131], a[192:195], v[56:59], v[128:131]
    v_mfma_f32_16x16x32_bf16 v[132:135], a[196:199], v[56:59], v[132:135]
    v_mfma_f32_16x16x32_bf16 v[128:131], a[200:203], v[60:63], v[128:131]
    v_mfma_f32_16x16x32_bf16 v[132:135], a[204:207], v[60:63], v[132:135]
P3_RN24:
    s_bitcmp1_b32 s78, 11
    s_cbranch_scc0 P3_RN22
    v_max_u32 v5, v48, v52
    v_cmp_eq_u32 vcc, -1, v5
    s_cbranch_vccz P3_RM22
    s_add_u32 s59, s63, 20480
    buffer_load_dwordx4 v[48:51], v1, s[36:39], s59 offen offset:2048 sc1
    buffer_load_dwordx4 v[52:55], v1, s[36:39], s59 offen offset:3072 sc1
    s_branch P3_RN22
P3_RM22:
    s_bitset0_b32 s78, 11
    v_mfma_f32_16x16x32_bf16 v[128:131], a[176:179], v[48:51], v[128:131]
    v_mfma_f32_16x16x32_bf16 v[132:135], a[180:183], v[48:51], v[132:135]
    v_mfma_f32_16x16x32_bf16 v[128:131], a[184:187], v[52:55], v[128:131]
    v_mfma_f32_16x16x32_bf16 v[132:135], a[188:191], v[52:55], v[132:135]
P3_RN22:
    s_bitcmp1_b32 s78, 10
    s_cbranch_scc0 P3_RN20
    v_max_u32 v5, v40, v44
    v_cmp_eq_u32 vcc, -1, v5
    s_cbranch_vccz P3_RM20
    s_add_u32 s59, s63, 20480
    buffer_load_dwordx4 v[40:43], v1, s[36:39], s59 offen offset:0 sc1
    buffer_load_dwordx4 v[44:47], v1, s[36:39], s59 offen offset:1024 sc1
    s_branch P3_RN20
P3_RM20:
    s_bitset0_b32 s78, 10
    v_mfma_f32_16x16x32_bf16 v[128:131], a[160:163], v[40:43], v[128:131]
    v_mfma_f32_16x16x32_bf16 v[132:135], a[164:167], v[40:43], v[132:135]
    v_mfma_f32_16x16x32_bf16 v[128:131], a[168:171], v[44:47], v[128:131]
    v_mfma_f32_16x16x32_bf16 v[132:135], a[172:175], v[44:47], v[132:135]
P3_RN20:
    s_bitcmp1_b32 s78, 9
    s_cbranch_scc0 P3_RN18
    v_max_u32 v5, v32, v36
    v_cmp_eq_u32 vcc, -1, v5
    s_cbranch_vccz P3_RM18
    s_add_u32 s59, s63, 16384
    buffer_load_dwordx4 v[32:35], v1, s[36:39], s59 offen offset:2048 sc1
    buffer_load_dwordx4 v[36:39], v1, s[36:39], s59 offen offset:3072 sc1
    s_branch P3_RN18
P3_RM18:
    s_bitset0_b32 s78, 9
    v_mfma_f32_16x16x32_bf16 v[128:131], a[144:147], v[32:35], v[128:131]
    v_mfma_f32_16x16x32_bf16 v[132:135], a[148:151], v[32:35], v[132:135]
    v_mfma_f32_16x16x32_bf16 v[128:131], a[152:155], v[36:39], v[128:131]
    v_mfma_f32_16x16x32_bf16 v[132:135], a[156:159], v[36:39], v[132:135]
P3_RN18:
    s_bitcmp1_b32 s78, 8
    s_cbranch_scc0 P3_RN16
    v_max_u32 v5, v24, v28
    v_cmp_eq_u32 vcc, -1, v5
    s_cbranch_vccz P3_RM16
    s_add_u32 s59, s63, 16384
    buffer_load_dwordx4 v[24:27], v1, s[36:39], s59 offen offset:0 sc1
    buffer_load_dwordx4 v[28:31], v1, s[36:39], s59 offen offset:1024 sc1
    s_branch P3_RN16
P3_RM16:
    s_bitset0_b32 s78, 8
    v_mfma_f32_16x16x32_bf16 v[128:131], a[128:131], v[24:27], v[128:131]
    v_mfma_f32_16x16x32_bf16 v[132:135], a[132:135], v[24:27], v[132:135]
    v_mfma_f32_16x16x32_bf16 v[128:131], a[136:139], v[28:31], v[128:131]
    v_mfma_f32_16x16x32_bf16 v[132:135], a[140:143], v[28:31], v[132:135]
P3_RN16:
    s_bitcmp1_b32 s78, 7
    s_cbranch_scc0 P3_RN14
    v_max_u32 v5, v16, v20
    v_cmp_eq_u32 vcc, -1, v5
    s_cbranch_vccz P3_RM14
    s_add_u32 s59, s63, 12288
    buffer_load_dwordx4 v[16:19], v1, s[36:39], s59 offen offset:2048 sc1
    buffer_load_dwordx4 v[20:23], v1, s[36:39], s59 offen offset:3072 sc1
    s_branch P3_RN14
P3_RM14:
    s_bitset0_b32 s78, 7
    v_mfma_f32_16x16x32_bf16 v[128:131], a[112:115], v[16:19], v[128:131]
    v_mfma_f32_16x16x32_bf16 v[132:135], a[116:119], v[16:19], v[132:135]
    v_mfma_f32_16x16x32_bf16 v[128:131], a[120:123], v[20:23], v[128:131]
    v_mfma_f32_16x16x32_bf16 v[132:135], a[124:127], v[20:23], v[132:135]
P3_RN14:
    s_bitcmp1_b32 s78, 6
    s_cbranch_scc0 P3_RN12
    v_max_u32 v5, v120, v124
    v_cmp_eq_u32 vcc, -1, v5
    s_cbranch_vccz P3_RM12
    s_add_u32 s59, s63, 12288
    buffer_load_dwordx4 v[120:123], v1, s[36:39], s59 offen offset:0 sc1
    buffer_load_dwordx4 v[124:127], v1, s[36:39], s59 offen offset:1024 sc1
    s_branch P3_RN12
P3_RM12:
    s_bitset0_b32 s78, 6
    v_mfma_f32_16x16x32_bf16 v[128:131], a[96:99], v[120:123], v[128:131]
    v_mfma_f32_16x16x32_bf16 v[132:135], a[100:103], v[120:123], v[132:135]
    v_mfma_f32_16x16x32_bf16 v[128:131], a[104:107], v[124:127], v[128:131]
    v_mfma_f32_16x16x32_bf16 v[132:135], a[108:111], v[124:127], v[132:135]
P3_RN12:
    s_bitcmp1_b32 s78, 5
    s_cbranch_scc0 P3_RN10
    v_max_u32 v5, v112, v116
    v_cmp_eq_u32 vcc, -1, v5
    s_cbranch_vccz P3_RM10
    s_add_u32 s59, s63, 8192
    buffer_load_dwordx4 v[112:115], v1, s[36:39], s59 offen offset:2048 sc1
    buffer_load_dwordx4 v[116:119], v1, s[36:39], s59 offen offset:3072 sc1
    s_branch P3_RN10
P3_RM10:
    s_bitset0_b32 s78, 5
    v_mfma_f32_16x16x32_bf16 v[128:131], a[80:83], v[112:115], v[128:131]
    v_mfma_f32_16x16x32_bf16 v[132:135], a[84:87], v[112:115], v[132:135]
    v_mfma_f32_16x16x32_bf16 v[128:131], a[88:91], v[116:119], v[128:131]
    v_mfma_f32_16x16x32_bf16 v[132:135], a[92:95], v[116:119], v[132:135]
P3_RN10:
    s_bitcmp1_b32 s78, 4
    s_cbranch_scc0 P3_RN8
    v_max_u32 v5, v104, v108
    v_cmp_eq_u32 vcc, -1, v5
    s_cbranch_vccz P3_RM8
    s_add_u32 s59, s63, 8192
    buffer_load_dwordx4 v[104:107], v1, s[36:39], s59 offen offset:0 sc1
    buffer_load_dwordx4 v[108:111], v1, s[36:39], s59 offen offset:1024 sc1
    s_branch P3_RN8
P3_RM8:
    s_bitset0_b32 s78, 4
    v_mfma_f32_16x16x32_bf16 v[128:131], a[64:67], v[104:107], v[128:131]
    v_mfma_f32_16x16x32_bf16 v[132:135], a[68:71], v[104:107], v[132:135]
    v_mfma_f32_16x16x32_bf16 v[128:131], a[72:75], v[108:111], v[128:131]
    v_mfma_f32_16x16x32_bf16 v[132:135], a[76:79], v[108:111], v[132:135]
P3_RN8:
    s_bitcmp1_b32 s78, 3
    s_cbranch_scc0 P3_RN6
    v_max_u32 v5, v96, v100
    v_cmp_eq_u32 vcc, -1, v5
    s_cbranch_vccz P3_RM6
    s_add_u32 s59, s63, 4096
    buffer_load_dwordx4 v[96:99], v1, s[36:39], s59 offen offset:2048 sc1
    buffer_load_dwordx4 v[100:103], v1, s[36:39], s59 offen offset:3072 sc1
    s_branch P3_RN6
P3_RM6:
    s_bitset0_b32 s78, 3
    v_mfma_f32_16x16x32_bf16 v[128:131], a[48:51], v[96:99], v[128:131]
    v_mfma_f32_16x16x32_bf16 v[132:135], a[52:55], v[96:99], v[132:135]
    v_mfma_f32_16x16x32_bf16 v[128:131], a[56:59], v[100:103], v[128:131]
    v_mfma_f32_16x16x32_bf16 v[132:135], a[60:63], v[100:103], v[132:135]
P3_RN6:
    s_bitcmp1_b32 s78, 2
    s_cbranch_scc0 P3_RN4
    v_max_u32 v5, v88, v92
    v_cmp_eq_u32 vcc, -1, v5
    s_cbranch_vccz P3_RM4
    s_add_u32 s59, s63, 4096
    buffer_load_dwordx4 v[88:91], v1, s[36:39], s59 offen offset:0 sc1
    buffer_load_dwordx4 v[92:95], v1, s[36:39], s59 offen offset:1024 sc1
    s_branch P3_RN4
P3_RM4:
    s_bitset0_b32 s78, 2
    v_mfma_f32_16x16x32_bf16 v[128:131], a[32:35], v[88:91], v[128:131]
    v_mfma_f32_16x16x32_bf16 v[132:135], a[36:39], v[88:91], v[132:135]
    v_mfma_f32_16x16x32_bf16 v[128:131], a[40:43], v[92:95], v[128:131]
    v_mfma_f32_16x16x32_bf16 v[132:135], a[44:47], v[92:95], v[132:135]
P3_RN4:
    s_bitcmp1_b32 s78, 1
    s_cbranch_scc0 P3_RN2
    v_max_u32 v5, v80, v84
    v_cmp_eq_u32 vcc, -1, v5
    s_cbranch_vccz P3_RM2
    s_add_u32 s59, s63, 0
    buffer_load_dwordx4 v[80:83], v1, s[36:39], s59 offen offset:2048 sc1
    buffer_load_dwordx4 v[84:87], v1, s[36:39], s59 offen offset:3072 sc1
    s_branch P3_RN2
P3_RM2:
    s_bitset0_b32 s78, 1
    v_mfma_f32_16x16x32_bf16 v[128:131], a[16:19], v[80:83], v[128:131]
    v_mfma_f32_16x16x32_bf16 v[132:135], a[20:23], v[80:83], v[132:135]
    v_mfma_f32_16x16x32_bf16 v[128:131], a[24:27], v[84:87], v[128:131]
    v_mfma_f32_16x16x32_bf16 v[132:135], a[28:31], v[84:87], v[132:135]
    s_add_u32 s59, s63, 28672
    buffer_load_dwordx4 v[80:83], v1, s[36:39], s59 offen offset:2048 sc1
    buffer_load_dwordx4 v[84:87], v1, s[36:39], s59 offen offset:3072 sc1
    s_bitset1_b32 s78, 15
P3_RN2:
    s_bitcmp1_b32 s78, 0
    s_cbranch_scc0 P3_RN0
    v_max_u32 v5, v72, v76
    v_cmp_eq_u32 vcc, -1, v5
    s_cbranch_vccz P3_RM0
    s_add_u32 s59, s63, 0
    buffer_load_dwordx4 v[72:75], v1, s[36:39], s59 offen offset:0 sc1
    buffer_load_dwordx4 v[76:79], v1, s[36:39], s59 offen offset:1024 sc1
    s_branch P3_RN0
P3_RM0:
    s_bitset0_b32 s78, 0
    v_mfma_f32_16x16x32_bf16 v[128:131], a[0:3], v[72:75], v[128:131]
    v_mfma_f32_16x16x32_bf16 v[132:135], a[4:7], v[72:75], v[132:135]
    v_mfma_f32_16x16x32_bf16 v[128:131], a[8:11], v[76:79], v[128:131]
    v_mfma_f32_16x16x32_bf16 v[132:135], a[12:15], v[76:79], v[132:135]
    s_add_u32 s59, s63, 28672
    buffer_load_dwordx4 v[72:75], v1, s[36:39], s59 offen offset:0 sc1
    buffer_load_dwordx4 v[76:79], v1, s[36:39], s59 offen offset:1024 sc1
    s_bitset1_b32 s78, 14
P3_RN0:
    s_branch P3_RR
P3_RD:
    s_add_u32 s72, s72, 131072
    s_cmp_eq_u32 s72, 393216
    s_cselect_b32 s72, 0, s72
    s_add_u32 s60, s72, 131072
    s_cmp_eq_u32 s60, 393216
    s_cselect_b32 s60, 0, s60
    s_add_u32 s60, s60, s74
    s_add_u32 s58, s58, s60
    v_mov_b32 v88, -1
    v_mov_b32 v89, -1
    v_mov_b32 v90, -1
    v_mov_b32 v91, -1
    s_lshl_b32 s77, s65, 14
    s_add_u32 s65, s65, 12
    s_cmp_ge_u32 s65, 128
    s_cbranch_scc1 P3_NOST
    s_cmp_eq_u32 s71, 0
    s_cbranch_scc1 SA_38
    buffer_store_dwordx4 v[88:91], v1, s[36:39], s58 offen offset:0
    buffer_store_dwordx4 v[88:91], v1, s[36:39], s58 offen offset:1024
    s_branch SB_39
SA_38:
    buffer_store_dwordx4 v[88:91], v1, s[36:39], s58 offen offset:0 sc1
    buffer_store_dwordx4 v[88:91], v1, s[36:39], s58 offen offset:1024 sc1
SB_39:
    s_lshr_b32 s62, s65, 1
    s_lshl_b32 s62, s62, 5
    s_add_u32 s62, s62, s66
    s_mul_i32 s60, s65, 57344
    s_mul_i32 s61, s3, 14336
    s_add_u32 s60, s60, s61
    s_add_u32 s60, s60, 53477376
    s_and_b32 s61, s65, 1
    s_lshl_b32 s59, s62, 1
    s_add_u32 s59, s59, s61
    s_lshl_b32 s59, s59, 12
    s_add_u32 s59, s59, 36700160
    s_lshl_b32 s63, s62, 14
    s_add_u32 s63, s63, 2097152
    s_add_u32 m0, s73, 14336
    s_nop 0
    buffer_load_dwordx4 v1, s[36:39], s59 offen offset:0 lds
    buffer_load_dwordx4 v1, s[36:39], s59 offen offset:1024 lds
    buffer_load_dwordx4 v1, s[36:39], s59 offen offset:2048 lds
    buffer_load_dwordx4 v1, s[36:39], s59 offen offset:3072 lds
    s_add_u32 m0, s73, 18432
    s_nop 0
    buffer_load_dwordx4 v1, s[36:39], s63 offen offset:0 lds
    buffer_load_dwordx4 v1, s[36:39], s63 offen offset:1024 lds
    buffer_load_dwordx4 v1, s[36:39], s63 offen offset:2048 lds
    buffer_load_dwordx4 v1, s[36:39], s63 offen offset:3072 lds
    s_add_u32 s59, s63, 4096
    s_add_u32 m0, s73, 22528
    s_nop 0
    buffer_load_dwordx4 v1, s[36:39], s59 offen offset:0 lds
    buffer_load_dwordx4 v1, s[36:39], s59 offen offset:1024 lds
    buffer_load_dwordx4 v1, s[36:39], s59 offen offset:2048 lds
    buffer_load_dwordx4 v1, s[36:39], s59 offen offset:3072 lds
    s_lshl_b32 s59, s67, 12
    s_add_u32 s59, s59, s63
    s_add_u32 s59, s59, 8192
    s_add_u32 m0, s73, 26624
    s_nop 0
    buffer_load_dwordx4 v1, s[36:39], s59 offen offset:0 lds
    buffer_load_dwordx4 v1, s[36:39], s59 offen offset:1024 lds
    buffer_load_dwordx4 v1, s[36:39], s59 offen offset:2048 lds
    buffer_load_dwordx4 v1, s[36:39], s59 offen offset:3072 lds
    s_add_u32 m0, s73, 0
    s_nop 0
    buffer_load_dwordx4 v1, s[36:39], s60 offen offset:0 lds
    buffer_load_dwordx4 v1, s[36:39], s60 offen offset:1024 lds
    buffer_load_dwordx4 v1, s[36:39], s60 offen offset:2048 lds
    buffer_load_dwordx4 v1, s[36:39], s60 offen offset:3072 lds
    s_add_u32 s60, s60, 4096
    s_add_u32 m0, s73, 4096
    s_nop 0
    buffer_load_dwordx4 v1, s[36:39], s60 offen offset:0 lds
    buffer_load_dwordx4 v1, s[36:39], s60 offen offset:1024 lds
    buffer_load_dwordx4 v1, s[36:39], s60 offen offset:2048 lds
    buffer_load_dwordx4 v1, s[36:39], s60 offen offset:3072 lds
    s_add_u32 s60, s60, 4096
    s_add_u32 m0, s73, 8192
    s_nop 0
    buffer_load_dwordx4 v1, s[36:39], s60 offen offset:0 lds
    buffer_load_dwordx4 v1, s[36:39], s60 offen offset:1024 lds
    buffer_load_dwordx4 v1, s[36:39], s60 offen offset:2048 lds
    buffer_load_dwordx4 v1, s[36:39], s60 offen offset:3072 lds
    s_add_u32 s60, s60, 4096
    s_add_u32 m0, s73, 12288
    s_nop 0
    buffer_load_dwordx4 v1, s[36:39], s60 offen offset:0 lds
    buffer_load_dwordx4 v1, s[36:39], s60 offen offset:1024 lds
P3_NOST:
    s_lshl_b32 s60, s3, 12
    s_add_u32 s60, s60, s68
    s_add_u32 s60, s60, 122880
    v_add_u32 v5, s60, v1
    v_add_u32 v6, s68, v9
    ds_write_b128 v5, v[136:139] offset:2048
    ds_write_b128 v5, v[140:143] offset:3072
    s_nop 3
    ds_write_b128 v5, v[128:131] offset:0
    ds_write_b128 v5, v[132:135] offset:1024
    s_waitcnt lgkmcnt(0)
    s_barrier
    ds_read_b32 v16, v6 offset:0
    ds_read_b32 v17, v6 offset:1024
    ds_read_b32 v18, v6 offset:2048
    ds_read_b32 v19, v6 offset:3072
    ds_read_b32 v20, v6 offset:4096
    ds_read_b32 v21, v6 offset:5120
    ds_read_b32 v22, v6 offset:6144
    ds_read_b32 v23, v6 offset:7168
    s_waitcnt lgkmcnt(1)
    ds_read_b32 v24, v6 offset:8192
    ds_read_b32 v25, v6 offset:9216
    ds_read_b32 v26, v6 offset:10240
    ds_read_b32 v27, v6 offset:11264
    ds_read_b32 v28, v6 offset:12288
    ds_read_b32 v29, v6 offset:13312
    ds_read_b32 v30, v6 offset:14336
    ds_read_b32 v31, v6 offset:15360
    s_xor_b32 s68, s68, 16384
    s_waitcnt lgkmcnt(0)
    v_add_f32 v16, v16, v20
    v_add_f32 v24, v24, v28
    v_add_f32 v17, v17, v21
    v_add_f32 v25, v25, v29
    v_add_f32 v18, v18, v22
    v_add_f32 v26, v26, v30
    v_add_f32 v19, v19, v23
    v_add_f32 v27, v27, v31
    v_add_f32 v16, v16, v24
    v_add_f32 v17, v17, v25
    v_add_f32 v18, v18, v26
    v_add_f32 v19, v19, v27
    v_cvt_pk_bf16_f32 v5, v16, v17
    v_lshlrev_b32 v16, 16, v5
    v_and_b32 v17, 0xffff0000, v5
    v_cvt_pk_bf16_f32 v5, v18, v19
    v_lshlrev_b32 v18, 16, v5
    v_and_b32 v19, 0xffff0000, v5
    v_lshlrev_b32 v20, 16, v8
    v_and_b32 v21, 0xffff0000, v8
    v_add_f32 v16, v16, v20
    v_add_f32 v17, v17, v21
    v_cvt_pk_bf16_f32 v5, v16, v17
    v_lshlrev_b32 v16, 16, v5
    v_and_b32 v17, 0xffff0000, v5
    v_add_f32 v16, v16, v18
    v_add_f32 v17, v17, v19
    v_cvt_pk_bf16_f32 v5, v16, v17
    buffer_store_dword v5, v4, s[48:51], s77 offen
    s_cmp_lt_u32 s65, 128
    s_cbranch_scc1 P3_TOP
    s_branch P3_END
P3_OR0:
    s_add_u32 s59, s63, 0
    buffer_load_dwordx4 v[72:75], v1, s[36:39], s59 offen offset:0 sc1
    buffer_load_dwordx4 v[76:79], v1, s[36:39], s59 offen offset:1024 sc1
    s_bitset1_b32 s78, 0
    s_branch P3_NX0
P3_OR2:
    s_add_u32 s59, s63, 0
    buffer_load_dwordx4 v[80:83], v1, s[36:39], s59 offen offset:2048 sc1
    buffer_load_dwordx4 v[84:87], v1, s[36:39], s59 offen offset:3072 sc1
    s_bitset1_b32 s78, 1
    s_branch P3_NX2
P3_OR4:
    s_add_u32 s59, s63, 4096
    buffer_load_dwordx4 v[88:91], v1, s[36:39], s59 offen offset:0 sc1
    buffer_load_dwordx4 v[92:95], v1, s[36:39], s59 offen offset:1024 sc1
    s_bitset1_b32 s78, 2
    s_branch P3_NX4
P3_OR6:
    s_add_u32 s59, s63, 4096
    buffer_load_dwordx4 v[96:99], v1, s[36:39], s59 offen offset:2048 sc1
    buffer_load_dwordx4 v[100:103], v1, s[36:39], s59 offen offset:3072 sc1
    s_bitset1_b32 s78, 3
    s_branch P3_NX6
P3_OR8:
    s_add_u32 s59, s63, 8192
    buffer_load_dwordx4 v[104:107], v1, s[36:39], s59 offen offset:0 sc1
    buffer_load_dwordx4 v[108:111], v1, s[36:39], s59 offen offset:1024 sc1
    s_bitset1_b32 s78, 4
    s_branch P3_NX8
P3_OR10:
    s_add_u32 s59, s63, 8192
    buffer_load_dwordx4 v[112:115], v1, s[36:39], s59 offen offset:2048 sc1
    buffer_load_dwordx4 v[116:119], v1, s[36:39], s59 offen offset:3072 sc1
    s_bitset1_b32 s78, 5
    s_branch P3_NX10
P3_OR12:
    s_add_u32 s59, s63, 12288
    buffer_load_dwordx4 v[120:123], v1, s[36:39], s59 offen offset:0 sc1
    buffer_load_dwordx4 v[124:127], v1, s[36:39], s59 offen offset:1024 sc1
    s_bitset1_b32 s78, 6
    s_branch P3_NX12
P3_OR14:
    s_add_u32 s59, s63, 12288
    buffer_load_dwordx4 v[16:19], v1, s[36:39], s59 offen offset:2048 sc1
    buffer_load_dwordx4 v[20:23], v1, s[36:39], s59 offen offset:3072 sc1
    s_bitset1_b32 s78, 7
    s_branch P3_NX14
P3_OR16:
    s_add_u32 s59, s63, 16384
    buffer_load_dwordx4 v[24:27], v1, s[36:39], s59 offen offset:0 sc1
    buffer_load_dwordx4 v[28:31], v1, s[36:39], s59 offen offset:1024 sc1
    s_bitset1_b32 s78, 8
    s_branch P3_NX16
P3_OR18:
    s_add_u32 s59, s63, 16384
    buffer_load_dwordx4 v[32:35], v1, s[36:39], s59 offen offset:2048 sc1
    buffer_load_dwordx4 v[36:39], v1, s[36:39], s59 offen offset:3072 sc1
    s_bitset1_b32 s78, 9
    s_branch P3_NX18
P3_OR20:
    s_add_u32 s59, s63, 20480
    buffer_load_dwordx4 v[40:43], v1, s[36:39], s59 offen offset:0 sc1
    buffer_load_dwordx4 v[44:47], v1, s[36:39], s59 offen offset:1024 sc1
    s_bitset1_b32 s78, 10
    s_branch P3_NX20
P3_OR22:
    s_add_u32 s59, s63, 20480
    buffer_load_dwordx4 v[48:51], v1, s[36:39], s59 offen offset:2048 sc1
    buffer_load_dwordx4 v[52:55], v1, s[36:39], s59 offen offset:3072 sc1
    s_bitset1_b32 s78, 11
    s_branch P3_NX22
P3_OR24:
    s_add_u32 s59, s63, 24576
    buffer_load_dwordx4 v[56:59], v1, s[36:39], s59 offen offset:0 sc1
    buffer_load_dwordx4 v[60:63], v1, s[36:39], s59 offen offset:1024 sc1
    s_bitset1_b32 s78, 12
    s_branch P3_NX24
P3_OR26:
    s_add_u32 s59, s63, 24576
    buffer_load_dwordx4 v[64:67], v1, s[36:39], s59 offen offset:2048 sc1
    buffer_load_dwordx4 v[68:71], v1, s[36:39], s59 offen offset:3072 sc1
    s_bitset1_b32 s78, 13
    s_branch P3_NX26
P3_OR28:
    s_add_u32 s59, s63, 28672
    buffer_load_dwordx4 v[72:75], v1, s[36:39], s59 offen offset:0 sc1
    buffer_load_dwordx4 v[76:79], v1, s[36:39], s59 offen offset:1024 sc1
    s_bitset1_b32 s78, 14
    s_branch P3_NX28
P3_OR30:
    s_add_u32 s59, s63, 28672
    buffer_load_dwordx4 v[80:83], v1, s[36:39], s59 offen offset:2048 sc1
    buffer_load_dwordx4 v[84:87], v1, s[36:39], s59 offen offset:3072 sc1
    s_bitset1_b32 s78, 15
    s_branch P3_NX30
P3_END:
    s_waitcnt vmcnt(0)
    s_endpgm
REC_ENTRY:
    s_mov_b32 s64, s4
    s_barrier
    v_lshlrev_b32 v1, 4, v0
    v_lshrrev_b32 v20, 4, v0
    v_and_b32 v21, 15, v0
    v_bfe_u32 v22, v0, 1, 1
    v_cmp_eq_u32 s[72:73], 1, v22
    v_mov_b32 v23, 0x4444
    v_mov_b32 v24, 0xeeee
    s_mul_i32 s60, s3, 36864
    v_cndmask_b32 v2, v23, v24, s[72:73]
    s_add_u32 s60, s60, 16384
    v_add_u32 v3, s60, v1
    s_add_u32 s82, s60, 32768
    s_lshl_b32 s81, s3, 11
    v_mul_u32_u24 v23, 576, v20
    v_lshl_add_u32 v23, v21, 2, v23
    s_lshl_b32 s61, s3, 6
    s_add_u32 s61, s61, 10240
    v_add_u32 v4, s61, v23
    v_lshrrev_b32 v23, 2, v21
    v_and_b32 v24, 1, v0
    v_lshl_add_u32 v25, v23, 1, v24
    v_mul_u32_u24 v25, 288, v25
    v_lshl_add_u32 v25, v20, 4, v25
    v_add_u32 v5, 10240, v25
    v_xor_b32 v23, v23, v22
    v_lshl_add_u32 v25, v23, 1, v24
    v_mul_u32_u24 v25, 288, v25
    v_lshl_add_u32 v25, v20, 4, v25
    v_add_u32 v6, 10240, v25
    s_lshr_b32 s61, s3, 1
    s_lshl_b32 s61, s61, 10
    s_and_b32 s62, s3, 1
    s_lshl_b32 s62, s62, 3
    s_add_u32 s61, s61, s62
    s_add_u32 s61, s61, 8192
    v_add_u32 v7, s61, v1
    v_lshrrev_b32 v23, 2, v0
    v_lshlrev_b32 v23, 11, v23
    v_and_b32 v24, 3, v0
    v_lshl_add_u32 v8, v24, 4, v23
    s_xor_b32 s61, s3, 1
    s_sub_i32 s61, s61, s3
    s_mul_i32 s78, s61, 36864
    s_xor_b32 s61, s3, 2
    s_sub_i32 s61, s61, s3
    s_mul_i32 s79, s61, 36864
    s_xor_b32 s61, s3, 3
    s_sub_i32 s61, s61, s3
    s_mul_i32 s80, s61, 36864
    v_lshrrev_b32 v23, 1, v20
    v_and_b32 v25, 1, v20
    v_and_b32 v26, 2, v0
    v_add_u32 v26, v26, v23
    v_lshlrev_b32 v26, 4, v26
    v_and_b32 v27, 1, v0
    v_lshl_add_u32 v26, v27, 3, v26
    v_lshl_add_u32 v26, v25, 2, v26
    v_cmp_gt_u32 vcc, 4, v21
    v_mov_b32 v27, 0x40000000
    s_nop 0
    v_cndmask_b32 v9, v27, v26, vcc
    s_lshl_b32 s60, s64, 2
    s_add_u32 s60, s60, s3
    s_lshl_b32 s61, s60, 11
    s_add_u32 s68, s61, 85983232
    s_lshr_b32 s61, s60, 4
    s_bfe_u32 s62, s60, 0x20002
    s_and_b32 s63, s60, 3
    s_lshl_b32 s76, s61, 10
    s_lshl_b32 s58, s63, 8
    s_add_u32 s76, s76, s58
    s_lshl_b32 s58, s62, 6
    s_add_u32 s76, s76, s58
    s_add_u32 s76, s76, 84934656
    s_lshr_b32 s58, s61, 1
    s_lshl_b32 s58, s58, 8
    s_and_b32 s61, s61, 1
    s_lshl_b32 s61, s61, 3
    s_add_u32 s58, s58, s61
    s_lshl_b32 s63, s63, 6
    s_add_u32 s58, s58, s63
    s_lshl_b32 s62, s62, 11
    s_add_u32 s58, s58, s62
    v_lshlrev_b32 v26, 10, v23
    v_lshl_add_u32 v26, v24, 4, v26
    v_lshl_add_u32 v26, v25, 2, v26
    s_mov_b32 s40, s10
    s_mov_b32 s41, s11
    s_mov_b32 s42, 8192
    s_mov_b32 s43, 0x00020000
    buffer_load_dword v28, v26, s[40:43], s58 offen
    v_mov_b32 v32, -1
    v_mov_b32 v33, -1
    v_mov_b32 v34, -1
    v_mov_b32 v35, -1
    buffer_store_dwordx4 v[32:35], v1, s[36:39], s68 offen offset:0 sc1
    buffer_store_dwordx4 v[32:35], v1, s[36:39], s68 offen offset:1024 sc1
    s_xor_b32 s60, s76, 8192
    buffer_store_dword v32, v9, s[36:39], s60 offen sc1
    v_lshrrev_b32 v13, 5, v0
    v_bfe_u32 v14, v0, 4, 1
    v_and_b32 v15, 15, v0
    v_lshrrev_b32 v10, 4, v0
    v_lshlrev_b32 v12, 18, v13
    v_lshl_add_u32 v12, v14, 16, v12
    v_lshlrev_b32 v16, 2, v10
    v_sub_u32 v16, v15, v16
    v_and_b32 v16, 15, v16
    v_lshl_add_u32 v12, v16, 4, v12
    s_lshl_b32 s60, s64, 8
    v_add_u32 v12, s60, v12
    v_lshlrev_b32 v11, 13, v13
    v_lshl_add_u32 v11, v14, 12, v11
    v_lshl_add_u32 v11, v15, 4, v11
    s_lshl_b32 s60, s64, 17
    s_lshl_b32 s61, s3, 8
    s_add_u32 s60, s60, s61
    v_add_u32 v11, s60, v11
    v_add_u32 v16, s3, v10
    v_and_b32 v16, 3, v16
    v_lshlrev_b32 v16, 6, v16
    v_lshl_add_u32 v16, v10, 8, v16
    v_lshl_add_u32 v16, v15, 2, v16
    s_lshl_b32 s88, s3, 12
    s_xor_b32 s84, s3, 0
    s_lshl_b32 s60, s84, 12
    s_lshl_b32 s84, s84, 20
    v_add_u32 v10, s60, v16
    s_xor_b32 s85, s3, 1
    s_lshl_b32 s60, s85, 12
    s_lshl_b32 s85, s85, 20
    v_add_u32 v13, s60, v16
    s_xor_b32 s86, s3, 2
    s_lshl_b32 s60, s86, 12
    s_lshl_b32 s86, s86, 20
    v_add_u32 v14, s60, v16
    s_xor_b32 s87, s3, 3
    s_lshl_b32 s60, s87, 12
    s_lshl_b32 s87, s87, 20
    v_add_u32 v15, s60, v16
    s_mov_b32 s40, s12
    s_mov_b32 s41, s13
    s_mov_b32 s42, 4194304
    s_mov_b32 s43, 0x00020000
    s_mov_b32 s44, s14
    s_mov_b32 s45, s15
    s_mov_b32 s46, 4194304
    s_mov_b32 s47, 0x00020000
    s_mov_b32 s48, s16
    s_mov_b32 s49, s17
    s_mov_b32 s50, 4194304
    s_mov_b32 s51, 0x00020000
    s_mov_b32 s52, s18
    s_mov_b32 s53, s19
    s_mov_b32 s54, 4194304
    s_mov_b32 s55, 0x00020000
    s_add_u32 m0, s88, 0
    s_add_u32 s60, s84, 0
    buffer_load_dwordx4 v12, s[40:43], s60 offen offset:0 lds
    s_add_u32 s60, s84, 7168
    buffer_load_dwordx4 v12, s[40:43], s60 offen offset:1024 lds
    s_add_u32 s60, s84, 129024
    buffer_load_dwordx4 v12, s[40:43], s60 offen offset:2048 lds
    s_add_u32 s60, s84, 136192
    buffer_load_dwordx4 v12, s[40:43], s60 offen offset:3072 lds
    s_lshr_b32 s60, s84, 5
    s_add_u32 s60, s60, 0
    buffer_load_dwordx4 v[32:35], v11, s[52:55], s60 offen
    s_lshr_b32 s60, s84, 5
    s_add_u32 s60, s60, 1024
    buffer_load_dwordx4 v[36:39], v11, s[52:55], s60 offen
    s_lshr_b32 s60, s84, 5
    s_add_u32 s60, s60, 2048
    buffer_load_dwordx4 v[40:43], v11, s[52:55], s60 offen
    s_lshr_b32 s60, s84, 5
    s_add_u32 s60, s60, 3072
    buffer_load_dwordx4 v[44:47], v11, s[52:55], s60 offen
    s_add_u32 m0, s88, 36864
    s_add_u32 s60, s84, 16384
    buffer_load_dwordx4 v12, s[40:43], s60 offen offset:0 lds
    s_add_u32 s60, s84, 23552
    buffer_load_dwordx4 v12, s[40:43], s60 offen offset:1024 lds
    s_add_u32 s60, s84, 145408
    buffer_load_dwordx4 v12, s[40:43], s60 offen offset:2048 lds
    s_add_u32 s60, s84, 152576
    buffer_load_dwordx4 v12, s[40:43], s60 offen offset:3072 lds
    s_add_u32 m0, s88, 73728
    s_add_u32 s60, s84, 524288
    buffer_load_dwordx4 v12, s[40:43], s60 offen offset:0 lds
    s_add_u32 s60, s84, 531456
    buffer_load_dwordx4 v12, s[40:43], s60 offen offset:1024 lds
    s_add_u32 s60, s84, 653312
    buffer_load_dwordx4 v12, s[40:43], s60 offen offset:2048 lds
    s_add_u32 s60, s84, 660480
    buffer_load_dwordx4 v12, s[40:43], s60 offen offset:3072 lds
    s_add_u32 m0, s88, 110592
    s_add_u32 s60, s84, 540672
    buffer_load_dwordx4 v12, s[40:43], s60 offen offset:0 lds
    s_add_u32 s60, s84, 547840
    buffer_load_dwordx4 v12, s[40:43], s60 offen offset:1024 lds
    s_add_u32 s60, s84, 669696
    buffer_load_dwordx4 v12, s[40:43], s60 offen offset:2048 lds
    s_add_u32 s60, s84, 676864
    buffer_load_dwordx4 v12, s[40:43], s60 offen offset:3072 lds
    s_waitcnt vmcnt(23)
    v_min_u32 v28, -2, v28
    buffer_store_dword v28, v9, s[36:39], s76 offen sc1
    s_mov_b32 s65, 0
    s_mov_b32 s77, 0x3e0293ee
    s_lshl_b32 s60, s3, 11
    s_add_u32 s66, s60, 84934656
    s_lshl_b32 s61, s64, 6
    s_lshl_b32 s62, s3, 16
    s_add_u32 s61, s61, s62
    s_add_u32 s67, s61, 85983232
    s_add_u32 s69, s61, 86016000
    s_mov_b32 s8, 0
    s_lshl_b32 s61, s3, 7
    s_add_u32 s61, s61, 12544
    s_lshl_b32 s62, s3, 10
    s_add_u32 s62, s62, 8192
    s_cmp_lt_u32 s3, 2
    s_cselect_b32 s9, s61, s62
    s_cselect_b32 s10, 288, 64
    s_cselect_b32 s11, 64, 512
    s_lshl_b32 s61, s64, 14
    s_add_u32 s61, s61, s60
    s_add_u32 s71, s61, 2097152
    s_mul_i32 s61, s64, 4096
    s_lshl_b32 s62, s3, 10
    s_add_u32 s61, s61, s62
    s_add_u32 s70, s61, 88997888
    s_lshl_b32 s61, s64, 4
    s_add_u32 s74, s61, 87031808
    s_add_u32 s83, s61, 87064064
    v_mov_b32 v174, 0
    v_bfe_u32 v16, v0, 0, 1
    v_lshl_add_u32 v174, v16, 7, v174
    v_bfe_u32 v16, v0, 1, 1
    v_lshl_add_u32 v174, v16, 16, v174
    v_bfe_u32 v16, v0, 2, 1
    v_lshl_add_u32 v174, v16, 18, v174
    v_bfe_u32 v16, v0, 3, 1
    v_lshl_add_u32 v174, v16, 13, v174
    v_bfe_u32 v16, v0, 4, 1
    v_lshl_add_u32 v174, v16, 17, v174
    v_bfe_u32 v16, v0, 5, 1
    v_lshl_add_u32 v174, v16, 20, v174
    s_and_b32 s60, s64, 28
    s_lshl_b32 s60, s60, 8
    s_and_b32 s61, s3, 1
    s_lshl_b32 s61, s61, 21
    s_add_u32 s60, s60, s61
    s_add_u32 s60, s60, 256
    v_add_u32 v174, s60, v174
    s_add_u32 s89, s64, 2
    s_and_b32 s89, s89, 3
    s_lshl_b32 s60, s89, 1
    s_lshr_b32 s89, s3, 1
    s_add_u32 s89, s89, s60
    s_cmp_eq_u32 s64, 31
    s_cselect_b32 s89, 7, s89
    s_cmp_lg_u32 s89, 0
    s_cbranch_scc1 HT_40
    s_mov_b32 s60, 32768
    buffer_load_dword v175, v174, s[40:43], s60 offen
HT_40:
    s_cmp_lg_u32 s89, 1
    s_cbranch_scc1 HT_41
    s_mov_b32 s60, 49152
    buffer_load_dword v175, v174, s[40:43], s60 offen
HT_41:
    s_waitcnt vmcnt(17)
    s_barrier
    ds_read2st64_b32 v[16:17], v10 offset0:0 offset1:4
    ds_read2st64_b32 v[18:19], v10 offset0:8 offset1:12
    ds_read2st64_b32 v[20:21], v13 offset0:0 offset1:4
    ds_read2st64_b32 v[22:23], v13 offset0:8 offset1:12
    ds_read2st64_b32 v[24:25], v14 offset0:0 offset1:4
    ds_read2st64_b32 v[26:27], v14 offset0:8 offset1:12
    ds_read2st64_b32 v[28:29], v15 offset0:0 offset1:4
    ds_read2st64_b32 v[30:31], v15 offset0:8 offset1:12
    s_lshr_b32 s60, s84, 5
    s_add_u32 s60, s60, 16384
    buffer_load_dwordx4 v[48:51], v11, s[52:55], s60 offen
    s_lshr_b32 s60, s84, 5
    s_add_u32 s60, s60, 17408
    buffer_load_dwordx4 v[52:55], v11, s[52:55], s60 offen
    s_lshr_b32 s60, s84, 5
    s_add_u32 s60, s60, 18432
    buffer_load_dwordx4 v[56:59], v11, s[52:55], s60 offen
    s_lshr_b32 s60, s84, 5
    s_add_u32 s60, s60, 19456
    buffer_load_dwordx4 v[60:63], v11, s[52:55], s60 offen
    s_add_u32 m0, s88, 147456
    s_add_u32 s60, s84, 32768
    buffer_load_dwordx4 v12, s[40:43], s60 offen offset:0 lds
    s_add_u32 s60, s84, 39936
    buffer_load_dwordx4 v12, s[40:43], s60 offen offset:1024 lds
    s_add_u32 s60, s84, 161792
    buffer_load_dwordx4 v12, s[40:43], s60 offen offset:2048 lds
    s_add_u32 s60, s84, 168960
    buffer_load_dwordx4 v12, s[40:43], s60 offen offset:3072 lds
    s_waitcnt lgkmcnt(6)
    v_add_u32 v10, 36864, v10
    v_perm_b32 v64, v17, v16, s56
    v_perm_b32 v65, v19, v18, s56
    ds_write_b64 v3, v[64:65] offset:0
    v_perm_b32 v66, v17, v16, s57
    v_perm_b32 v67, v19, v18, s57
    ds_write_b64 v3, v[66:67] offset:2048
    s_waitcnt lgkmcnt(6)
    v_add_u32 v13, 36864, v13
    v_perm_b32 v68, v21, v20, s56
    v_perm_b32 v69, v23, v22, s56
    v_accvgpr_write_b32 a0, v68
    v_accvgpr_write_b32 a1, v69
    v_perm_b32 v70, v21, v20, s57
    v_perm_b32 v71, v23, v22, s57
    v_accvgpr_write_b32 a8, v70
    v_accvgpr_write_b32 a9, v71
    s_waitcnt lgkmcnt(4)
    v_add_u32 v14, 36864, v14
    v_perm_b32 v72, v25, v24, s56
    v_perm_b32 v73, v27, v26, s56
    v_accvgpr_write_b32 a32, v72
    v_accvgpr_write_b32 a33, v73
    v_perm_b32 v74, v25, v24, s57
    v_perm_b32 v75, v27, v26, s57
    v_accvgpr_write_b32 a40, v74
    v_accvgpr_write_b32 a41, v75
    s_waitcnt lgkmcnt(2)
    v_add_u32 v15, 36864, v15
    v_perm_b32 v76, v29, v28, s56
    v_perm_b32 v77, v31, v30, s56
    v_accvgpr_write_b32 a64, v76
    v_accvgpr_write_b32 a65, v77
    v_perm_b32 v78, v29, v28, s57
    v_perm_b32 v79, v31, v30, s57
    v_accvgpr_write_b32 a72, v78
    v_accvgpr_write_b32 a73, v79
    s_waitcnt lgkmcnt(0)
    s_waitcnt vmcnt(17)
    s_barrier
    ds_read2st64_b32 v[16:17], v10 offset0:0 offset1:4
    ds_read2st64_b32 v[18:19], v10 offset0:8 offset1:12
    ds_read2st64_b32 v[20:21], v13 offset0:0 offset1:4
    ds_read2st64_b32 v[22:23], v13 offset0:8 offset1:12
    ds_read2st64_b32 v[24:25], v14 offset0:0 offset1:4
    ds_read2st64_b32 v[26:27], v14 offset0:8 offset1:12
    ds_read2st64_b32 v[28:29], v15 offset0:0 offset1:4
    ds_read2st64_b32 v[30:31], v15 offset0:8 offset1:12
    s_cmp_lg_u32 s89, 2
    s_cbranch_scc1 HT_42
    s_mov_b32 s60, 573440
    buffer_load_dword v175, v174, s[40:43], s60 offen
HT_42:
    s_add_u32 m0, s88, 0
    s_add_u32 s60, s84, 49152
    buffer_load_dwordx4 v12, s[40:43], s60 offen offset:0 lds
    s_add_u32 s60, s84, 56320
    buffer_load_dwordx4 v12, s[40:43], s60 offen offset:1024 lds
    s_add_u32 s60, s84, 178176
    buffer_load_dwordx4 v12, s[40:43], s60 offen offset:2048 lds
    s_add_u32 s60, s84, 185344
    buffer_load_dwordx4 v12, s[40:43], s60 offen offset:3072 lds
    s_waitcnt lgkmcnt(6)
    v_add_u32 v10, 36864, v10
    v_perm_b32 v64, v17, v16, s56
    v_perm_b32 v65, v19, v18, s56
    ds_write_b64 v3, v[64:65] offset:8
    v_perm_b32 v66, v17, v16, s57
    v_perm_b32 v67, v19, v18, s57
    ds_write_b64 v3, v[66:67] offset:2056
    s_waitcnt lgkmcnt(6)
    v_add_u32 v13, 36864, v13
    v_perm_b32 v68, v21, v20, s56
    v_perm_b32 v69, v23, v22, s56
    v_accvgpr_write_b32 a2, v68
    v_accvgpr_write_b32 a3, v69
    v_perm_b32 v70, v21, v20, s57
    v_perm_b32 v71, v23, v22, s57
    v_accvgpr_write_b32 a10, v70
    v_accvgpr_write_b32 a11, v71
    s_waitcnt lgkmcnt(4)
    v_add_u32 v14, 36864, v14
    v_perm_b32 v72, v25, v24, s56
    v_perm_b32 v73, v27, v26, s56
    v_accvgpr_write_b32 a34, v72
    v_accvgpr_write_b32 a35, v73
    v_perm_b32 v74, v25, v24, s57
    v_perm_b32 v75, v27, v26, s57
    v_accvgpr_write_b32 a42, v74
    v_accvgpr_write_b32 a43, v75
    s_waitcnt lgkmcnt(2)
    v_add_u32 v15, 36864, v15
    v_perm_b32 v76, v29, v28, s56
    v_perm_b32 v77, v31, v30, s56
    v_accvgpr_write_b32 a66, v76
    v_accvgpr_write_b32 a67, v77
    v_perm_b32 v78, v29, v28, s57
    v_perm_b32 v79, v31, v30, s57
    v_accvgpr_write_b32 a74, v78
    v_accvgpr_write_b32 a75, v79
    v_perm_b32 v176, v36, v32, s56
    v_perm_b32 v177, v36, v32, s57
    v_perm_b32 v208, v37, v33, s56
    v_perm_b32 v209, v37, v33, s57
    v_perm_b32 v240, v38, v34, s56
    v_perm_b32 v241, v38, v34, s57
    v_perm_b32 v248, v39, v35, s56
    v_perm_b32 v249, v39, v35, s57
    v_perm_b32 v178, v44, v40, s56
    v_perm_b32 v179, v44, v40, s57
    v_perm_b32 v210, v45, v41, s56
    v_perm_b32 v211, v45, v41, s57
    v_perm_b32 v242, v46, v42, s56
    v_perm_b32 v243, v46, v42, s57
    v_perm_b32 v250, v47, v43, s56
    v_perm_b32 v251, v47, v43, s57
    s_waitcnt lgkmcnt(0)
    s_waitcnt vmcnt(17)
    s_barrier
    ds_read2st64_b32 v[16:17], v10 offset0:0 offset1:4
    ds_read2st64_b32 v[18:19], v10 offset0:8 offset1:12
    ds_read2st64_b32 v[20:21], v13 offset0:0 offset1:4
    ds_read2st64_b32 v[22:23], v13 offset0:8 offset1:12
    ds_read2st64_b32 v[24:25], v14 offset0:0 offset1:4
    ds_read2st64_b32 v[26:27], v14 offset0:8 offset1:12
    ds_read2st64_b32 v[28:29], v15 offset0:0 offset1:4
    ds_read2st64_b32 v[30:31], v15 offset0:8 offset1:12
    s_add_u32 m0, s88, 36864
    s_add_u32 s60, s84, 557056
    buffer_load_dwordx4 v12, s[40:43], s60 offen offset:0 lds
    s_add_u32 s60, s84, 564224
    buffer_load_dwordx4 v12, s[40:43], s60 offen offset:1024 lds
    s_add_u32 s60, s84, 686080
    buffer_load_dwordx4 v12, s[40:43], s60 offen offset:2048 lds
    s_add_u32 s60, s84, 693248
    buffer_load_dwordx4 v12, s[40:43], s60 offen offset:3072 lds
    s_waitcnt lgkmcnt(6)
    v_add_u32 v10, 36864, v10
    v_perm_b32 v64, v17, v16, s56
    v_perm_b32 v65, v19, v18, s56
    ds_write_b64 v3, v[64:65] offset:1024
    v_perm_b32 v66, v17, v16, s57
    v_perm_b32 v67, v19, v18, s57
    ds_write_b64 v3, v[66:67] offset:3072
    s_waitcnt lgkmcnt(6)
    v_add_u32 v13, 36864, v13
    v_perm_b32 v68, v21, v20, s56
    v_perm_b32 v69, v23, v22, s56
    v_accvgpr_write_b32 a4, v68
    v_accvgpr_write_b32 a5, v69
    v_perm_b32 v70, v21, v20, s57
    v_perm_b32 v71, v23, v22, s57
    v_accvgpr_write_b32 a12, v70
    v_accvgpr_write_b32 a13, v71
    s_waitcnt lgkmcnt(4)
    v_add_u32 v14, 36864, v14
    v_perm_b32 v72, v25, v24, s56
    v_perm_b32 v73, v27, v26, s56
    v_accvgpr_write_b32 a36, v72
    v_accvgpr_write_b32 a37, v73
    v_perm_b32 v74, v25, v24, s57
    v_perm_b32 v75, v27, v26, s57
    v_accvgpr_write_b32 a44, v74
    v_accvgpr_write_b32 a45, v75
    s_waitcnt lgkmcnt(2)
    v_add_u32 v15, 36864, v15
    v_perm_b32 v76, v29, v28, s56
    v_perm_b32 v77, v31, v30, s56
    v_accvgpr_write_b32 a68, v76
    v_accvgpr_write_b32 a69, v77
    v_perm_b32 v78, v29, v28, s57
    v_perm_b32 v79, v31, v30, s57
    v_accvgpr_write_b32 a76, v78
    v_accvgpr_write_b32 a77, v79
    s_waitcnt lgkmcnt(0)
    s_waitcnt vmcnt(17)
    s_barrier
    ds_read2st64_b32 v[16:17], v10 offset0:0 offset1:4
    ds_read2st64_b32 v[18:19], v10 offset0:8 offset1:12
    ds_read2st64_b32 v[20:21], v13 offset0:0 offset1:4
    ds_read2st64_b32 v[22:23], v13 offset0:8 offset1:12
    ds_read2st64_b32 v[24:25], v14 offset0:0 offset1:4
    ds_read2st64_b32 v[26:27], v14 offset0:8 offset1:12
    ds_read2st64_b32 v[28:29], v15 offset0:0 offset1:4
    ds_read2st64_b32 v[30:31], v15 offset0:8 offset1:12
    s_cmp_lg_u32 s89, 3
    s_cbranch_scc1 HT_43
    s_mov_b32 s60, 16384
    buffer_load_dword v175, v174, s[44:47], s60 offen
HT_43:
    s_lshr_b32 s60, s85, 5
    s_add_u32 s60, s60, 0
    buffer_load_dwordx4 v[32:35], v11, s[52:55], s60 offen
    s_lshr_b32 s60, s85, 5
    s_add_u32 s60, s60, 1024
    buffer_load_dwordx4 v[36:39], v11, s[52:55], s60 offen
    s_lshr_b32 s60, s85, 5
    s_add_u32 s60, s60, 2048
    buffer_load_dwordx4 v[40:43], v11, s[52:55], s60 offen
    s_lshr_b32 s60, s85, 5
    s_add_u32 s60, s60, 3072
    buffer_load_dwordx4 v[44:47], v11, s[52:55], s60 offen
    s_add_u32 m0, s88, 73728
    s_add_u32 s60, s84, 573440
    buffer_load_dwordx4 v12, s[40:43], s60 offen offset:0 lds
    s_add_u32 s60, s84, 580608
    buffer_load_dwordx4 v12, s[40:43], s60 offen offset:1024 lds
    s_add_u32 s60, s84, 702464
    buffer_load_dwordx4 v12, s[40:43], s60 offen offset:2048 lds
    s_add_u32 s60, s84, 709632
    buffer_load_dwordx4 v12, s[40:43], s60 offen offset:3072 lds
    s_waitcnt lgkmcnt(6)
    v_add_u32 v10, 36864, v10
    v_perm_b32 v64, v17, v16, s56
    v_perm_b32 v65, v19, v18, s56
    ds_write_b64 v3, v[64:65] offset:1032
    v_perm_b32 v66, v17, v16, s57
    v_perm_b32 v67, v19, v18, s57
    ds_write_b64 v3, v[66:67] offset:3080
    s_waitcnt lgkmcnt(6)
    v_add_u32 v13, 36864, v13
    v_perm_b32 v68, v21, v20, s56
    v_perm_b32 v69, v23, v22, s56
    v_accvgpr_write_b32 a6, v68
    v_accvgpr_write_b32 a7, v69
    v_perm_b32 v70, v21, v20, s57
    v_perm_b32 v71, v23, v22, s57
    v_accvgpr_write_b32 a14, v70
    v_accvgpr_write_b32 a15, v71
    s_waitcnt lgkmcnt(4)
    v_add_u32 v14, 36864, v14
    v_perm_b32 v72, v25, v24, s56
    v_perm_b32 v73, v27, v26, s56
    v_accvgpr_write_b32 a38, v72
    v_accvgpr_write_b32 a39, v73
    v_perm_b32 v74, v25, v24, s57
    v_perm_b32 v75, v27, v26, s57
    v_accvgpr_write_b32 a46, v74
    v_accvgpr_write_b32 a47, v75
    s_waitcnt lgkmcnt(2)
    v_add_u32 v15, 36864, v15
    v_perm_b32 v76, v29, v28, s56
    v_perm_b32 v77, v31, v30, s56
    v_accvgpr_write_b32 a70, v76
    v_accvgpr_write_b32 a71, v77
    v_perm_b32 v78, v29, v28, s57
    v_perm_b32 v79, v31, v30, s57
    v_accvgpr_write_b32 a78, v78
    v_accvgpr_write_b32 a79, v79
    s_waitcnt lgkmcnt(0)
    s_waitcnt vmcnt(16)
    s_barrier
    s_cmp_lg_u32 s3, 0
    s_cbranch_scc1 AR_44
    s_add_u32 s60, s20, 65536
    v_mov_b32 v173, 128
    v_mov_b32 v172, s60
    s_mov_b64 exec, 1
    global_atomic_add v173, v172, s[32:33] sc1
    s_mov_b64 exec, -1
AR_44:
    ds_read2st64_b32 v[16:17], v10 offset0:0 offset1:4
    ds_read2st64_b32 v[18:19], v10 offset0:8 offset1:12
    ds_read2st64_b32 v[20:21], v13 offset0:0 offset1:4
    ds_read2st64_b32 v[22:23], v13 offset0:8 offset1:12
    ds_read2st64_b32 v[24:25], v14 offset0:0 offset1:4
    ds_read2st64_b32 v[26:27], v14 offset0:8 offset1:12
    ds_read2st64_b32 v[28:29], v15 offset0:0 offset1:4
    ds_read2st64_b32 v[30:31], v15 offset0:8 offset1:12
    s_cmp_lg_u32 s89, 4
    s_cbranch_scc1 HT_45
    s_mov_b32 s60, 524288
    buffer_load_dword v175, v174, s[44:47], s60 offen
HT_45:
    s_add_u32 m0, s88, 110592
    s_add_u32 s60, s84, 0
    buffer_load_dwordx4 v12, s[44:47], s60 offen offset:0 lds
    s_add_u32 s60, s84, 7168
    buffer_load_dwordx4 v12, s[44:47], s60 offen offset:1024 lds
    s_add_u32 s60, s84, 129024
    buffer_load_dwordx4 v12, s[44:47], s60 offen offset:2048 lds
    s_add_u32 s60, s84, 136192
    buffer_load_dwordx4 v12, s[44:47], s60 offen offset:3072 lds
    s_waitcnt lgkmcnt(6)
    v_add_u32 v10, -147456, v10
    v_perm_b32 v64, v17, v16, s56
    v_perm_b32 v65, v19, v18, s56
    ds_write_b64 v3, v[64:65] offset:4096
    v_perm_b32 v66, v17, v16, s57
    v_perm_b32 v67, v19, v18, s57
    ds_write_b64 v3, v[66:67] offset:6144
    s_waitcnt lgkmcnt(6)
    v_add_u32 v13, -147456, v13
    v_perm_b32 v68, v21, v20, s56
    v_perm_b32 v69, v23, v22, s56
    v_accvgpr_write_b32 a16, v68
    v_accvgpr_write_b32 a17, v69
    v_perm_b32 v70, v21, v20, s57
    v_perm_b32 v71, v23, v22, s57
    v_accvgpr_write_b32 a24, v70
    v_accvgpr_write_b32 a25, v71
    s_waitcnt lgkmcnt(4)
    v_add_u32 v14, -147456, v14
    v_perm_b32 v72, v25, v24, s56
    v_perm_b32 v73, v27, v26, s56
    v_accvgpr_write_b32 a48, v72
    v_accvgpr_write_b32 a49, v73
    v_perm_b32 v74, v25, v24, s57
    v_perm_b32 v75, v27, v26, s57
    v_accvgpr_write_b32 a56, v74
    v_accvgpr_write_b32 a57, v75
    s_waitcnt lgkmcnt(2)
    v_add_u32 v15, -147456, v15
    v_perm_b32 v76, v29, v28, s56
    v_perm_b32 v77, v31, v30, s56
    v_accvgpr_write_b32 a80, v76
    v_accvgpr_write_b32 a81, v77
    v_perm_b32 v78, v29, v28, s57
    v_perm_b32 v79, v31, v30, s57
    v_accvgpr_write_b32 a88, v78
    v_accvgpr_write_b32 a89, v79
    v_perm_b32 v180, v52, v48, s56
    v_perm_b32 v181, v52, v48, s57
    v_perm_b32 v212, v53, v49, s56
    v_perm_b32 v213, v53, v49, s57
    v_perm_b32 v244, v54, v50, s56
    v_perm_b32 v245, v54, v50, s57
    v_perm_b32 v252, v55, v51, s56
    v_perm_b32 v253, v55, v51, s57
    v_perm_b32 v182, v60, v56, s56
    v_perm_b32 v183, v60, v56, s57
    v_perm_b32 v214, v61, v57, s56
    v_perm_b32 v215, v61, v57, s57
    v_perm_b32 v246, v62, v58, s56
    v_perm_b32 v247, v62, v58, s57
    v_perm_b32 v254, v63, v59, s56
    v_perm_b32 v255, v63, v59, s57
    s_waitcnt lgkmcnt(0)
    s_waitcnt vmcnt(16)
    s_barrier
    ds_read2st64_b32 v[16:17], v10 offset0:0 offset1:4
    ds_read2st64_b32 v[18:19], v10 offset0:8 offset1:12
    ds_read2st64_b32 v[20:21], v13 offset0:0 offset1:4
    ds_read2st64_b32 v[22:23], v13 offset0:8 offset1:12
    ds_read2st64_b32 v[24:25], v14 offset0:0 offset1:4
    ds_read2st64_b32 v[26:27], v14 offset0:8 offset1:12
    ds_read2st64_b32 v[28:29], v15 offset0:0 offset1:4
    ds_read2st64_b32 v[30:31], v15 offset0:8 offset1:12
    s_add_u32 m0, s88, 147456
    s_add_u32 s60, s84, 16384
    buffer_load_dwordx4 v12, s[44:47], s60 offen offset:0 lds
    s_add_u32 s60, s84, 23552
    buffer_load_dwordx4 v12, s[44:47], s60 offen offset:1024 lds
    s_add_u32 s60, s84, 145408
    buffer_load_dwordx4 v12, s[44:47], s60 offen offset:2048 lds
    s_add_u32 s60, s84, 152576
    buffer_load_dwordx4 v12, s[44:47], s60 offen offset:3072 lds
    s_waitcnt lgkmcnt(6)
    v_add_u32 v10, 36864, v10
    v_perm_b32 v64, v17, v16, s56
    v_perm_b32 v65, v19, v18, s56
    ds_write_b64 v3, v[64:65] offset:4104
    v_perm_b32 v66, v17, v16, s57
    v_perm_b32 v67, v19, v18, s57
    ds_write_b64 v3, v[66:67] offset:6152
    s_waitcnt lgkmcnt(6)
    v_add_u32 v13, 36864, v13
    v_perm_b32 v68, v21, v20, s56
    v_perm_b32 v69, v23, v22, s56
    v_accvgpr_write_b32 a18, v68
    v_accvgpr_write_b32 a19, v69
    v_perm_b32 v70, v21, v20, s57
    v_perm_b32 v71, v23, v22, s57
    v_accvgpr_write_b32 a26, v70
    v_accvgpr_write_b32 a27, v71
    s_waitcnt lgkmcnt(4)
    v_add_u32 v14, 36864, v14
    v_perm_b32 v72, v25, v24, s56
    v_perm_b32 v73, v27, v26, s56
    v_accvgpr_write_b32 a50, v72
    v_accvgpr_write_b32 a51, v73
    v_perm_b32 v74, v25, v24, s57
    v_perm_b32 v75, v27, v26, s57
    v_accvgpr_write_b32 a58, v74
    v_accvgpr_write_b32 a59, v75
    s_waitcnt lgkmcnt(2)
    v_add_u32 v15, 36864, v15
    v_perm_b32 v76, v29, v28, s56
    v_perm_b32 v77, v31, v30, s56
    v_accvgpr_write_b32 a82, v76
    v_accvgpr_write_b32 a83, v77
    v_perm_b32 v78, v29, v28, s57
    v_perm_b32 v79, v31, v30, s57
    v_accvgpr_write_b32 a90, v78
    v_accvgpr_write_b32 a91, v79
    s_waitcnt lgkmcnt(0)
    s_waitcnt vmcnt(16)
    s_barrier
    ds_read2st64_b32 v[16:17], v10 offset0:0 offset1:4
    ds_read2st64_b32 v[18:19], v10 offset0:8 offset1:12
    ds_read2st64_b32 v[20:21], v13 offset0:0 offset1:4
    ds_read2st64_b32 v[22:23], v13 offset0:8 offset1:12
    ds_read2st64_b32 v[24:25], v14 offset0:0 offset1:4
    ds_read2st64_b32 v[26:27], v14 offset0:8 offset1:12
    ds_read2st64_b32 v[28:29], v15 offset0:0 offset1:4
    ds_read2st64_b32 v[30:31], v15 offset0:8 offset1:12
    s_cmp_lg_u32 s89, 5
    s_cbranch_scc1 HT_46
    s_mov_b32 s60, 32768
    buffer_load_dword v175, v174, s[44:47], s60 offen
HT_46:
    s_lshr_b32 s60, s85, 5
    s_add_u32 s60, s60, 16384
    buffer_load_dwordx4 v[48:51], v11, s[52:55], s60 offen
    s_lshr_b32 s60, s85, 5
    s_add_u32 s60, s60, 17408
    buffer_load_dwordx4 v[52:55], v11, s[52:55], s60 offen
    s_lshr_b32 s60, s85, 5
    s_add_u32 s60, s60, 18432
    buffer_load_dwordx4 v[56:59], v11, s[52:55], s60 offen
    s_lshr_b32 s60, s85, 5
    s_add_u32 s60, s60, 19456
    buffer_load_dwordx4 v[60:63], v11, s[52:55], s60 offen
    s_add_u32 m0, s88, 0
    s_add_u32 s60, s84, 524288
    buffer_load_dwordx4 v12, s[44:47], s60 offen offset:0 lds
    s_add_u32 s60, s84, 531456
    buffer_load_dwordx4 v12, s[44:47], s60 offen offset:1024 lds
    s_add_u32 s60, s84, 653312
    buffer_load_dwordx4 v12, s[44:47], s60 offen offset:2048 lds
    s_add_u32 s60, s84, 660480
    buffer_load_dwordx4 v12, s[44:47], s60 offen offset:3072 lds
    s_waitcnt lgkmcnt(6)
    v_add_u32 v10, 36864, v10
    v_perm_b32 v64, v17, v16, s56
    v_perm_b32 v65, v19, v18, s56
    ds_write_b64 v3, v[64:65] offset:5120
    v_perm_b32 v66, v17, v16, s57
    v_perm_b32 v67, v19, v18, s57
    ds_write_b64 v3, v[66:67] offset:7168
    s_waitcnt lgkmcnt(6)
    v_add_u32 v13, 36864, v13
    v_perm_b32 v68, v21, v20, s56
    v_perm_b32 v69, v23, v22, s56
    v_accvgpr_write_b32 a20, v68
    v_accvgpr_write_b32 a21, v69
    v_perm_b32 v70, v21, v20, s57
    v_perm_b32 v71, v23, v22, s57
    v_accvgpr_write_b32 a28, v70
    v_accvgpr_write_b32 a29, v71
    s_waitcnt lgkmcnt(4)
    v_add_u32 v14, 36864, v14
    v_perm_b32 v72, v25, v24, s56
    v_perm_b32 v73, v27, v26, s56
    v_accvgpr_write_b32 a52, v72
    v_accvgpr_write_b32 a53, v73
    v_perm_b32 v74, v25, v24, s57
    v_perm_b32 v75, v27, v26, s57
    v_accvgpr_write_b32 a60, v74
    v_accvgpr_write_b32 a61, v75
    s_waitcnt lgkmcnt(2)
    v_add_u32 v15, 36864, v15
    v_perm_b32 v76, v29, v28, s56
    v_perm_b32 v77, v31, v30, s56
    v_accvgpr_write_b32 a84, v76
    v_accvgpr_write_b32 a85, v77
    v_perm_b32 v78, v29, v28, s57
    v_perm_b32 v79, v31, v30, s57
    v_accvgpr_write_b32 a92, v78
    v_accvgpr_write_b32 a93, v79
    s_waitcnt lgkmcnt(0)
    s_waitcnt vmcnt(16)
    s_barrier
    ds_read2st64_b32 v[16:17], v10 offset0:0 offset1:4
    ds_read2st64_b32 v[18:19], v10 offset0:8 offset1:12
    ds_read2st64_b32 v[20:21], v13 offset0:0 offset1:4
    ds_read2st64_b32 v[22:23], v13 offset0:8 offset1:12
    ds_read2st64_b32 v[24:25], v14 offset0:0 offset1:4
    ds_read2st64_b32 v[26:27], v14 offset0:8 offset1:12
    ds_read2st64_b32 v[28:29], v15 offset0:0 offset1:4
    ds_read2st64_b32 v[30:31], v15 offset0:8 offset1:12
    s_add_u32 m0, s88, 36864
    s_add_u32 s60, s84, 540672
    buffer_load_dwordx4 v12, s[44:47], s60 offen offset:0 lds
    s_add_u32 s60, s84, 547840
    buffer_load_dwordx4 v12, s[44:47], s60 offen offset:1024 lds
    s_add_u32 s60, s84, 669696
    buffer_load_dwordx4 v12, s[44:47], s60 offen offset:2048 lds
    s_add_u32 s60, s84, 676864
    buffer_load_dwordx4 v12, s[44:47], s60 offen offset:3072 lds
    s_waitcnt lgkmcnt(6)
    v_add_u32 v10, 36864, v10
    v_perm_b32 v64, v17, v16, s56
    v_perm_b32 v65, v19, v18, s56
    ds_write_b64 v3, v[64:65] offset:5128
    v_perm_b32 v66, v17, v16, s57
    v_perm_b32 v67, v19, v18, s57
    ds_write_b64 v3, v[66:67] offset:7176
    s_waitcnt lgkmcnt(6)
    v_add_u32 v13, 36864, v13
    v_perm_b32 v68, v21, v20, s56
    v_perm_b32 v69, v23, v22, s56
    v_accvgpr_write_b32 a22, v68
    v_accvgpr_write_b32 a23, v69
    v_perm_b32 v70, v21, v20, s57
    v_perm_b32 v71, v23, v22, s57
    v_accvgpr_write_b32 a30, v70
    v_accvgpr_write_b32 a31, v71
    s_waitcnt lgkmcnt(4)
    v_add_u32 v14, 36864, v14
    v_perm_b32 v72, v25, v24, s56
    v_perm_b32 v73, v27, v26, s56
    v_accvgpr_write_b32 a54, v72
    v_accvgpr_write_b32 a55, v73
    v_perm_b32 v74, v25, v24, s57
    v_perm_b32 v75, v27, v26, s57
    v_accvgpr_write_b32 a62, v74
    v_accvgpr_write_b32 a63, v75
    s_waitcnt lgkmcnt(2)
    v_add_u32 v15, 36864, v15
    v_perm_b32 v76, v29, v28, s56
    v_perm_b32 v77, v31, v30, s56
    v_accvgpr_write_b32 a86, v76
    v_accvgpr_write_b32 a87, v77
    v_perm_b32 v78, v29, v28, s57
    v_perm_b32 v79, v31, v30, s57
    v_accvgpr_write_b32 a94, v78
    v_accvgpr_write_b32 a95, v79
    v_perm_b32 v184, v36, v32, s56
    v_perm_b32 v185, v36, v32, s57
    v_perm_b32 v216, v37, v33, s56
    v_perm_b32 v217, v37, v33, s57
    v_perm_b32 v80, v38, v34, s56
    v_perm_b32 v81, v38, v34, s57
    v_perm_b32 v88, v39, v35, s56
    v_perm_b32 v89, v39, v35, s57
    v_perm_b32 v186, v44, v40, s56
    v_perm_b32 v187, v44, v40, s57
    v_perm_b32 v218, v45, v41, s56
    v_perm_b32 v219, v45, v41, s57
    v_perm_b32 v82, v46, v42, s56
    v_perm_b32 v83, v46, v42, s57
    v_perm_b32 v90, v47, v43, s56
    v_perm_b32 v91, v47, v43, s57
    s_waitcnt lgkmcnt(0)
    s_waitcnt vmcnt(16)
    s_barrier
    ds_read2st64_b32 v[16:17], v10 offset0:0 offset1:4
    ds_read2st64_b32 v[18:19], v10 offset0:8 offset1:12
    ds_read2st64_b32 v[20:21], v13 offset0:0 offset1:4
    ds_read2st64_b32 v[22:23], v13 offset0:8 offset1:12
    ds_read2st64_b32 v[24:25], v14 offset0:0 offset1:4
    ds_read2st64_b32 v[26:27], v14 offset0:8 offset1:12
    ds_read2st64_b32 v[28:29], v15 offset0:0 offset1:4
    ds_read2st64_b32 v[30:31], v15 offset0:8 offset1:12
    s_cmp_lg_u32 s89, 0
    s_cbranch_scc1 HT_47
    s_mov_b32 s60, 557056
    buffer_load_dword v175, v174, s[44:47], s60 offen
HT_47:
    s_add_u32 m0, s88, 73728
    s_add_u32 s60, s84, 32768
    buffer_load_dwordx4 v12, s[44:47], s60 offen offset:0 lds
    s_add_u32 s60, s84, 39936
    buffer_load_dwordx4 v12, s[44:47], s60 offen offset:1024 lds
    s_add_u32 s60, s84, 161792
    buffer_load_dwordx4 v12, s[44:47], s60 offen offset:2048 lds
    s_add_u32 s60, s84, 168960
    buffer_load_dwordx4 v12, s[44:47], s60 offen offset:3072 lds
    s_waitcnt lgkmcnt(6)
    v_add_u32 v10, 36864, v10
    v_perm_b32 v64, v17, v16, s56
    v_perm_b32 v65, v19, v18, s56
    ds_write_b64 v3, v[64:65] offset:8192
    v_perm_b32 v66, v17, v16, s57
    v_perm_b32 v67, v19, v18, s57
    ds_write_b64 v3, v[66:67] offset:10240
    s_waitcnt lgkmcnt(6)
    v_add_u32 v13, 36864, v13
    v_perm_b32 v68, v21, v20, s56
    v_perm_b32 v69, v23, v22, s56
    v_accvgpr_write_b32 a112, v68
    v_accvgpr_write_b32 a113, v69
    v_perm_b32 v70, v21, v20, s57
    v_perm_b32 v71, v23, v22, s57
    v_accvgpr_write_b32 a120, v70
    v_accvgpr_write_b32 a121, v71
    s_waitcnt lgkmcnt(4)
    v_add_u32 v14, 36864, v14
    v_perm_b32 v72, v25, v24, s56
    v_perm_b32 v73, v27, v26, s56
    v_accvgpr_write_b32 a144, v72
    v_accvgpr_write_b32 a145, v73
    v_perm_b32 v74, v25, v24, s57
    v_perm_b32 v75, v27, v26, s57
    v_accvgpr_write_b32 a152, v74
    v_accvgpr_write_b32 a153, v75
    s_waitcnt lgkmcnt(2)
    v_add_u32 v15, 36864, v15
    v_perm_b32 v76, v29, v28, s56
    v_perm_b32 v77, v31, v30, s56
    v_accvgpr_write_b32 a176, v76
    v_accvgpr_write_b32 a177, v77
    v_perm_b32 v78, v29, v28, s57
    v_perm_b32 v79, v31, v30, s57
    v_accvgpr_write_b32 a184, v78
    v_accvgpr_write_b32 a185, v79
    s_waitcnt lgkmcnt(0)
    s_waitcnt vmcnt(16)
    s_barrier
    ds_read2st64_b32 v[16:17], v10 offset0:0 offset1:4
    ds_read2st64_b32 v[18:19], v10 offset0:8 offset1:12
    ds_read2st64_b32 v[20:21], v13 offset0:0 offset1:4
    ds_read2st64_b32 v[22:23], v13 offset0:8 offset1:12
    ds_read2st64_b32 v[24:25], v14 offset0:0 offset1:4
    ds_read2st64_b32 v[26:27], v14 offset0:8 offset1:12
    ds_read2st64_b32 v[28:29], v15 offset0:0 offset1:4
    ds_read2st64_b32 v[30:31], v15 offset0:8 offset1:12
    s_lshr_b32 s60, s86, 5
    s_add_u32 s60, s60, 0
    buffer_load_dwordx4 v[32:35], v11, s[52:55], s60 offen
    s_lshr_b32 s60, s86, 5
    s_add_u32 s60, s60, 1024
    buffer_load_dwordx4 v[36:39], v11, s[52:55], s60 offen
    s_lshr_b32 s60, s86, 5
    s_add_u32 s60, s60, 2048
    buffer_load_dwordx4 v[40:43], v11, s[52:55], s60 offen
    s_lshr_b32 s60, s86, 5
    s_add_u32 s60, s60, 3072
    buffer_load_dwordx4 v[44:47], v11, s[52:55], s60 offen
    s_add_u32 m0, s88, 110592
    s_add_u32 s60, s84, 49152
    buffer_load_dwordx4 v12, s[44:47], s60 offen offset:0 lds
    s_add_u32 s60, s84, 56320
    buffer_load_dwordx4 v12, s[44:47], s60 offen offset:1024 lds
    s_add_u32 s60, s84, 178176
    buffer_load_dwordx4 v12, s[44:47], s60 offen offset:2048 lds
    s_add_u32 s60, s84, 185344
    buffer_load_dwordx4 v12, s[44:47], s60 offen offset:3072 lds
    s_waitcnt lgkmcnt(6)
    v_add_u32 v10, -147456, v10
    v_perm_b32 v64, v17, v16, s56
    v_perm_b32 v65, v19, v18, s56
    ds_write_b64 v3, v[64:65] offset:8200
    v_perm_b32 v66, v17, v16, s57
    v_perm_b32 v67, v19, v18, s57
    ds_write_b64 v3, v[66:67] offset:10248
    s_waitcnt lgkmcnt(6)
    v_add_u32 v13, -147456, v13
    v_perm_b32 v68, v21, v20, s56
    v_perm_b32 v69, v23, v22, s56
    v_accvgpr_write_b32 a114, v68
    v_accvgpr_write_b32 a115, v69
    v_perm_b32 v70, v21, v20, s57
    v_perm_b32 v71, v23, v22, s57
    v_accvgpr_write_b32 a122, v70
    v_accvgpr_write_b32 a123, v71
    s_waitcnt lgkmcnt(4)
    v_add_u32 v14, -147456, v14
    v_perm_b32 v72, v25, v24, s56
    v_perm_b32 v73, v27, v26, s56
    v_accvgpr_write_b32 a146, v72
    v_accvgpr_write_b32 a147, v73
    v_perm_b32 v74, v25, v24, s57
    v_perm_b32 v75, v27, v26, s57
    v_accvgpr_write_b32 a154, v74
    v_accvgpr_write_b32 a155, v75
    s_waitcnt lgkmcnt(2)
    v_add_u32 v15, -147456, v15
    v_perm_b32 v76, v29, v28, s56
    v_perm_b32 v77, v31, v30, s56
    v_accvgpr_write_b32 a178, v76
    v_accvgpr_write_b32 a179, v77
    v_perm_b32 v78, v29, v28, s57
    v_perm_b32 v79, v31, v30, s57
    v_accvgpr_write_b32 a186, v78
    v_accvgpr_write_b32 a187, v79
    s_waitcnt lgkmcnt(0)
    s_waitcnt vmcnt(16)
    s_barrier
    ds_read2st64_b32 v[16:17], v10 offset0:0 offset1:4
    ds_read2st64_b32 v[18:19], v10 offset0:8 offset1:12
    ds_read2st64_b32 v[20:21], v13 offset0:0 offset1:4
    ds_read2st64_b32 v[22:23], v13 offset0:8 offset1:12
    ds_read2st64_b32 v[24:25], v14 offset0:0 offset1:4
    ds_read2st64_b32 v[26:27], v14 offset0:8 offset1:12
    ds_read2st64_b32 v[28:29], v15 offset0:0 offset1:4
    ds_read2st64_b32 v[30:31], v15 offset0:8 offset1:12
    s_cmp_lg_u32 s89, 1
    s_cbranch_scc1 HT_48
    s_mov_b32 s60, 0
    buffer_load_dword v175, v174, s[48:51], s60 offen
HT_48:
    s_add_u32 m0, s88, 147456
    s_add_u32 s60, s84, 557056
    buffer_load_dwordx4 v12, s[44:47], s60 offen offset:0 lds
    s_add_u32 s60, s84, 564224
    buffer_load_dwordx4 v12, s[44:47], s60 offen offset:1024 lds
    s_add_u32 s60, s84, 686080
    buffer_load_dwordx4 v12, s[44:47], s60 offen offset:2048 lds
    s_add_u32 s60, s84, 693248
    buffer_load_dwordx4 v12, s[44:47], s60 offen offset:3072 lds
    s_waitcnt lgkmcnt(6)
    v_add_u32 v10, 36864, v10
    v_perm_b32 v64, v17, v16, s56
    v_perm_b32 v65, v19, v18, s56
    ds_write_b64 v3, v[64:65] offset:9216
    v_perm_b32 v66, v17, v16, s57
    v_perm_b32 v67, v19, v18, s57
    ds_write_b64 v3, v[66:67] offset:11264
    s_waitcnt lgkmcnt(6)
    v_add_u32 v13, 36864, v13
    v_perm_b32 v68, v21, v20, s56
    v_perm_b32 v69, v23, v22, s56
    v_accvgpr_write_b32 a116, v68
    v_accvgpr_write_b32 a117, v69
    v_perm_b32 v70, v21, v20, s57
    v_perm_b32 v71, v23, v22, s57
    v_accvgpr_write_b32 a124, v70
    v_accvgpr_write_b32 a125, v71
    s_waitcnt lgkmcnt(4)
    v_add_u32 v14, 36864, v14
    v_perm_b32 v72, v25, v24, s56
    v_perm_b32 v73, v27, v26, s56
    v_accvgpr_write_b32 a148, v72
    v_accvgpr_write_b32 a149, v73
    v_perm_b32 v74, v25, v24, s57
    v_perm_b32 v75, v27, v26, s57
    v_accvgpr_write_b32 a156, v74
    v_accvgpr_write_b32 a157, v75
    s_waitcnt lgkmcnt(2)
    v_add_u32 v15, 36864, v15
    v_perm_b32 v76, v29, v28, s56
    v_perm_b32 v77, v31, v30, s56
    v_accvgpr_write_b32 a180, v76
    v_accvgpr_write_b32 a181, v77
    v_perm_b32 v78, v29, v28, s57
    v_perm_b32 v79, v31, v30, s57
    v_accvgpr_write_b32 a188, v78
    v_accvgpr_write_b32 a189, v79
    v_perm_b32 v188, v52, v48, s56
    v_perm_b32 v189, v52, v48, s57
    v_perm_b32 v220, v53, v49, s56
    v_perm_b32 v221, v53, v49, s57
    v_perm_b32 v84, v54, v50, s56
    v_perm_b32 v85, v54, v50, s57
    v_perm_b32 v92, v55, v51, s56
    v_perm_b32 v93, v55, v51, s57
    v_perm_b32 v190, v60, v56, s56
    v_perm_b32 v191, v60, v56, s57
    v_perm_b32 v222, v61, v57, s56
    v_perm_b32 v223, v61, v57, s57
    v_perm_b32 v86, v62, v58, s56
    v_perm_b32 v87, v62, v58, s57
    v_perm_b32 v94, v63, v59, s56
    v_perm_b32 v95, v63, v59, s57
    s_waitcnt lgkmcnt(0)
    s_waitcnt vmcnt(16)
    s_barrier
    ds_read2st64_b32 v[16:17], v10 offset0:0 offset1:4
    ds_read2st64_b32 v[18:19], v10 offset0:8 offset1:12
    ds_read2st64_b32 v[20:21], v13 offset0:0 offset1:4
    ds_read2st64_b32 v[22:23], v13 offset0:8 offset1:12
    ds_read2st64_b32 v[24:25], v14 offset0:0 offset1:4
    ds_read2st64_b32 v[26:27], v14 offset0:8 offset1:12
    ds_read2st64_b32 v[28:29], v15 offset0:0 offset1:4
    ds_read2st64_b32 v[30:31], v15 offset0:8 offset1:12
    s_cmp_lg_u32 s89, 2
    s_cbranch_scc1 HT_49
    s_mov_b32 s60, 16384
    buffer_load_dword v175, v174, s[48:51], s60 offen
HT_49:
    s_add_u32 m0, s88, 0
    s_add_u32 s60, s84, 573440
    buffer_load_dwordx4 v12, s[44:47], s60 offen offset:0 lds
    s_add_u32 s60, s84, 580608
    buffer_load_dwordx4 v12, s[44:47], s60 offen offset:1024 lds
    s_add_u32 s60, s84, 702464
    buffer_load_dwordx4 v12, s[44:47], s60 offen offset:2048 lds
    s_add_u32 s60, s84, 709632
    buffer_load_dwordx4 v12, s[44:47], s60 offen offset:3072 lds
    s_waitcnt lgkmcnt(6)
    v_add_u32 v10, 36864, v10
    v_perm_b32 v64, v17, v16, s56
    v_perm_b32 v65, v19, v18, s56
    ds_write_b64 v3, v[64:65] offset:9224
    v_perm_b32 v66, v17, v16, s57
    v_perm_b32 v67, v19, v18, s57
    ds_write_b64 v3, v[66:67] offset:11272
    s_waitcnt lgkmcnt(6)
    v_add_u32 v13, 36864, v13
    v_perm_b32 v68, v21, v20, s56
    v_perm_b32 v69, v23, v22, s56
    v_accvgpr_write_b32 a118, v68
    v_accvgpr_write_b32 a119, v69
    v_perm_b32 v70, v21, v20, s57
    v_perm_b32 v71, v23, v22, s57
    v_accvgpr_write_b32 a126, v70
    v_accvgpr_write_b32 a127, v71
    s_waitcnt lgkmcnt(4)
    v_add_u32 v14, 36864, v14
    v_perm_b32 v72, v25, v24, s56
    v_perm_b32 v73, v27, v26, s56
    v_accvgpr_write_b32 a150, v72
    v_accvgpr_write_b32 a151, v73
    v_perm_b32 v74, v25, v24, s57
    v_perm_b32 v75, v27, v26, s57
    v_accvgpr_write_b32 a158, v74
    v_accvgpr_write_b32 a159, v75
    s_waitcnt lgkmcnt(2)
    v_add_u32 v15, 36864, v15
    v_perm_b32 v76, v29, v28, s56
    v_perm_b32 v77, v31, v30, s56
    v_accvgpr_write_b32 a182, v76
    v_accvgpr_write_b32 a183, v77
    v_perm_b32 v78, v29, v28, s57
    v_perm_b32 v79, v31, v30, s57
    v_accvgpr_write_b32 a190, v78
    v_accvgpr_write_b32 a191, v79
    s_waitcnt lgkmcnt(0)
    s_waitcnt vmcnt(16)
    s_barrier
    ds_read2st64_b32 v[16:17], v10 offset0:0 offset1:4
    ds_read2st64_b32 v[18:19], v10 offset0:8 offset1:12
    ds_read2st64_b32 v[20:21], v13 offset0:0 offset1:4
    ds_read2st64_b32 v[22:23], v13 offset0:8 offset1:12
    ds_read2st64_b32 v[24:25], v14 offset0:0 offset1:4
    ds_read2st64_b32 v[26:27], v14 offset0:8 offset1:12
    ds_read2st64_b32 v[28:29], v15 offset0:0 offset1:4
    ds_read2st64_b32 v[30:31], v15 offset0:8 offset1:12
    s_lshr_b32 s60, s86, 5
    s_add_u32 s60, s60, 16384
    buffer_load_dwordx4 v[48:51], v11, s[52:55], s60 offen
    s_lshr_b32 s60, s86, 5
    s_add_u32 s60, s60, 17408
    buffer_load_dwordx4 v[52:55], v11, s[52:55], s60 offen
    s_lshr_b32 s60, s86, 5
    s_add_u32 s60, s60, 18432
    buffer_load_dwordx4 v[56:59], v11, s[52:55], s60 offen
    s_lshr_b32 s60, s86, 5
    s_add_u32 s60, s60, 19456
    buffer_load_dwordx4 v[60:63], v11, s[52:55], s60 offen
    s_add_u32 m0, s88, 36864
    s_add_u32 s60, s84, 0
    buffer_load_dwordx4 v12, s[48:51], s60 offen offset:0 lds
    s_add_u32 s60, s84, 7168
    buffer_load_dwordx4 v12, s[48:51], s60 offen offset:1024 lds
    s_add_u32 s60, s84, 129024
    buffer_load_dwordx4 v12, s[48:51], s60 offen offset:2048 lds
    s_add_u32 s60, s84, 136192
    buffer_load_dwordx4 v12, s[48:51], s60 offen offset:3072 lds
    s_waitcnt lgkmcnt(6)
    v_add_u32 v10, 36864, v10
    v_perm_b32 v64, v17, v16, s56
    v_perm_b32 v65, v19, v18, s56
    v_accvgpr_write_b32 a96, v64
    v_accvgpr_write_b32 a97, v65
    v_perm_b32 v66, v17, v16, s57
    v_perm_b32 v67, v19, v18, s57
    v_accvgpr_write_b32 a104, v66
    v_accvgpr_write_b32 a105, v67
    s_waitcnt lgkmcnt(4)
    v_add_u32 v13, 36864, v13
    v_perm_b32 v68, v21, v20, s56
    v_perm_b32 v69, v23, v22, s56
    v_accvgpr_write_b32 a128, v68
    v_accvgpr_write_b32 a129, v69
    v_perm_b32 v70, v21, v20, s57
    v_perm_b32 v71, v23, v22, s57
    v_accvgpr_write_b32 a136, v70
    v_accvgpr_write_b32 a137, v71
    s_waitcnt lgkmcnt(2)
    v_add_u32 v14, 36864, v14
    v_perm_b32 v72, v25, v24, s56
    v_perm_b32 v73, v27, v26, s56
    v_accvgpr_write_b32 a160, v72
    v_accvgpr_write_b32 a161, v73
    v_perm_b32 v74, v25, v24, s57
    v_perm_b32 v75, v27, v26, s57
    v_accvgpr_write_b32 a168, v74
    v_accvgpr_write_b32 a169, v75
    s_waitcnt lgkmcnt(0)
    v_add_u32 v15, 36864, v15
    v_perm_b32 v76, v29, v28, s56
    v_perm_b32 v77, v31, v30, s56
    v_accvgpr_write_b32 a192, v76
    v_accvgpr_write_b32 a193, v77
    v_perm_b32 v78, v29, v28, s57
    v_perm_b32 v79, v31, v30, s57
    v_accvgpr_write_b32 a200, v78
    v_accvgpr_write_b32 a201, v79
    s_waitcnt vmcnt(16)
    s_barrier
    ds_read2st64_b32 v[16:17], v10 offset0:0 offset1:4
    ds_read2st64_b32 v[18:19], v10 offset0:8 offset1:12
    ds_read2st64_b32 v[20:21], v13 offset0:0 offset1:4
    ds_read2st64_b32 v[22:23], v13 offset0:8 offset1:12
    ds_read2st64_b32 v[24:25], v14 offset0:0 offset1:4
    ds_read2st64_b32 v[26:27], v14 offset0:8 offset1:12
    ds_read2st64_b32 v[28:29], v15 offset0:0 offset1:4
    ds_read2st64_b32 v[30:31], v15 offset0:8 offset1:12
    s_cmp_lg_u32 s89, 3
    s_cbranch_scc1 HT_50
    s_mov_b32 s60, 540672
    buffer_load_dword v175, v174, s[48:51], s60 offen
HT_50:
    s_add_u32 m0, s88, 73728
    s_add_u32 s60, s84, 16384
    buffer_load_dwordx4 v12, s[48:51], s60 offen offset:0 lds
    s_add_u32 s60, s84, 23552
    buffer_load_dwordx4 v12, s[48:51], s60 offen offset:1024 lds
    s_add_u32 s60, s84, 145408
    buffer_load_dwordx4 v12, s[48:51], s60 offen offset:2048 lds
    s_add_u32 s60, s84, 152576
    buffer_load_dwordx4 v12, s[48:51], s60 offen offset:3072 lds
    s_waitcnt lgkmcnt(6)
    v_add_u32 v10, 36864, v10
    v_perm_b32 v64, v17, v16, s56
    v_perm_b32 v65, v19, v18, s56
    v_accvgpr_write_b32 a98, v64
    v_accvgpr_write_b32 a99, v65
    v_perm_b32 v66, v17, v16, s57
    v_perm_b32 v67, v19, v18, s57
    v_accvgpr_write_b32 a106, v66
    v_accvgpr_write_b32 a107, v67
    s_waitcnt lgkmcnt(4)
    v_add_u32 v13, 36864, v13
    v_perm_b32 v68, v21, v20, s56
    v_perm_b32 v69, v23, v22, s56
    v_accvgpr_write_b32 a130, v68
    v_accvgpr_write_b32 a131, v69
    v_perm_b32 v70, v21, v20, s57
    v_perm_b32 v71, v23, v22, s57
    v_accvgpr_write_b32 a138, v70
    v_accvgpr_write_b32 a139, v71
    s_waitcnt lgkmcnt(2)
    v_add_u32 v14, 36864, v14
    v_perm_b32 v72, v25, v24, s56
    v_perm_b32 v73, v27, v26, s56
    v_accvgpr_write_b32 a162, v72
    v_accvgpr_write_b32 a163, v73
    v_perm_b32 v74, v25, v24, s57
    v_perm_b32 v75, v27, v26, s57
    v_accvgpr_write_b32 a170, v74
    v_accvgpr_write_b32 a171, v75
    s_waitcnt lgkmcnt(0)
    v_add_u32 v15, 36864, v15
    v_perm_b32 v76, v29, v28, s56
    v_perm_b32 v77, v31, v30, s56
    v_accvgpr_write_b32 a194, v76
    v_accvgpr_write_b32 a195, v77
    v_perm_b32 v78, v29, v28, s57
    v_perm_b32 v79, v31, v30, s57
    v_accvgpr_write_b32 a202, v78
    v_accvgpr_write_b32 a203, v79
    v_perm_b32 v192, v36, v32, s56
    v_perm_b32 v193, v36, v32, s57
    v_perm_b32 v224, v37, v33, s56
    v_perm_b32 v225, v37, v33, s57
    v_perm_b32 v96, v38, v34, s56
    v_perm_b32 v97, v38, v34, s57
    v_perm_b32 v104, v39, v35, s56
    v_perm_b32 v105, v39, v35, s57
    v_perm_b32 v194, v44, v40, s56
    v_perm_b32 v195, v44, v40, s57
    v_perm_b32 v226, v45, v41, s56
    v_perm_b32 v227, v45, v41, s57
    v_perm_b32 v98, v46, v42, s56
    v_perm_b32 v99, v46, v42, s57
    v_perm_b32 v106, v47, v43, s56
    v_perm_b32 v107, v47, v43, s57
    s_waitcnt vmcnt(16)
    s_barrier
    ds_read2st64_b32 v[16:17], v10 offset0:0 offset1:4
    ds_read2st64_b32 v[18:19], v10 offset0:8 offset1:12
    ds_read2st64_b32 v[20:21], v13 offset0:0 offset1:4
    ds_read2st64_b32 v[22:23], v13 offset0:8 offset1:12
    ds_read2st64_b32 v[24:25], v14 offset0:0 offset1:4
    ds_read2st64_b32 v[26:27], v14 offset0:8 offset1:12
    ds_read2st64_b32 v[28:29], v15 offset0:0 offset1:4
    ds_read2st64_b32 v[30:31], v15 offset0:8 offset1:12
    s_cmp_lg_u32 s3, 0
    s_cbranch_scc1 WA_51
    v_mov_b32 v173, 128
    global_load_dword v172, v173, s[32:33] sc1
WA_51:
    s_add_u32 m0, s88, 110592
    s_add_u32 s60, s84, 524288
    buffer_load_dwordx4 v12, s[48:51], s60 offen offset:0 lds
    s_add_u32 s60, s84, 531456
    buffer_load_dwordx4 v12, s[48:51], s60 offen offset:1024 lds
    s_add_u32 s60, s84, 653312
    buffer_load_dwordx4 v12, s[48:51], s60 offen offset:2048 lds
    s_add_u32 s60, s84, 660480
    buffer_load_dwordx4 v12, s[48:51], s60 offen offset:3072 lds
    s_waitcnt lgkmcnt(6)
    v_add_u32 v10, -147456, v10
    v_perm_b32 v64, v17, v16, s56
    v_perm_b32 v65, v19, v18, s56
    v_accvgpr_write_b32 a100, v64
    v_accvgpr_write_b32 a101, v65
    v_perm_b32 v66, v17, v16, s57
    v_perm_b32 v67, v19, v18, s57
    v_accvgpr_write_b32 a108, v66
    v_accvgpr_write_b32 a109, v67
    s_waitcnt lgkmcnt(4)
    v_add_u32 v13, -147456, v13
    v_perm_b32 v68, v21, v20, s56
    v_perm_b32 v69, v23, v22, s56
    v_accvgpr_write_b32 a132, v68
    v_accvgpr_write_b32 a133, v69
    v_perm_b32 v70, v21, v20, s57
    v_perm_b32 v71, v23, v22, s57
    v_accvgpr_write_b32 a140, v70
    v_accvgpr_write_b32 a141, v71
    s_waitcnt lgkmcnt(2)
    v_add_u32 v14, -147456, v14
    v_perm_b32 v72, v25, v24, s56
    v_perm_b32 v73, v27, v26, s56
    v_accvgpr_write_b32 a164, v72
    v_accvgpr_write_b32 a165, v73
    v_perm_b32 v74, v25, v24, s57
    v_perm_b32 v75, v27, v26, s57
    v_accvgpr_write_b32 a172, v74
    v_accvgpr_write_b32 a173, v75
    s_waitcnt lgkmcnt(0)
    v_add_u32 v15, -147456, v15
    v_perm_b32 v76, v29, v28, s56
    v_perm_b32 v77, v31, v30, s56
    v_accvgpr_write_b32 a196, v76
    v_accvgpr_write_b32 a197, v77
    v_perm_b32 v78, v29, v28, s57
    v_perm_b32 v79, v31, v30, s57
    v_accvgpr_write_b32 a204, v78
    v_accvgpr_write_b32 a205, v79
    s_waitcnt vmcnt(16)
    s_barrier
    ds_read2st64_b32 v[16:17], v10 offset0:0 offset1:4
    ds_read2st64_b32 v[18:19], v10 offset0:8 offset1:12
    ds_read2st64_b32 v[20:21], v13 offset0:0 offset1:4
    ds_read2st64_b32 v[22:23], v13 offset0:8 offset1:12
    ds_read2st64_b32 v[24:25], v14 offset0:0 offset1:4
    ds_read2st64_b32 v[26:27], v14 offset0:8 offset1:12
    ds_read2st64_b32 v[28:29], v15 offset0:0 offset1:4
    ds_read2st64_b32 v[30:31], v15 offset0:8 offset1:12
    s_cmp_lg_u32 s89, 4
    s_cbranch_scc1 HT_52
    s_mov_b32 s60, 49152
    buffer_load_dword v175, v174, s[48:51], s60 offen
HT_52:
    s_lshr_b32 s60, s87, 5
    s_add_u32 s60, s60, 0
    buffer_load_dwordx4 v[32:35], v11, s[52:55], s60 offen
    s_lshr_b32 s60, s87, 5
    s_add_u32 s60, s60, 1024
    buffer_load_dwordx4 v[36:39], v11, s[52:55], s60 offen
    s_lshr_b32 s60, s87, 5
    s_add_u32 s60, s60, 2048
    buffer_load_dwordx4 v[40:43], v11, s[52:55], s60 offen
    s_lshr_b32 s60, s87, 5
    s_add_u32 s60, s60, 3072
    buffer_load_dwordx4 v[44:47], v11, s[52:55], s60 offen
    s_add_u32 m0, s88, 147456
    s_add_u32 s60, s84, 540672
    buffer_load_dwordx4 v12, s[48:51], s60 offen offset:0 lds
    s_add_u32 s60, s84, 547840
    buffer_load_dwordx4 v12, s[48:51], s60 offen offset:1024 lds
    s_add_u32 s60, s84, 669696
    buffer_load_dwordx4 v12, s[48:51], s60 offen offset:2048 lds
    s_add_u32 s60, s84, 676864
    buffer_load_dwordx4 v12, s[48:51], s60 offen offset:3072 lds
    s_waitcnt lgkmcnt(6)
    v_add_u32 v10, 36864, v10
    v_perm_b32 v64, v17, v16, s56
    v_perm_b32 v65, v19, v18, s56
    v_accvgpr_write_b32 a102, v64
    v_accvgpr_write_b32 a103, v65
    v_perm_b32 v66, v17, v16, s57
    v_perm_b32 v67, v19, v18, s57
    v_accvgpr_write_b32 a110, v66
    v_accvgpr_write_b32 a111, v67
    s_waitcnt lgkmcnt(4)
    v_add_u32 v13, 36864, v13
    v_perm_b32 v68, v21, v20, s56
    v_perm_b32 v69, v23, v22, s56
    v_accvgpr_write_b32 a134, v68
    v_accvgpr_write_b32 a135, v69
    v_perm_b32 v70, v21, v20, s57
    v_perm_b32 v71, v23, v22, s57
    v_accvgpr_write_b32 a142, v70
    v_accvgpr_write_b32 a143, v71
    s_waitcnt lgkmcnt(2)
    v_add_u32 v14, 36864, v14
    v_perm_b32 v72, v25, v24, s56
    v_perm_b32 v73, v27, v26, s56
    v_accvgpr_write_b32 a166, v72
    v_accvgpr_write_b32 a167, v73
    v_perm_b32 v74, v25, v24, s57
    v_perm_b32 v75, v27, v26, s57
    v_accvgpr_write_b32 a174, v74
    v_accvgpr_write_b32 a175, v75
    s_waitcnt lgkmcnt(0)
    v_add_u32 v15, 36864, v15
    v_perm_b32 v76, v29, v28, s56
    v_perm_b32 v77, v31, v30, s56
    v_accvgpr_write_b32 a198, v76
    v_accvgpr_write_b32 a199, v77
    v_perm_b32 v78, v29, v28, s57
    v_perm_b32 v79, v31, v30, s57
    v_accvgpr_write_b32 a206, v78
    v_accvgpr_write_b32 a207, v79
    s_waitcnt vmcnt(16)
    s_barrier
    ds_read2st64_b32 v[16:17], v10 offset0:0 offset1:4
    ds_read2st64_b32 v[18:19], v10 offset0:8 offset1:12
    ds_read2st64_b32 v[20:21], v13 offset0:0 offset1:4
    ds_read2st64_b32 v[22:23], v13 offset0:8 offset1:12
    ds_read2st64_b32 v[24:25], v14 offset0:0 offset1:4
    ds_read2st64_b32 v[26:27], v14 offset0:8 offset1:12
    ds_read2st64_b32 v[28:29], v15 offset0:0 offset1:4
    ds_read2st64_b32 v[30:31], v15 offset0:8 offset1:12
    s_add_u32 m0, s88, 0
    s_add_u32 s60, s84, 32768
    buffer_load_dwordx4 v12, s[48:51], s60 offen offset:0 lds
    s_add_u32 s60, s84, 39936
    buffer_load_dwordx4 v12, s[48:51], s60 offen offset:1024 lds
    s_add_u32 s60, s84, 161792
    buffer_load_dwordx4 v12, s[48:51], s60 offen offset:2048 lds
    s_add_u32 s60, s84, 168960
    buffer_load_dwordx4 v12, s[48:51], s60 offen offset:3072 lds
    s_waitcnt lgkmcnt(6)
    v_add_u32 v10, 36864, v10
    v_perm_b32 v64, v17, v16, s56
    v_perm_b32 v65, v19, v18, s56
    v_accvgpr_write_b32 a208, v64
    v_accvgpr_write_b32 a209, v65
    v_perm_b32 v66, v17, v16, s57
    v_perm_b32 v67, v19, v18, s57
    v_accvgpr_write_b32 a216, v66
    v_accvgpr_write_b32 a217, v67
    s_waitcnt lgkmcnt(4)
    v_add_u32 v13, 36864, v13
    v_perm_b32 v68, v21, v20, s56
    v_perm_b32 v69, v23, v22, s56
    v_accvgpr_write_b32 a240, v68
    v_accvgpr_write_b32 a241, v69
    v_perm_b32 v70, v21, v20, s57
    v_perm_b32 v71, v23, v22, s57
    v_accvgpr_write_b32 a248, v70
    v_accvgpr_write_b32 a249, v71
    s_waitcnt lgkmcnt(2)
    v_add_u32 v14, 36864, v14
    v_perm_b32 v144, v25, v24, s56
    v_perm_b32 v145, v27, v26, s56
    v_perm_b32 v152, v25, v24, s57
    v_perm_b32 v153, v27, v26, s57
    s_waitcnt lgkmcnt(0)
    v_add_u32 v15, 36864, v15
    v_perm_b32 v76, v29, v28, s56
    v_perm_b32 v77, v31, v30, s56
    ds_write_b64 v3, v[76:77] offset:12288
    v_perm_b32 v78, v29, v28, s57
    v_perm_b32 v79, v31, v30, s57
    ds_write_b64 v3, v[78:79] offset:14336
    v_perm_b32 v196, v52, v48, s56
    v_perm_b32 v197, v52, v48, s57
    v_perm_b32 v228, v53, v49, s56
    v_perm_b32 v229, v53, v49, s57
    v_perm_b32 v100, v54, v50, s56
    v_perm_b32 v101, v54, v50, s57
    v_perm_b32 v108, v55, v51, s56
    v_perm_b32 v109, v55, v51, s57
    v_perm_b32 v198, v60, v56, s56
    v_perm_b32 v199, v60, v56, s57
    v_perm_b32 v230, v61, v57, s56
    v_perm_b32 v231, v61, v57, s57
    v_perm_b32 v102, v62, v58, s56
    v_perm_b32 v103, v62, v58, s57
    v_perm_b32 v110, v63, v59, s56
    v_perm_b32 v111, v63, v59, s57
    s_waitcnt lgkmcnt(0)
    s_waitcnt vmcnt(16)
    s_barrier
    ds_read2st64_b32 v[16:17], v10 offset0:0 offset1:4
    ds_read2st64_b32 v[18:19], v10 offset0:8 offset1:12
    ds_read2st64_b32 v[20:21], v13 offset0:0 offset1:4
    ds_read2st64_b32 v[22:23], v13 offset0:8 offset1:12
    ds_read2st64_b32 v[24:25], v14 offset0:0 offset1:4
    ds_read2st64_b32 v[26:27], v14 offset0:8 offset1:12
    ds_read2st64_b32 v[28:29], v15 offset0:0 offset1:4
    ds_read2st64_b32 v[30:31], v15 offset0:8 offset1:12
    s_cmp_lg_u32 s89, 5
    s_cbranch_scc1 HT_53
    s_mov_b32 s60, 573440
    buffer_load_dword v175, v174, s[48:51], s60 offen
HT_53:
    s_add_u32 m0, s88, 36864
    s_add_u32 s60, s84, 49152
    buffer_load_dwordx4 v12, s[48:51], s60 offen offset:0 lds
    s_add_u32 s60, s84, 56320
    buffer_load_dwordx4 v12, s[48:51], s60 offen offset:1024 lds
    s_add_u32 s60, s84, 178176
    buffer_load_dwordx4 v12, s[48:51], s60 offen offset:2048 lds
    s_add_u32 s60, s84, 185344
    buffer_load_dwordx4 v12, s[48:51], s60 offen offset:3072 lds
    s_waitcnt lgkmcnt(6)
    v_add_u32 v10, 36864, v10
    v_perm_b32 v64, v17, v16, s56
    v_perm_b32 v65, v19, v18, s56
    v_accvgpr_write_b32 a210, v64
    v_accvgpr_write_b32 a211, v65
    v_perm_b32 v66, v17, v16, s57
    v_perm_b32 v67, v19, v18, s57
    v_accvgpr_write_b32 a218, v66
    v_accvgpr_write_b32 a219, v67
    s_waitcnt lgkmcnt(4)
    v_add_u32 v13, 36864, v13
    v_perm_b32 v68, v21, v20, s56
    v_perm_b32 v69, v23, v22, s56
    v_accvgpr_write_b32 a242, v68
    v_accvgpr_write_b32 a243, v69
    v_perm_b32 v70, v21, v20, s57
    v_perm_b32 v71, v23, v22, s57
    v_accvgpr_write_b32 a250, v70
    v_accvgpr_write_b32 a251, v71
    s_waitcnt lgkmcnt(2)
    v_add_u32 v14, 36864, v14
    v_perm_b32 v146, v25, v24, s56
    v_perm_b32 v147, v27, v26, s56
    v_perm_b32 v154, v25, v24, s57
    v_perm_b32 v155, v27, v26, s57
    s_waitcnt lgkmcnt(0)
    v_add_u32 v15, 36864, v15
    v_perm_b32 v76, v29, v28, s56
    v_perm_b32 v77, v31, v30, s56
    ds_write_b64 v3, v[76:77] offset:12296
    v_perm_b32 v78, v29, v28, s57
    v_perm_b32 v79, v31, v30, s57
    ds_write_b64 v3, v[78:79] offset:14344
    s_waitcnt lgkmcnt(0)
    s_waitcnt vmcnt(16)
    s_barrier
    ds_read2st64_b32 v[16:17], v10 offset0:0 offset1:4
    ds_read2st64_b32 v[18:19], v10 offset0:8 offset1:12
    ds_read2st64_b32 v[20:21], v13 offset0:0 offset1:4
    ds_read2st64_b32 v[22:23], v13 offset0:8 offset1:12
    ds_read2st64_b32 v[24:25], v14 offset0:0 offset1:4
    ds_read2st64_b32 v[26:27], v14 offset0:8 offset1:12
    ds_read2st64_b32 v[28:29], v15 offset0:0 offset1:4
    ds_read2st64_b32 v[30:31], v15 offset0:8 offset1:12
    s_lshr_b32 s60, s87, 5
    s_add_u32 s60, s60, 16384
    buffer_load_dwordx4 v[48:51], v11, s[52:55], s60 offen
    s_lshr_b32 s60, s87, 5
    s_add_u32 s60, s60, 17408
    buffer_load_dwordx4 v[52:55], v11, s[52:55], s60 offen
    s_lshr_b32 s60, s87, 5
    s_add_u32 s60, s60, 18432
    buffer_load_dwordx4 v[56:59], v11, s[52:55], s60 offen
    s_lshr_b32 s60, s87, 5
    s_add_u32 s60, s60, 19456
    buffer_load_dwordx4 v[60:63], v11, s[52:55], s60 offen
    s_add_u32 m0, s88, 73728
    s_add_u32 s60, s84, 557056
    buffer_load_dwordx4 v12, s[48:51], s60 offen offset:0 lds
    s_add_u32 s60, s84, 564224
    buffer_load_dwordx4 v12, s[48:51], s60 offen offset:1024 lds
    s_add_u32 s60, s84, 686080
    buffer_load_dwordx4 v12, s[48:51], s60 offen offset:2048 lds
    s_add_u32 s60, s84, 693248
    buffer_load_dwordx4 v12, s[48:51], s60 offen offset:3072 lds
    s_waitcnt lgkmcnt(6)
    v_add_u32 v10, 36864, v10
    v_perm_b32 v64, v17, v16, s56
    v_perm_b32 v65, v19, v18, s56
    v_accvgpr_write_b32 a212, v64
    v_accvgpr_write_b32 a213, v65
    v_perm_b32 v66, v17, v16, s57
    v_perm_b32 v67, v19, v18, s57
    v_accvgpr_write_b32 a220, v66
    v_accvgpr_write_b32 a221, v67
    s_waitcnt lgkmcnt(4)
    v_add_u32 v13, 36864, v13
    v_perm_b32 v68, v21, v20, s56
    v_perm_b32 v69, v23, v22, s56
    v_accvgpr_write_b32 a244, v68
    v_accvgpr_write_b32 a245, v69
    v_perm_b32 v70, v21, v20, s57
    v_perm_b32 v71, v23, v22, s57
    v_accvgpr_write_b32 a252, v70
    v_accvgpr_write_b32 a253, v71
    s_waitcnt lgkmcnt(2)
    v_add_u32 v14, 36864, v14
    v_perm_b32 v148, v25, v24, s56
    v_perm_b32 v149, v27, v26, s56
    v_perm_b32 v156, v25, v24, s57
    v_perm_b32 v157, v27, v26, s57
    s_waitcnt lgkmcnt(0)
    v_add_u32 v15, 36864, v15
    v_perm_b32 v76, v29, v28, s56
    v_perm_b32 v77, v31, v30, s56
    ds_write_b64 v3, v[76:77] offset:13312
    v_perm_b32 v78, v29, v28, s57
    v_perm_b32 v79, v31, v30, s57
    ds_write_b64 v3, v[78:79] offset:15360
    s_waitcnt lgkmcnt(0)
    s_waitcnt vmcnt(16)
    s_cmp_lg_u32 s3, 0
    s_cbranch_scc1 WDD_55
    v_mov_b32 v173, 128
    s_mov_b32 s60, 0
    s_branch WD_54_F
WD_54:
    global_load_dword v172, v173, s[32:33] sc1
    s_waitcnt vmcnt(0)
WD_54_F:
    v_readfirstlane_b32 s61, v172
    s_cmp_ge_u32 s61, 2097408
    s_cbranch_scc1 WDD_55
    s_add_u32 s60, s60, 1
    s_cmp_lt_u32 s60, 200000
    s_cbranch_scc1 WD_54
    v_mov_b32 v1, 32
    v_mov_b32 v2, 224
    global_atomic_or v2, v1, s[32:33] sc1
    s_waitcnt vmcnt(0)
    s_endpgm
WDD_55:
    s_barrier
    ds_read2st64_b32 v[16:17], v10 offset0:0 offset1:4
    ds_read2st64_b32 v[18:19], v10 offset0:8 offset1:12
    ds_read2st64_b32 v[20:21], v13 offset0:0 offset1:4
    ds_read2st64_b32 v[22:23], v13 offset0:8 offset1:12
    ds_read2st64_b32 v[24:25], v14 offset0:0 offset1:4
    ds_read2st64_b32 v[26:27], v14 offset0:8 offset1:12
    ds_read2st64_b32 v[28:29], v15 offset0:0 offset1:4
    ds_read2st64_b32 v[30:31], v15 offset0:8 offset1:12
    s_add_u32 m0, s88, 110592
    s_add_u32 s60, s84, 573440
    buffer_load_dwordx4 v12, s[48:51], s60 offen offset:0 lds
    s_add_u32 s60, s84, 580608
    buffer_load_dwordx4 v12, s[48:51], s60 offen offset:1024 lds
    s_add_u32 s60, s84, 702464
    buffer_load_dwordx4 v12, s[48:51], s60 offen offset:2048 lds
    s_add_u32 s60, s84, 709632
    buffer_load_dwordx4 v12, s[48:51], s60 offen offset:3072 lds
    s_waitcnt lgkmcnt(6)
    v_add_u32 v10, -147456, v10
    v_perm_b32 v64, v17, v16, s56
    v_perm_b32 v65, v19, v18, s56
    v_accvgpr_write_b32 a214, v64
    v_accvgpr_write_b32 a215, v65
    v_perm_b32 v66, v17, v16, s57
    v_perm_b32 v67, v19, v18, s57
    v_accvgpr_write_b32 a222, v66
    v_accvgpr_write_b32 a223, v67
    s_waitcnt lgkmcnt(4)
    v_add_u32 v13, -147456, v13
    v_perm_b32 v68, v21, v20, s56
    v_perm_b32 v69, v23, v22, s56
    v_accvgpr_write_b32 a246, v68
    v_accvgpr_write_b32 a247, v69
    v_perm_b32 v70, v21, v20, s57
    v_perm_b32 v71, v23, v22, s57
    v_accvgpr_write_b32 a254, v70
    v_accvgpr_write_b32 a255, v71
    s_waitcnt lgkmcnt(2)
    v_add_u32 v14, -147456, v14
    v_perm_b32 v150, v25, v24, s56
    v_perm_b32 v151, v27, v26, s56
    v_perm_b32 v158, v25, v24, s57
    v_perm_b32 v159, v27, v26, s57
    s_waitcnt lgkmcnt(0)
    v_add_u32 v15, -147456, v15
    v_perm_b32 v76, v29, v28, s56
    v_perm_b32 v77, v31, v30, s56
    ds_write_b64 v3, v[76:77] offset:13320
    v_perm_b32 v78, v29, v28, s57
    v_perm_b32 v79, v31, v30, s57
    ds_write_b64 v3, v[78:79] offset:15368
    v_perm_b32 v200, v36, v32, s56
    v_perm_b32 v201, v36, v32, s57
    v_perm_b32 v232, v37, v33, s56
    v_perm_b32 v233, v37, v33, s57
    v_perm_b32 v112, v38, v34, s56
    v_perm_b32 v113, v38, v34, s57
    v_perm_b32 v120, v39, v35, s56
    v_perm_b32 v121, v39, v35, s57
    v_perm_b32 v202, v44, v40, s56
    v_perm_b32 v203, v44, v40, s57
    v_perm_b32 v234, v45, v41, s56
    v_perm_b32 v235, v45, v41, s57
    v_perm_b32 v114, v46, v42, s56
    v_perm_b32 v115, v46, v42, s57
    v_perm_b32 v122, v47, v43, s56
    v_perm_b32 v123, v47, v43, s57
    s_waitcnt lgkmcnt(0)
    s_waitcnt vmcnt(16)
    s_barrier
    ds_read2st64_b32 v[16:17], v10 offset0:0 offset1:4
    ds_read2st64_b32 v[18:19], v10 offset0:8 offset1:12
    ds_read2st64_b32 v[20:21], v13 offset0:0 offset1:4
    ds_read2st64_b32 v[22:23], v13 offset0:8 offset1:12
    ds_read2st64_b32 v[24:25], v14 offset0:0 offset1:4
    ds_read2st64_b32 v[26:27], v14 offset0:8 offset1:12
    ds_read2st64_b32 v[28:29], v15 offset0:0 offset1:4
    ds_read2st64_b32 v[30:31], v15 offset0:8 offset1:12
    s_lshl_b32 s61, s64, 4
    s_add_u32 s74, s61, 87031808
    v_bfe_u32 v35, v1, 2, 4
    v_mov_b32 v36, 0
    buffer_load_dword v32, v35, s[36:39], s74 offen offset:0 sc1
    buffer_load_dword v33, v35, s[36:39], s74 offen offset:512 sc1
    global_load_dword v34, v36, s[32:33] sc1
    s_waitcnt lgkmcnt(6)
    v_add_u32 v10, 36864, v10
    v_perm_b32 v64, v17, v16, s56
    v_perm_b32 v65, v19, v18, s56
    v_accvgpr_write_b32 a224, v64
    v_accvgpr_write_b32 a225, v65
    v_perm_b32 v66, v17, v16, s57
    v_perm_b32 v67, v19, v18, s57
    v_accvgpr_write_b32 a232, v66
    v_accvgpr_write_b32 a233, v67
    s_waitcnt lgkmcnt(4)
    v_add_u32 v13, 36864, v13
    v_perm_b32 v128, v21, v20, s56
    v_perm_b32 v129, v23, v22, s56
    v_perm_b32 v136, v21, v20, s57
    v_perm_b32 v137, v23, v22, s57
    s_waitcnt lgkmcnt(2)
    v_add_u32 v14, 36864, v14
    v_perm_b32 v160, v25, v24, s56
    v_perm_b32 v161, v27, v26, s56
    v_perm_b32 v168, v25, v24, s57
    v_perm_b32 v169, v27, v26, s57
    s_waitcnt lgkmcnt(0)
    v_add_u32 v15, 36864, v15
    v_perm_b32 v76, v29, v28, s56
    v_perm_b32 v77, v31, v30, s56
    ds_write_b64 v3, v[76:77] offset:16384
    v_perm_b32 v78, v29, v28, s57
    v_perm_b32 v79, v31, v30, s57
    ds_write_b64 v3, v[78:79] offset:18432
    s_waitcnt lgkmcnt(0)
    s_waitcnt vmcnt(15)
    s_barrier
    ds_read2st64_b32 v[16:17], v10 offset0:0 offset1:4
    ds_read2st64_b32 v[18:19], v10 offset0:8 offset1:12
    ds_read2st64_b32 v[20:21], v13 offset0:0 offset1:4
    ds_read2st64_b32 v[22:23], v13 offset0:8 offset1:12
    ds_read2st64_b32 v[24:25], v14 offset0:0 offset1:4
    ds_read2st64_b32 v[26:27], v14 offset0:8 offset1:12
    ds_read2st64_b32 v[28:29], v15 offset0:0 offset1:4
    ds_read2st64_b32 v[30:31], v15 offset0:8 offset1:12
    s_waitcnt lgkmcnt(6)
    v_add_u32 v10, 36864, v10
    v_perm_b32 v64, v17, v16, s56
    v_perm_b32 v65, v19, v18, s56
    v_accvgpr_write_b32 a226, v64
    v_accvgpr_write_b32 a227, v65
    v_perm_b32 v66, v17, v16, s57
    v_perm_b32 v67, v19, v18, s57
    v_accvgpr_write_b32 a234, v66
    v_accvgpr_write_b32 a235, v67
    s_waitcnt lgkmcnt(4)
    v_add_u32 v13, 36864, v13
    v_perm_b32 v130, v21, v20, s56
    v_perm_b32 v131, v23, v22, s56
    v_perm_b32 v138, v21, v20, s57
    v_perm_b32 v139, v23, v22, s57
    s_waitcnt lgkmcnt(2)
    v_add_u32 v14, 36864, v14
    v_perm_b32 v162, v25, v24, s56
    v_perm_b32 v163, v27, v26, s56
    v_perm_b32 v170, v25, v24, s57
    v_perm_b32 v171, v27, v26, s57
    s_waitcnt lgkmcnt(0)
    v_add_u32 v15, 36864, v15
    v_perm_b32 v76, v29, v28, s56
    v_perm_b32 v77, v31, v30, s56
    ds_write_b64 v3, v[76:77] offset:16392
    v_perm_b32 v78, v29, v28, s57
    v_perm_b32 v79, v31, v30, s57
    ds_write_b64 v3, v[78:79] offset:18440
    s_waitcnt lgkmcnt(0)
    s_waitcnt vmcnt(7)
    s_barrier
    ds_read2st64_b32 v[16:17], v10 offset0:0 offset1:4
    ds_read2st64_b32 v[18:19], v10 offset0:8 offset1:12
    ds_read2st64_b32 v[20:21], v13 offset0:0 offset1:4
    ds_read2st64_b32 v[22:23], v13 offset0:8 offset1:12
    ds_read2st64_b32 v[24:25], v14 offset0:0 offset1:4
    ds_read2st64_b32 v[26:27], v14 offset0:8 offset1:12
    ds_read2st64_b32 v[28:29], v15 offset0:0 offset1:4
    ds_read2st64_b32 v[30:31], v15 offset0:8 offset1:12
    s_waitcnt lgkmcnt(6)
    v_add_u32 v10, 36864, v10
    v_perm_b32 v64, v17, v16, s56
    v_perm_b32 v65, v19, v18, s56
    v_accvgpr_write_b32 a228, v64
    v_accvgpr_write_b32 a229, v65
    v_perm_b32 v66, v17, v16, s57
    v_perm_b32 v67, v19, v18, s57
    v_accvgpr_write_b32 a236, v66
    v_accvgpr_write_b32 a237, v67
    s_waitcnt lgkmcnt(4)
    v_add_u32 v13, 36864, v13
    v_perm_b32 v132, v21, v20, s56
    v_perm_b32 v133, v23, v22, s56
    v_perm_b32 v140, v21, v20, s57
    v_perm_b32 v141, v23, v22, s57
    s_waitcnt lgkmcnt(2)
    v_add_u32 v14, 36864, v14
    v_perm_b32 v164, v25, v24, s56
    v_perm_b32 v165, v27, v26, s56
    v_perm_b32 v172, v25, v24, s57
    v_perm_b32 v173, v27, v26, s57
    s_waitcnt lgkmcnt(0)
    v_add_u32 v15, 36864, v15
    v_perm_b32 v76, v29, v28, s56
    v_perm_b32 v77, v31, v30, s56
    ds_write_b64 v3, v[76:77] offset:17408
    v_perm_b32 v78, v29, v28, s57
    v_perm_b32 v79, v31, v30, s57
    ds_write_b64 v3, v[78:79] offset:19456
    v_perm_b32 v204, v52, v48, s56
    v_perm_b32 v205, v52, v48, s57
    v_perm_b32 v236, v53, v49, s56
    v_perm_b32 v237, v53, v49, s57
    v_perm_b32 v116, v54, v50, s56
    v_perm_b32 v117, v54, v50, s57
    v_perm_b32 v124, v55, v51, s56
    v_perm_b32 v125, v55, v51, s57
    v_perm_b32 v206, v60, v56, s56
    v_perm_b32 v207, v60, v56, s57
    v_perm_b32 v238, v61, v57, s56
    v_perm_b32 v239, v61, v57, s57
    v_perm_b32 v118, v62, v58, s56
    v_perm_b32 v119, v62, v58, s57
    v_perm_b32 v126, v63, v59, s56
    v_perm_b32 v127, v63, v59, s57
    s_waitcnt lgkmcnt(0)
    s_waitcnt vmcnt(3)
    s_barrier
    ds_read2st64_b32 v[16:17], v10 offset0:0 offset1:4
    ds_read2st64_b32 v[18:19], v10 offset0:8 offset1:12
    ds_read2st64_b32 v[20:21], v13 offset0:0 offset1:4
    ds_read2st64_b32 v[22:23], v13 offset0:8 offset1:12
    ds_read2st64_b32 v[24:25], v14 offset0:0 offset1:4
    ds_read2st64_b32 v[26:27], v14 offset0:8 offset1:12
    ds_read2st64_b32 v[28:29], v15 offset0:0 offset1:4
    ds_read2st64_b32 v[30:31], v15 offset0:8 offset1:12
    s_waitcnt lgkmcnt(6)
    v_add_u32 v10, 36864, v10
    v_perm_b32 v64, v17, v16, s56
    v_perm_b32 v65, v19, v18, s56
    v_accvgpr_write_b32 a230, v64
    v_accvgpr_write_b32 a231, v65
    v_perm_b32 v66, v17, v16, s57
    v_perm_b32 v67, v19, v18, s57
    v_accvgpr_write_b32 a238, v66
    v_accvgpr_write_b32 a239, v67
    s_waitcnt lgkmcnt(4)
    v_add_u32 v13, 36864, v13
    v_perm_b32 v134, v21, v20, s56
    v_perm_b32 v135, v23, v22, s56
    v_perm_b32 v142, v21, v20, s57
    v_perm_b32 v143, v23, v22, s57
    s_waitcnt lgkmcnt(2)
    v_add_u32 v14, 36864, v14
    v_perm_b32 v166, v25, v24, s56
    v_perm_b32 v167, v27, v26, s56
    v_perm_b32 v174, v25, v24, s57
    v_perm_b32 v175, v27, v26, s57
    s_waitcnt lgkmcnt(0)
    v_add_u32 v15, 36864, v15
    v_perm_b32 v76, v29, v28, s56
    v_perm_b32 v77, v31, v30, s56
    ds_write_b64 v3, v[76:77] offset:17416
    v_perm_b32 v78, v29, v28, s57
    v_perm_b32 v79, v31, v30, s57
    ds_write_b64 v3, v[78:79] offset:19464
    s_waitcnt lgkmcnt(0)
    s_barrier
    s_waitcnt vmcnt(0)
    v_mov_b32 v10, v32
    v_cmp_ne_u32 vcc, 1, v10
    s_mov_b32 s61, 0
    s_nop 3
    s_cmp_eq_u32 vcc_hi, 0
    s_cbranch_scc1 FWD_57
FW_56:
    v_bfe_u32 v11, v1, 2, 4
    buffer_load_dword v10, v11, s[36:39], s74 offen sc1
    s_waitcnt vmcnt(0)
    v_cmp_ne_u32 vcc, 1, v10
    s_cbranch_vccz FWD_57
    s_add_u32 s61, s61, 1
    s_cmp_lt_u32 s61, 200000
    s_cbranch_scc1 FW_56
    v_mov_b32 v1, 128
    v_mov_b32 v2, 224
    global_atomic_or v2, v1, s[32:33] sc1
    s_waitcnt vmcnt(0)
    s_endpgm
FWD_57:
    s_mov_b32 m0, s81
    s_add_u32 s60, s71, 8192
    buffer_load_dwordx4 v1, s[36:39], s71 offen offset:0 lds
    buffer_load_dwordx4 v1, s[36:39], s71 offen offset:1024 lds
    s_mov_b32 m0, s82
    s_nop 0
    buffer_load_dwordx4 v1, s[36:39], s60 offen offset:0 lds
    buffer_load_dwordx4 v1, s[36:39], s60 offen offset:1024 lds
    buffer_load_dwordx4 v[16:19], v1, s[36:39], s66 offen offset:0 sc1
    buffer_load_dwordx4 v[20:23], v1, s[36:39], s66 offen offset:1024 sc1
    buffer_load_dwordx4 v[16:19], v1, s[36:39], s66 offen offset:0 sc1
    buffer_load_dwordx4 v[20:23], v1, s[36:39], s66 offen offset:1024 sc1
    ds_write_b128 v3, v[80:83] offset:20480
    ds_write_b128 v3, v[84:87] offset:21504
    ds_write_b128 v3, v[88:91] offset:22528
    ds_write_b128 v3, v[92:95] offset:23552
    ds_write_b128 v3, v[96:99] offset:24576
    ds_write_b128 v3, v[100:103] offset:25600
    ds_write_b128 v3, v[104:107] offset:26624
    ds_write_b128 v3, v[108:111] offset:27648
    ds_write_b128 v3, v[112:115] offset:28672
    ds_write_b128 v3, v[116:119] offset:29696
    ds_write_b128 v3, v[120:123] offset:30720
    ds_write_b128 v3, v[124:127] offset:31744
    s_waitcnt lgkmcnt(0)
    v_and_b32 v44, 15, v0
    v_lshrrev_b32 v45, 3, v44
    v_lshlrev_b32 v45, 4, v45
    v_mov_b32 v46, 0x3f80
    v_lshlrev_b32 v46, v45, v46
    v_and_b32 v47, 7, v44
    v_cmp_eq_u32 vcc, 0, v47
    s_nop 1
    v_cndmask_b32 v12, 0, v46, vcc
    v_cmp_eq_u32 vcc, 1, v47
    s_nop 1
    v_cndmask_b32 v13, 0, v46, vcc
    v_cmp_eq_u32 vcc, 4, v47
    s_nop 1
    v_cndmask_b32 v14, 0, v46, vcc
    v_cmp_eq_u32 vcc, 5, v47
    s_nop 1
    v_cndmask_b32 v15, 0, v46, vcc
    v_and_b32 v47, 3, v44
    v_cmp_eq_u32 vcc, 2, v47
    v_mov_b32 v46, 0x3f803f80
    s_nop 0
    v_cndmask_b32 v12, v12, v46, vcc
    v_cndmask_b32 v13, v13, v46, vcc
    v_cndmask_b32 v14, v14, v46, vcc
    v_cndmask_b32 v15, v15, v46, vcc
    v_add_u32 v64, s78, v3
    v_add_u32 v65, s79, v3
    v_add_u32 v66, s80, v3
    s_add_u32 s71, s71, 524288
    s_add_u32 s74, s74, 512
    v_mov_b32 v10, v33
    v_cmp_ne_u32 vcc, 1, v10
    s_mov_b32 s61, 0
    s_nop 3
    s_cmp_eq_u32 vcc_hi, 0
    s_cbranch_scc1 FWD_59
FW_58:
    v_bfe_u32 v11, v1, 2, 4
    buffer_load_dword v10, v11, s[36:39], s74 offen sc1
    s_waitcnt vmcnt(0)
    v_cmp_ne_u32 vcc, 1, v10
    s_cbranch_vccz FWD_59
    s_add_u32 s61, s61, 1
    s_cmp_lt_u32 s61, 200000
    s_cbranch_scc1 FW_58
    v_mov_b32 v1, 128
    v_mov_b32 v2, 224
    global_atomic_or v2, v1, s[32:33] sc1
    s_waitcnt vmcnt(0)
    s_endpgm
FWD_59:
    s_add_u32 s74, s74, 512
    ds_read_b128 v[96:99], v3 offset:0
    ds_read_b128 v[100:103], v3 offset:1024
    ds_read_b128 v[104:107], v3 offset:2048
    ds_read_b128 v[108:111], v3 offset:3072
    ds_read_b128 v[112:115], v3 offset:4096
    ds_read_b128 v[116:119], v3 offset:5120
    v_bfe_u32 v0, v1, 6, 3
    v_and_b32 v11, 48, v1
    v_mad_u32_u24 v0, v0, s10, v11
    v_lshrrev_b32 v11, 9, v1
    v_mad_u32_u24 v0, v11, s11, v0
    v_add_u32 v0, s9, v0
    ds_read_b128 v[68:71], v0
    ds_read_b128 v[120:123], v3 offset:6144
    ds_read_b128 v[124:127], v3 offset:7168
    ds_read_b128 v[80:83], v3 offset:8192
    ds_read_b128 v[84:87], v3 offset:9216
    ds_read_b128 v[88:91], v3 offset:10240
    ds_read_b128 v[92:95], v3 offset:11264
    v_mov_b64 v[48:49], 0
    v_mov_b64 v[50:51], 0
    v_mov_b64 v[52:53], 0
    v_mov_b64 v[54:55], 0
    v_mov_b64 v[56:57], 0
    v_mov_b64 v[58:59], 0
    v_mov_b64 v[60:61], 0
    v_mov_b64 v[62:63], 0
    v_mov_b64 v[72:73], 0
    v_mov_b64 v[74:75], 0
    v_mov_b64 v[76:77], 0
    v_mov_b64 v[78:79], 0
    s_sub_u32 s12, s74, s71
    v_bfe_u32 v0, v1, 8, 1
    v_and_b32 v67, 0xf0, v1
    v_lshlrev_b32 v0, 13, v0
    v_lshl_add_u32 v67, v67, 3, v0
    s_mov_b32 exec_lo, 0
    v_bfe_u32 v67, v1, 2, 4
    v_add_u32 v67, s12, v67
    s_mov_b32 exec_lo, -1
    ds_write_b128 v1, v[72:75] offset:8192
    v_readfirstlane_b32 s60, v34
    s_waitcnt lgkmcnt(0)
    s_cmp_lt_u32 s60, 32
    s_cbranch_scc1 REC_SLOW
    s_branch RT_60
    .p2align 7
RT_60:
    s_mov_b32 s61, 0
    s_branch PAE_63
PA_62:
    s_mov_b64 exec, vcc
    buffer_load_dwordx4 v[16:19], v1, s[36:39], s66 offen offset:0 sc1
    s_mov_b64 exec, -1
    s_waitcnt vmcnt(3)
    v_max3_u32 v0, v20, v21, v22
    v_max_u32 v0, v0, v23
    v_cmpx_eq_u32 vcc, -1, v0
    buffer_load_dwordx4 v[20:23], v1, s[36:39], s66 offen offset:1024 sc1
    s_mov_b64 exec, -1
    s_add_u32 s61, s61, 1
    s_cmp_lt_u32 s61, 200000
    s_cbranch_scc0 PAD_66
PAE_63:
    s_waitcnt vmcnt(3)
    v_max3_u32 v0, v16, v17, v18
    v_max_u32 v0, v0, v19
    v_cmp_eq_u32 vcc, -1, v0
    ds_write_b128 v3, v[16:19] offset:34816
    s_cbranch_vccnz PA_62
    v_smfmac_f32_16x16x64_bf16 v[48:51], v[16:19], v[96:103], v2
    s_waitcnt vmcnt(2)
    v_max3_u32 v0, v20, v21, v22
    v_max_u32 v0, v0, v23
    v_smfmac_f32_16x16x64_bf16 v[52:55], v[16:19], v[104:111], v2
    ds_write_b128 v3, v[20:23] offset:35840
    v_cmp_eq_u32 vcc, -1, v0
    v_smfmac_f32_16x16x64_bf16 v[56:59], v[16:19], v[80:87], v2
    v_smfmac_f32_16x16x64_bf16 v[60:63], v[16:19], v[88:95], v2
    s_cbranch_vccnz PB_64
PBE_65:
    s_cmp_eq_u32 s65, 63
    s_cbranch_scc1 RL_67
    s_waitcnt lgkmcnt(0)
    s_barrier
    ds_read_b128 v[24:27], v64 offset:34816
    ds_read_b128 v[28:31], v64 offset:35840
    v_smfmac_f32_16x16x64_bf16 v[48:51], v[20:23], v[112:119], v2
    buffer_load_dword v10, v67, s[36:39], s71 offen
    ds_read_b128 v[32:35], v65 offset:34816
    v_smfmac_f32_16x16x64_bf16 v[52:55], v[20:23], v[120:127], v2
    ds_read_b128 v[36:39], v65 offset:35840
    v_smfmac_f32_16x16x64_bf16 v[56:59], v[20:23], a[96:103], v2
    ds_read_b128 v[40:43], v66 offset:34816
    v_smfmac_f32_16x16x64_bf16 v[60:63], v[20:23], a[104:111], v2
    ds_read_b128 v[44:47], v66 offset:35840
    s_waitcnt lgkmcnt(5)
    v_smfmac_f32_16x16x64_bf16 v[48:51], v[24:27], a[0:7], v2
    ds_read_b128 v[96:99], v1 offset:0
    v_smfmac_f32_16x16x64_bf16 v[52:55], v[24:27], a[8:15], v2
    ds_read_b128 v[100:103], v1 offset:4096
    s_waitcnt lgkmcnt(6)
    v_smfmac_f32_16x16x64_bf16 v[48:51], v[28:31], a[16:23], v2
    ds_read_b128 v[104:107], v1 offset:1024
    v_smfmac_f32_16x16x64_bf16 v[52:55], v[28:31], a[24:31], v2
    ds_read_b128 v[108:111], v1 offset:5120
    buffer_store_dwordx4 v[68:71], v1, s[36:39], s70 offen sc1
    s_waitcnt lgkmcnt(7)
    v_smfmac_f32_16x16x64_bf16 v[48:51], v[32:35], a[32:39], v2
    ds_read_b128 v[112:115], v1 offset:2048
    v_smfmac_f32_16x16x64_bf16 v[52:55], v[32:35], a[40:47], v2
    ds_read_b128 v[116:119], v1 offset:6144
    s_waitcnt lgkmcnt(8)
    v_smfmac_f32_16x16x64_bf16 v[48:51], v[36:39], a[48:55], v2
    ds_read_b128 v[120:123], v1 offset:3072
    v_smfmac_f32_16x16x64_bf16 v[52:55], v[36:39], a[56:63], v2
    ds_read_b128 v[124:127], v1 offset:7168
    s_waitcnt lgkmcnt(8)
    v_smfmac_f32_16x16x64_bf16 v[48:51], v[40:43], a[64:71], v2
    v_smfmac_f32_16x16x64_bf16 v[48:51], v[44:47], a[80:87], v2
    v_smfmac_f32_16x16x64_bf16 v[52:55], v[40:43], a[72:79], v2
    v_smfmac_f32_16x16x64_bf16 v[52:55], v[44:47], a[88:95], v2
    v_add_f32 v48, v48, v50
    v_smfmac_f32_16x16x64_bf16 v[56:59], v[24:27], a[112:119], v2
    v_add_f32 v49, v49, v51
    v_smfmac_f32_16x16x64_bf16 v[60:63], v[24:27], a[120:127], v2
    v_add_f32 v52, v52, v54
    v_cvt_pk_bf16_f32 v0, v48, v52
    v_smfmac_f32_16x16x64_bf16 v[56:59], v[28:31], a[128:135], v2
    ds_write_b32 v4, v0 offset:0
    v_add_f32 v53, v53, v55
    v_cvt_pk_bf16_f32 v11, v49, v53
    v_smfmac_f32_16x16x64_bf16 v[60:63], v[28:31], a[136:143], v2
    ds_write_b32 v4, v11 offset:288
    v_smfmac_f32_16x16x64_bf16 v[56:59], v[32:35], a[144:151], v2
    v_smfmac_f32_16x16x64_bf16 v[60:63], v[32:35], a[152:159], v2
    v_smfmac_f32_16x16x64_bf16 v[56:59], v[36:39], a[160:167], v2
    s_waitcnt lgkmcnt(0)
    s_barrier
    v_smfmac_f32_16x16x64_bf16 v[60:63], v[36:39], a[168:175], v2
    ds_read_b128 v[80:83], v5 offset:0
    ds_read_b128 v[84:87], v5 offset:64
    v_smfmac_f32_16x16x64_bf16 v[56:59], v[40:43], a[176:183], v2
    ds_read_b128 v[88:91], v5 offset:128
    v_smfmac_f32_16x16x64_bf16 v[56:59], v[44:47], a[192:199], v2
    ds_read_b128 v[92:95], v5 offset:192
    v_smfmac_f32_16x16x64_bf16 v[60:63], v[40:43], a[184:191], v2
    v_smfmac_f32_16x16x64_bf16 v[60:63], v[44:47], a[200:207], v2
    v_add_f32 v56, v56, v58
    v_smfmac_f32_16x16x64_bf16 v[72:75], v[16:19], a[208:215], v2
    s_waitcnt lgkmcnt(3)
    v_add_f32 v57, v57, v59
    v_mfma_f32_16x16x32_bf16 v[48:51], v[96:99], v[80:83], 0
    v_add_f32 v60, v60, v62
    v_cvt_pk_bf16_f32 v0, v56, v60
    v_mfma_f32_16x16x32_bf16 v[52:55], v[100:103], v[80:83], 0
    ds_write_b32 v4, v0 offset:2304
    v_add_f32 v61, v61, v63
    v_cvt_pk_bf16_f32 v11, v57, v61
    s_waitcnt lgkmcnt(3)
    v_mfma_f32_16x16x32_bf16 v[48:51], v[104:107], v[84:87], v[48:51]
    ds_write_b32 v4, v11 offset:2592
    v_mfma_f32_16x16x32_bf16 v[52:55], v[108:111], v[84:87], v[52:55]
    s_waitcnt lgkmcnt(2)
    ds_read_b128 v[96:99], v3 offset:12288
    v_mfma_f32_16x16x32_bf16 v[48:51], v[112:115], v[88:91], v[48:51]
    ds_read_b128 v[100:103], v3 offset:13312
    v_mfma_f32_16x16x32_bf16 v[52:55], v[116:119], v[88:91], v[52:55]
    s_mov_b32 m0, s81
    ds_read_b128 v[104:107], v3 offset:14336
    v_mfma_f32_16x16x32_bf16 v[48:51], v[120:123], v[92:95], v[48:51]
    ds_read_b128 v[108:111], v3 offset:15360
    v_mfma_f32_16x16x32_bf16 v[52:55], v[124:127], v[92:95], v[52:55]
    s_waitcnt lgkmcnt(4)
    s_barrier
    v_smfmac_f32_16x16x64_bf16 v[76:79], v[16:19], a[216:223], v2
    ds_read_b128 v[56:59], v6 offset:2304
    ds_read_b128 v[60:63], v6 offset:2368
    v_smfmac_f32_16x16x64_bf16 v[72:75], v[20:23], a[224:231], v2
    ds_read_b128 v[112:115], v6 offset:2432
    v_max3_f32 v0, v48, v49, v50
    v_smfmac_f32_16x16x64_bf16 v[76:79], v[20:23], a[232:239], v2
    ds_read_b128 v[116:119], v6 offset:2496
    v_max3_f32 v11, v52, v53, v54
    v_smfmac_f32_16x16x64_bf16 v[72:75], v[24:27], a[240:247], v2
    ds_read_b128 v[120:123], v3 offset:18432
    v_max3_f32 v0, v0, v51, v55
    v_smfmac_f32_16x16x64_bf16 v[76:79], v[24:27], a[248:255], v2
    s_waitcnt vmcnt(2) lgkmcnt(3)
    ds_read_b128 v[124:127], v3 offset:19456
    v_max_f32 v0, v0, v11
    v_mfma_f32_16x16x32_bf16 v[16:19], v[56:59], v[80:83], 0
    v_mov_b32 v11, v0
    v_cndmask_b32 v48, v48, v52, s[72:73]
    v_mfma_f32_16x16x32_bf16 v[16:19], v[60:63], v[84:87], v[16:19]
    s_waitcnt lgkmcnt(2)
    v_permlane16_swap_b32 v0, v11
    v_mfma_f32_16x16x32_bf16 v[16:19], v[112:115], v[88:91], v[16:19]
    v_cndmask_b32 v49, v49, v53, s[72:73]
    v_max_f32 v0, v0, v11
    v_mfma_f32_16x16x32_bf16 v[16:19], v[116:119], v[92:95], v[16:19]
    v_cndmask_b32 v50, v50, v54, s[72:73]
    v_cndmask_b32 v51, v51, v55, s[72:73]
    v_smfmac_f32_16x16x64_bf16 v[72:75], v[40:43], v[96:103], v2
    ds_read_b128 v[112:115], v3 offset:16384
    v_mov_b32 v85, 0
    v_smfmac_f32_16x16x64_bf16 v[76:79], v[40:43], v[104:111], v2
    ds_read_b128 v[116:119], v3 offset:17408
    v_max3_f32 v0, v0, v16, v17
    v_smfmac_f32_16x16x64_bf16 v[72:75], v[28:31], v[128:135], v2
    s_waitcnt lgkmcnt(2)
    ds_read_b128 v[56:59], v3 offset:32768
    v_max3_f32 v0, v0, v18, v19
    v_smfmac_f32_16x16x64_bf16 v[76:79], v[44:47], v[120:127], v2
    ds_read_b128 v[60:63], v3 offset:33792
    v_mov_b32 v11, v0
    v_smfmac_f32_16x16x64_bf16 v[72:75], v[32:35], v[144:151], v2
    ds_read_b128 v[88:91], v3 offset:20480
    v_permlane32_swap_b32 v0, v11
    v_smfmac_f32_16x16x64_bf16 v[76:79], v[28:31], v[136:143], v2
    ds_read_b128 v[92:95], v3 offset:21504
    v_max_f32 v0, v0, v11
    v_smfmac_f32_16x16x64_bf16 v[72:75], v[36:39], v[160:167], v2
    ds_read_b128 v[104:107], v3 offset:24576
    v_mul_f32 v0, s77, v0
    v_smfmac_f32_16x16x64_bf16 v[76:79], v[32:35], v[152:159], v2
    s_waitcnt lgkmcnt(5)
    ds_read_b128 v[108:111], v3 offset:25600
    v_fma_f32 v48, v48, s77, -v0
    v_smfmac_f32_16x16x64_bf16 v[72:75], v[44:47], v[112:119], v2
    ds_read_b128 v[120:123], v3 offset:28672
    v_fma_f32 v49, v49, s77, -v0
    v_smfmac_f32_16x16x64_bf16 v[76:79], v[36:39], v[168:175], v2
    ds_read_b128 v[124:127], v3 offset:29696
    v_fma_f32 v50, v50, s77, -v0
    v_fma_f32 v51, v51, s77, -v0
    v_exp_f32 v48, v48
    v_exp_f32 v49, v49
    v_fma_f32 v16, v16, s77, -v0
    v_fma_f32 v17, v17, s77, -v0
    v_exp_f32 v50, v50
    v_cvt_pk_bf16_f32 v0, v48, v49
    v_exp_f32 v51, v51
    v_exp_f32 v16, v16
    v_cvt_pk_bf16_f32 v11, v50, v51
    v_exp_f32 v17, v17
    v_mov_b32_dpp v80, v0 quad_perm:[0,1,0,1] row_mask:0xf bank_mask:0xf
    v_mov_b32_dpp v82, v0 quad_perm:[2,3,2,3] row_mask:0xf bank_mask:0xf
    v_mov_b32_dpp v81, v11 quad_perm:[0,1,0,1] row_mask:0xf bank_mask:0xf
    v_mov_b32_dpp v83, v11 quad_perm:[2,3,2,3] row_mask:0xf bank_mask:0xf
    v_cvt_pk_bf16_f32 v84, v16, v17
    s_waitcnt lgkmcnt(6)
    v_mov_b32 v86, 0
    v_mfma_f32_16x16x32_bf16 v[20:23], v[12:15], v[80:83], 0
    ds_read_b128 v[32:35], v1 offset:8192
    v_add_f32 v72, v72, v74
    v_add_f32 v73, v73, v75
    v_mfma_f32_16x16x32_bf16 v[24:27], v[56:59], v[80:83], 0
    ds_read_b128 v[36:39], v1 offset:8192
    v_add_f32 v76, v76, v78
    v_add_f32 v77, v77, v79
    v_mfma_f32_16x16x32_bf16 v[28:31], v[60:63], v[80:83], 0
    ds_read_b128 v[40:43], v1 offset:8192
    v_cvt_pk_bf16_f32 v74, v72, v73
    v_cvt_pk_bf16_f32 v75, v76, v77
    v_mfma_f32_16x16x16_bf16 v[20:23], v[12:13], v[84:85], v[20:23]
    ds_read_b128 v[44:47], v1 offset:8192
    v_cvt_pk_bf16_f32 v87, v16, v17
    v_mfma_f32_16x16x16_bf16 v[24:27], v[74:75], v[84:85], v[24:27]
    ds_write_b64 v7, v[74:75] offset:2048
    v_mfma_f32_16x16x16_bf16 v[28:31], v[74:75], v[86:87], v[28:31]
    v_rcp_f32 v0, v22
    s_add_u32 s65, s65, 1
    s_xor_b32 s66, s66, 8192
    s_nop 0
    v_pk_mul_f32 v[24:25], v[24:25], v[0:1] op_sel_hi:[1,0]
    v_pk_mul_f32 v[26:27], v[26:27], v[0:1] op_sel_hi:[1,0]
    s_nop 1
    v_pk_mul_f32 v[28:29], v[28:29], v[0:1] op_sel_hi:[1,0]
    v_pk_mul_f32 v[30:31], v[30:31], v[0:1] op_sel_hi:[1,0]
    v_cvt_pk_bf16_f32 v52, v24, v28
    v_cvt_pk_bf16_f32 v53, v25, v29
    v_cvt_pk_bf16_f32 v54, v26, v30
    v_cvt_pk_bf16_f32 v55, v27, v31
    ds_write_b128 v3, v[52:55] offset:34816
    s_waitcnt lgkmcnt(2)
    v_smfmac_f32_16x16x64_bf16 v[32:35], v[52:55], v[176:183], v2
    buffer_load_dwordx4 v1, s[36:39], s71 offen offset:0 lds
    v_smfmac_f32_16x16x64_bf16 v[36:39], v[52:55], v[208:215], v2
    buffer_load_dwordx4 v1, s[36:39], s71 offen offset:1024 lds
    v_smfmac_f32_16x16x64_bf16 v[40:43], v[52:55], v[240:247], v2
    v_smfmac_f32_16x16x64_bf16 v[44:47], v[52:55], v[248:255], v2
    s_waitcnt lgkmcnt(0)
    s_barrier
    ds_read_b128 v[16:19], v64 offset:34816
    ds_read_b128 v[20:23], v65 offset:34816
    ds_read_b128 v[24:27], v66 offset:34816
    s_mov_b32 m0, s82
    s_add_u32 s59, s71, 8192
    buffer_load_dwordx4 v1, s[36:39], s59 offen offset:0 lds
    buffer_load_dwordx4 v1, s[36:39], s59 offen offset:1024 lds
    s_add_u32 s70, s70, 131072
    s_waitcnt lgkmcnt(2)
    v_smfmac_f32_16x16x64_bf16 v[32:35], v[16:19], v[184:191], v2
    s_waitcnt lgkmcnt(1)
    ds_read_b128 v[96:99], v3 offset:22528
    v_smfmac_f32_16x16x64_bf16 v[32:35], v[20:23], v[192:199], v2
    s_waitcnt lgkmcnt(1)
    ds_read_b128 v[100:103], v3 offset:23552
    v_smfmac_f32_16x16x64_bf16 v[32:35], v[24:27], v[200:207], v2
    ds_read_b128 v[112:115], v3 offset:26624
    v_smfmac_f32_16x16x64_bf16 v[36:39], v[16:19], v[216:223], v2
    ds_read_b128 v[116:119], v3 offset:27648
    v_smfmac_f32_16x16x64_bf16 v[36:39], v[20:23], v[224:231], v2
    ds_read_b128 v[72:75], v3 offset:30720
    v_cvt_pk_bf16_f32 v56, v32, v33
    v_smfmac_f32_16x16x64_bf16 v[36:39], v[24:27], v[232:239], v2
    ds_read_b128 v[76:79], v3 offset:31744
    v_cvt_pk_bf16_f32 v57, v34, v35
    v_smfmac_f32_16x16x64_bf16 v[40:43], v[16:19], v[88:95], v2
    v_and_or_b32 v56, v56, -2, s8
    v_smfmac_f32_16x16x64_bf16 v[40:43], v[20:23], v[104:111], v2
    v_cvt_pk_bf16_f32 v58, v36, v37
    v_smfmac_f32_16x16x64_bf16 v[40:43], v[24:27], v[120:127], v2
    s_waitcnt lgkmcnt(2)
    v_cvt_pk_bf16_f32 v59, v38, v39
    v_smfmac_f32_16x16x64_bf16 v[44:47], v[16:19], v[96:103], v2
    buffer_store_dwordx4 v[56:59], v8, s[36:39], s67 offen
    v_smfmac_f32_16x16x64_bf16 v[44:47], v[20:23], v[112:119], v2
    s_waitcnt lgkmcnt(0)
    v_cvt_pk_bf16_f32 v60, v40, v41
    v_smfmac_f32_16x16x64_bf16 v[44:47], v[24:27], v[72:79], v2
    v_cvt_pk_bf16_f32 v61, v42, v43
    v_and_or_b32 v60, v60, -2, s8
    s_nop 5
    v_cvt_pk_bf16_f32 v62, v44, v45
    v_cvt_pk_bf16_f32 v63, v46, v47
    buffer_store_dwordx4 v[60:63], v8, s[36:39], s69 offen
    s_add_u32 s71, s71, 524288
    s_xor_b32 s60, s76, 8192
    v_mov_b32 v16, -1
    ds_read_b128 v[96:99], v3 offset:0
    ds_read_b128 v[100:103], v3 offset:1024
    ds_read_b128 v[104:107], v3 offset:2048
    ds_read_b128 v[108:111], v3 offset:3072
    ds_read_b128 v[112:115], v3 offset:4096
    ds_read_b128 v[116:119], v3 offset:5120
    v_bfe_u32 v0, v1, 6, 3
    v_and_b32 v11, 48, v1
    v_mad_u32_u24 v0, v0, s10, v11
    v_lshrrev_b32 v11, 9, v1
    v_mad_u32_u24 v0, v11, s11, v0
    v_add_u32 v0, s9, v0
    ds_read_b128 v[68:71], v0
    ds_read_b128 v[120:123], v3 offset:6144
    ds_read_b128 v[124:127], v3 offset:7168
    ds_read_b128 v[80:83], v3 offset:8192
    ds_read_b128 v[84:87], v3 offset:9216
    ds_read_b128 v[88:91], v3 offset:10240
    ds_read_b128 v[92:95], v3 offset:11264
    v_mov_b64 v[48:49], 0
    v_mov_b64 v[50:51], 0
    v_mov_b64 v[52:53], 0
    v_mov_b64 v[54:55], 0
    v_mov_b64 v[56:57], 0
    v_mov_b64 v[58:59], 0
    v_mov_b64 v[60:61], 0
    v_mov_b64 v[62:63], 0
    s_waitcnt vmcnt(1)
    buffer_load_dwordx4 v[24:27], v1, s[36:39], s68 offen offset:0 sc1
    buffer_load_dwordx4 v[28:31], v1, s[36:39], s68 offen offset:1024 sc1
    s_waitcnt vmcnt(2)
    buffer_load_dwordx4 v[40:43], v1, s[36:39], s68 offen offset:0 sc1
    buffer_load_dwordx4 v[44:47], v1, s[36:39], s68 offen offset:1024 sc1
    s_mov_b32 s61, 0
PL_68:
    s_waitcnt vmcnt(3)
    v_mfma_f32_16x16x32_bf16 v[32:35], v[12:15], v[24:27], 0
    v_xor_b32 v0, s8, v24
    s_waitcnt vmcnt(2)
    v_mfma_f32_16x16x32_bf16 v[32:35], v[12:15], v[28:31], v[32:35]
    v_xor_b32 v11, s8, v28
    v_or_b32 v17, v0, v11
    v_and_b32 v17, 1, v17
    v_cmp_ne_u32 vcc, 0, v17
    s_cbranch_vccz PK_69
    v_and_b32 v11, 1, v11
    v_and_b32 v0, 1, v0
    v_cmp_ne_u32 s[62:63], 0, v11
    v_cmpx_ne_u32 vcc, 0, v0
    buffer_load_dwordx4 v[24:27], v1, s[36:39], s68 offen offset:0 sc1
    s_mov_b64 exec, s[62:63]
    buffer_load_dwordx4 v[28:31], v1, s[36:39], s68 offen offset:1024 sc1
    s_mov_b64 exec, -1
    s_waitcnt vmcnt(3)
    v_mfma_f32_16x16x32_bf16 v[32:35], v[12:15], v[40:43], 0
    v_xor_b32 v0, s8, v40
    s_waitcnt vmcnt(2)
    v_mfma_f32_16x16x32_bf16 v[32:35], v[12:15], v[44:47], v[32:35]
    v_xor_b32 v11, s8, v44
    v_or_b32 v17, v0, v11
    v_and_b32 v17, 1, v17
    v_cmp_ne_u32 vcc, 0, v17
    s_cbranch_vccz PK_69
    v_and_b32 v11, 1, v11
    v_and_b32 v0, 1, v0
    v_cmp_ne_u32 s[62:63], 0, v11
    v_cmpx_ne_u32 vcc, 0, v0
    buffer_load_dwordx4 v[40:43], v1, s[36:39], s68 offen offset:0 sc1
    s_mov_b64 exec, s[62:63]
    buffer_load_dwordx4 v[44:47], v1, s[36:39], s68 offen offset:1024 sc1
    s_mov_b64 exec, -1
    s_add_u32 s61, s61, 1
    s_cmp_lt_u32 s61, 200000
    s_cbranch_scc1 PL_68
    s_branch PLD_70
PK_69:
    s_nop 3
    v_add_f32_dpp v32, v32, v32 row_ror:4 row_mask:0xf bank_mask:0xf
    v_add_f32_dpp v33, v33, v33 row_ror:4 row_mask:0xf bank_mask:0xf
    s_nop 0
    v_add_f32_dpp v32, v32, v32 row_ror:8 row_mask:0xf bank_mask:0xf
    v_add_f32_dpp v33, v33, v33 row_ror:8 row_mask:0xf bank_mask:0xf
    v_cvt_pk_bf16_f32 v32, v32, v33
    buffer_store_dword v32, v9, s[36:39], s60 offen
    buffer_store_dword v16, v9, s[36:39], s76 offen
    s_mov_b32 s76, s60
    s_xor_b32 s8, s8, 1
    v_cmp_ne_u32 vcc, 1, v10
    s_mov_b32 s61, 0
    s_nop 3
    s_cmp_eq_u32 vcc_hi, 0
    s_cbranch_scc1 FWD_72
FW_71:
    v_bfe_u32 v11, v1, 2, 4
    buffer_load_dword v10, v11, s[36:39], s74 offen sc1
    s_waitcnt vmcnt(0)
    v_cmp_ne_u32 vcc, 1, v10
    s_cbranch_vccz FWD_72
    s_add_u32 s61, s61, 1
    s_cmp_lt_u32 s61, 200000
    s_cbranch_scc1 FW_71
    v_mov_b32 v1, 8
    v_mov_b32 v2, 224
    global_atomic_or v2, v1, s[32:33] sc1
    s_waitcnt vmcnt(0)
    s_endpgm
FWD_72:
    s_add_u32 s74, s74, 512
    s_min_u32 s74, s74, s83
    v_mov_b64 v[72:73], 0
    v_mov_b64 v[74:75], 0
    v_mov_b64 v[76:77], 0
    v_mov_b64 v[78:79], 0
    s_waitcnt vmcnt(1)
    buffer_load_dwordx4 v[16:19], v1, s[36:39], s66 offen offset:0 sc1
    buffer_load_dwordx4 v[20:23], v1, s[36:39], s66 offen offset:1024 sc1
    s_sub_u32 s12, s74, s71
    v_bfe_u32 v0, v1, 8, 1
    v_and_b32 v67, 0xf0, v1
    v_lshlrev_b32 v0, 13, v0
    v_lshl_add_u32 v67, v67, 3, v0
    s_mov_b32 exec_lo, 0
    v_bfe_u32 v67, v1, 2, 4
    v_add_u32 v67, s12, v67
    s_mov_b32 exec_lo, -1
    buffer_load_dwordx4 v[16:19], v1, s[36:39], s66 offen offset:0 sc1
    buffer_load_dwordx4 v[20:23], v1, s[36:39], s66 offen offset:1024 sc1
    s_waitcnt lgkmcnt(0)
    s_branch RT_60
PB_64:
    s_mov_b64 exec, vcc
    buffer_load_dwordx4 v[20:23], v1, s[36:39], s66 offen offset:1024 sc1
    s_mov_b64 exec, -1
    s_add_u32 s61, s61, 1
    s_cmp_lt_u32 s61, 200000
    s_cbranch_scc0 PAD_66
    s_waitcnt vmcnt(1)
    v_max3_u32 v0, v20, v21, v22
    v_max_u32 v0, v0, v23
    v_cmp_eq_u32 vcc, -1, v0
    ds_write_b128 v3, v[20:23] offset:35840
    s_cbranch_vccnz PB_64
    s_branch PBE_65
PAD_66:
    v_mov_b32 v1, 4
    v_mov_b32 v2, 224
    global_atomic_or v2, v1, s[32:33] sc1
    s_waitcnt vmcnt(0)
    s_endpgm
PLD_70:
    v_mov_b32 v1, 16
    v_mov_b32 v2, 224
    global_atomic_or v2, v1, s[32:33] sc1
    s_waitcnt vmcnt(0)
    s_endpgm
RL_67:
    s_waitcnt lgkmcnt(0)
    s_barrier
    ds_read_b128 v[24:27], v64 offset:34816
    ds_read_b128 v[28:31], v64 offset:35840
    v_smfmac_f32_16x16x64_bf16 v[56:59], v[20:23], a[96:103], v2
    ds_read_b128 v[32:35], v65 offset:34816
    ds_read_b128 v[36:39], v65 offset:35840
    v_smfmac_f32_16x16x64_bf16 v[60:63], v[20:23], a[104:111], v2
    ds_read_b128 v[40:43], v66 offset:34816
    ds_read_b128 v[44:47], v66 offset:35840
    v_smfmac_f32_16x16x64_bf16 v[72:75], v[16:19], a[208:215], v2
    buffer_store_dwordx4 v[68:71], v1, s[36:39], s70 offen sc1
    ds_read_b128 v[96:99], v3 offset:12288
    ds_read_b128 v[100:103], v3 offset:13312
    v_smfmac_f32_16x16x64_bf16 v[76:79], v[16:19], a[216:223], v2
    ds_read_b128 v[104:107], v3 offset:14336
    ds_read_b128 v[108:111], v3 offset:15360
    v_smfmac_f32_16x16x64_bf16 v[72:75], v[20:23], a[224:231], v2
    ds_read_b128 v[112:115], v3 offset:16384
    ds_read_b128 v[116:119], v3 offset:17408
    v_smfmac_f32_16x16x64_bf16 v[76:79], v[20:23], a[232:239], v2
    ds_read_b128 v[120:123], v3 offset:18432
    ds_read_b128 v[124:127], v3 offset:19456
    s_waitcnt lgkmcnt(13)
    v_smfmac_f32_16x16x64_bf16 v[56:59], v[24:27], a[112:119], v2
    v_smfmac_f32_16x16x64_bf16 v[60:63], v[24:27], a[120:127], v2
    v_smfmac_f32_16x16x64_bf16 v[72:75], v[24:27], a[240:247], v2
    v_smfmac_f32_16x16x64_bf16 v[76:79], v[24:27], a[248:255], v2
    s_waitcnt lgkmcnt(12)
    v_smfmac_f32_16x16x64_bf16 v[56:59], v[28:31], a[128:135], v2
    v_smfmac_f32_16x16x64_bf16 v[60:63], v[28:31], a[136:143], v2
    v_smfmac_f32_16x16x64_bf16 v[72:75], v[28:31], v[128:135], v2
    v_smfmac_f32_16x16x64_bf16 v[76:79], v[28:31], v[136:143], v2
    s_waitcnt lgkmcnt(11)
    v_smfmac_f32_16x16x64_bf16 v[56:59], v[32:35], a[144:151], v2
    v_smfmac_f32_16x16x64_bf16 v[60:63], v[32:35], a[152:159], v2
    v_smfmac_f32_16x16x64_bf16 v[72:75], v[32:35], v[144:151], v2
    v_smfmac_f32_16x16x64_bf16 v[76:79], v[32:35], v[152:159], v2
    s_waitcnt lgkmcnt(10)
    v_smfmac_f32_16x16x64_bf16 v[56:59], v[36:39], a[160:167], v2
    v_smfmac_f32_16x16x64_bf16 v[60:63], v[36:39], a[168:175], v2
    v_smfmac_f32_16x16x64_bf16 v[72:75], v[36:39], v[160:167], v2
    v_smfmac_f32_16x16x64_bf16 v[76:79], v[36:39], v[168:175], v2
    s_waitcnt lgkmcnt(0)
    v_smfmac_f32_16x16x64_bf16 v[56:59], v[40:43], a[176:183], v2
    v_smfmac_f32_16x16x64_bf16 v[56:59], v[44:47], a[192:199], v2
    v_smfmac_f32_16x16x64_bf16 v[60:63], v[40:43], a[184:191], v2
    v_smfmac_f32_16x16x64_bf16 v[60:63], v[44:47], a[200:207], v2
    v_smfmac_f32_16x16x64_bf16 v[72:75], v[40:43], v[96:103], v2
    v_add_f32 v56, v56, v58
    v_add_f32 v57, v57, v59
    v_smfmac_f32_16x16x64_bf16 v[72:75], v[44:47], v[112:119], v2
    v_smfmac_f32_16x16x64_bf16 v[76:79], v[40:43], v[104:111], v2
    v_add_f32 v60, v60, v62
    v_add_f32 v61, v61, v63
    v_cvt_pk_bf16_f32 v0, v56, v60
    v_cvt_pk_bf16_f32 v11, v57, v61
    v_smfmac_f32_16x16x64_bf16 v[76:79], v[44:47], v[120:127], v2
    ds_write_b32 v4, v0 offset:2304
    ds_write_b32 v4, v11 offset:2592
    v_add_f32 v72, v72, v74
    v_add_f32 v73, v73, v75
    v_cvt_pk_bf16_f32 v74, v72, v73
    s_nop 7
    v_add_f32 v76, v76, v78
    v_add_f32 v77, v77, v79
    v_cvt_pk_bf16_f32 v75, v76, v77
    ds_write_b64 v7, v[74:75] offset:2048
RF_61:
    s_waitcnt lgkmcnt(0)
    s_barrier
    s_add_u32 s70, s70, 131072
    v_bfe_u32 v0, v1, 6, 3
    v_and_b32 v11, 48, v1
    v_mad_u32_u24 v0, v0, s10, v11
    v_lshrrev_b32 v11, 9, v1
    v_mad_u32_u24 v0, v11, s11, v0
    v_add_u32 v0, s9, v0
    ds_read_b128 v[68:71], v0
    s_waitcnt lgkmcnt(0)
    buffer_store_dwordx4 v[68:71], v1, s[36:39], s70 offen sc1
    s_waitcnt vmcnt(0)
    s_waitcnt vmcnt(0)
    s_endpgm
REC_SLOW:
RT_73:
    s_mov_b32 s61, 0
    s_branch PAE_76
PA_75:
    s_mov_b64 exec, vcc
    buffer_load_dwordx4 v[16:19], v1, s[36:39], s66 offen offset:0 sc1
    s_mov_b64 exec, -1
    s_waitcnt vmcnt(3)
    v_max3_u32 v0, v20, v21, v22
    v_max_u32 v0, v0, v23
    v_cmpx_eq_u32 vcc, -1, v0
    buffer_load_dwordx4 v[20:23], v1, s[36:39], s66 offen offset:1024 sc1
    s_mov_b64 exec, -1
    s_add_u32 s61, s61, 1
    s_cmp_lt_u32 s61, 200000
    s_cbranch_scc0 PAD_79
PAE_76:
    s_waitcnt vmcnt(3)
    v_max3_u32 v0, v16, v17, v18
    v_max_u32 v0, v0, v19
    v_cmp_eq_u32 vcc, -1, v0
    ds_write_b128 v3, v[16:19] offset:34816
    s_cbranch_vccnz PA_75
    v_smfmac_f32_16x16x64_bf16 v[48:51], v[16:19], v[96:103], v2
    s_waitcnt vmcnt(2)
    v_max3_u32 v0, v20, v21, v22
    v_max_u32 v0, v0, v23
    v_smfmac_f32_16x16x64_bf16 v[52:55], v[16:19], v[104:111], v2
    ds_write_b128 v3, v[20:23] offset:35840
    v_cmp_eq_u32 vcc, -1, v0
    v_smfmac_f32_16x16x64_bf16 v[56:59], v[16:19], v[80:87], v2
    v_smfmac_f32_16x16x64_bf16 v[60:63], v[16:19], v[88:95], v2
    s_cbranch_vccnz PB_77
PBE_78:
    s_cmp_eq_u32 s65, 63
    s_cbranch_scc1 RL_80
    s_waitcnt lgkmcnt(0)
    s_barrier
    ds_read_b128 v[24:27], v64 offset:34816
    ds_read_b128 v[28:31], v64 offset:35840
    v_smfmac_f32_16x16x64_bf16 v[48:51], v[20:23], v[112:119], v2
    buffer_load_dword v10, v67, s[36:39], s71 offen
    ds_read_b128 v[32:35], v65 offset:34816
    v_smfmac_f32_16x16x64_bf16 v[52:55], v[20:23], v[120:127], v2
    ds_read_b128 v[36:39], v65 offset:35840
    v_smfmac_f32_16x16x64_bf16 v[56:59], v[20:23], a[96:103], v2
    ds_read_b128 v[40:43], v66 offset:34816
    v_smfmac_f32_16x16x64_bf16 v[60:63], v[20:23], a[104:111], v2
    ds_read_b128 v[44:47], v66 offset:35840
    s_waitcnt lgkmcnt(5)
    v_smfmac_f32_16x16x64_bf16 v[48:51], v[24:27], a[0:7], v2
    ds_read_b128 v[96:99], v1 offset:0
    v_smfmac_f32_16x16x64_bf16 v[52:55], v[24:27], a[8:15], v2
    ds_read_b128 v[100:103], v1 offset:4096
    s_waitcnt lgkmcnt(6)
    v_smfmac_f32_16x16x64_bf16 v[48:51], v[28:31], a[16:23], v2
    ds_read_b128 v[104:107], v1 offset:1024
    v_smfmac_f32_16x16x64_bf16 v[52:55], v[28:31], a[24:31], v2
    ds_read_b128 v[108:111], v1 offset:5120
    buffer_store_dwordx4 v[68:71], v1, s[36:39], s70 offen sc1
    s_waitcnt lgkmcnt(7)
    v_smfmac_f32_16x16x64_bf16 v[48:51], v[32:35], a[32:39], v2
    ds_read_b128 v[112:115], v1 offset:2048
    v_smfmac_f32_16x16x64_bf16 v[52:55], v[32:35], a[40:47], v2
    ds_read_b128 v[116:119], v1 offset:6144
    s_waitcnt lgkmcnt(8)
    v_smfmac_f32_16x16x64_bf16 v[48:51], v[36:39], a[48:55], v2
    ds_read_b128 v[120:123], v1 offset:3072
    v_smfmac_f32_16x16x64_bf16 v[52:55], v[36:39], a[56:63], v2
    ds_read_b128 v[124:127], v1 offset:7168
    s_waitcnt lgkmcnt(8)
    v_smfmac_f32_16x16x64_bf16 v[48:51], v[40:43], a[64:71], v2
    v_smfmac_f32_16x16x64_bf16 v[48:51], v[44:47], a[80:87], v2
    v_smfmac_f32_16x16x64_bf16 v[52:55], v[40:43], a[72:79], v2
    v_smfmac_f32_16x16x64_bf16 v[52:55], v[44:47], a[88:95], v2
    v_add_f32 v48, v48, v50
    v_smfmac_f32_16x16x64_bf16 v[56:59], v[24:27], a[112:119], v2
    v_add_f32 v49, v49, v51
    v_smfmac_f32_16x16x64_bf16 v[60:63], v[24:27], a[120:127], v2
    v_add_f32 v52, v52, v54
    v_cvt_pk_bf16_f32 v0, v48, v52
    v_smfmac_f32_16x16x64_bf16 v[56:59], v[28:31], a[128:135], v2
    ds_write_b32 v4, v0 offset:0
    v_add_f32 v53, v53, v55
    v_cvt_pk_bf16_f32 v11, v49, v53
    v_smfmac_f32_16x16x64_bf16 v[60:63], v[28:31], a[136:143], v2
    ds_write_b32 v4, v11 offset:288
    v_smfmac_f32_16x16x64_bf16 v[56:59], v[32:35], a[144:151], v2
    v_smfmac_f32_16x16x64_bf16 v[60:63], v[32:35], a[152:159], v2
    v_smfmac_f32_16x16x64_bf16 v[56:59], v[36:39], a[160:167], v2
    s_waitcnt lgkmcnt(0)
    s_barrier
    v_smfmac_f32_16x16x64_bf16 v[60:63], v[36:39], a[168:175], v2
    ds_read_b128 v[80:83], v5 offset:0
    ds_read_b128 v[84:87], v5 offset:64
    v_smfmac_f32_16x16x64_bf16 v[56:59], v[40:43], a[176:183], v2
    ds_read_b128 v[88:91], v5 offset:128
    v_smfmac_f32_16x16x64_bf16 v[56:59], v[44:47], a[192:199], v2
    ds_read_b128 v[92:95], v5 offset:192
    v_smfmac_f32_16x16x64_bf16 v[60:63], v[40:43], a[184:191], v2
    v_smfmac_f32_16x16x64_bf16 v[60:63], v[44:47], a[200:207], v2
    v_add_f32 v56, v56, v58
    v_smfmac_f32_16x16x64_bf16 v[72:75], v[16:19], a[208:215], v2
    s_waitcnt lgkmcnt(3)
    v_add_f32 v57, v57, v59
    v_mfma_f32_16x16x32_bf16 v[48:51], v[96:99], v[80:83], 0
    v_add_f32 v60, v60, v62
    v_cvt_pk_bf16_f32 v0, v56, v60
    v_mfma_f32_16x16x32_bf16 v[52:55], v[100:103], v[80:83], 0
    ds_write_b32 v4, v0 offset:2304
    v_add_f32 v61, v61, v63
    v_cvt_pk_bf16_f32 v11, v57, v61
    s_waitcnt lgkmcnt(3)
    v_mfma_f32_16x16x32_bf16 v[48:51], v[104:107], v[84:87], v[48:51]
    ds_write_b32 v4, v11 offset:2592
    v_mfma_f32_16x16x32_bf16 v[52:55], v[108:111], v[84:87], v[52:55]
    s_waitcnt lgkmcnt(2)
    ds_read_b128 v[96:99], v3 offset:12288
    v_mfma_f32_16x16x32_bf16 v[48:51], v[112:115], v[88:91], v[48:51]
    ds_read_b128 v[100:103], v3 offset:13312
    v_mfma_f32_16x16x32_bf16 v[52:55], v[116:119], v[88:91], v[52:55]
    s_mov_b32 m0, s81
    ds_read_b128 v[104:107], v3 offset:14336
    v_mfma_f32_16x16x32_bf16 v[48:51], v[120:123], v[92:95], v[48:51]
    ds_read_b128 v[108:111], v3 offset:15360
    v_mfma_f32_16x16x32_bf16 v[52:55], v[124:127], v[92:95], v[52:55]
    s_waitcnt lgkmcnt(4)
    s_barrier
    v_smfmac_f32_16x16x64_bf16 v[76:79], v[16:19], a[216:223], v2
    ds_read_b128 v[56:59], v6 offset:2304
    ds_read_b128 v[60:63], v6 offset:2368
    v_smfmac_f32_16x16x64_bf16 v[72:75], v[20:23], a[224:231], v2
    ds_read_b128 v[112:115], v6 offset:2432
    v_max3_f32 v0, v48, v49, v50
    v_smfmac_f32_16x16x64_bf16 v[76:79], v[20:23], a[232:239], v2
    ds_read_b128 v[116:119], v6 offset:2496
    v_max3_f32 v11, v52, v53, v54
    v_smfmac_f32_16x16x64_bf16 v[72:75], v[24:27], a[240:247], v2
    ds_read_b128 v[120:123], v3 offset:18432
    v_max3_f32 v0, v0, v51, v55
    v_smfmac_f32_16x16x64_bf16 v[76:79], v[24:27], a[248:255], v2
    s_waitcnt vmcnt(2) lgkmcnt(3)
    ds_read_b128 v[124:127], v3 offset:19456
    v_max_f32 v0, v0, v11
    v_mfma_f32_16x16x32_bf16 v[16:19], v[56:59], v[80:83], 0
    v_mov_b32 v11, v0
    v_cndmask_b32 v48, v48, v52, s[72:73]
    v_mfma_f32_16x16x32_bf16 v[16:19], v[60:63], v[84:87], v[16:19]
    s_waitcnt lgkmcnt(2)
    v_permlane16_swap_b32 v0, v11
    v_mfma_f32_16x16x32_bf16 v[16:19], v[112:115], v[88:91], v[16:19]
    v_cndmask_b32 v49, v49, v53, s[72:73]
    v_max_f32 v0, v0, v11
    v_mfma_f32_16x16x32_bf16 v[16:19], v[116:119], v[92:95], v[16:19]
    v_cndmask_b32 v50, v50, v54, s[72:73]
    v_cndmask_b32 v51, v51, v55, s[72:73]
    v_smfmac_f32_16x16x64_bf16 v[72:75], v[40:43], v[96:103], v2
    ds_read_b128 v[112:115], v3 offset:16384
    v_mov_b32 v85, 0
    v_smfmac_f32_16x16x64_bf16 v[76:79], v[40:43], v[104:111], v2
    ds_read_b128 v[116:119], v3 offset:17408
    v_max3_f32 v0, v0, v16, v17
    v_smfmac_f32_16x16x64_bf16 v[72:75], v[28:31], v[128:135], v2
    s_waitcnt lgkmcnt(2)
    ds_read_b128 v[56:59], v3 offset:32768
    v_max3_f32 v0, v0, v18, v19
    v_smfmac_f32_16x16x64_bf16 v[76:79], v[44:47], v[120:127], v2
    ds_read_b128 v[60:63], v3 offset:33792
    v_mov_b32 v11, v0
    v_smfmac_f32_16x16x64_bf16 v[72:75], v[32:35], v[144:151], v2
    ds_read_b128 v[88:91], v3 offset:20480
    v_permlane32_swap_b32 v0, v11
    v_smfmac_f32_16x16x64_bf16 v[76:79], v[28:31], v[136:143], v2
    ds_read_b128 v[92:95], v3 offset:21504
    v_max_f32 v0, v0, v11
    v_smfmac_f32_16x16x64_bf16 v[72:75], v[36:39], v[160:167], v2
    ds_read_b128 v[104:107], v3 offset:24576
    v_mul_f32 v0, s77, v0
    v_smfmac_f32_16x16x64_bf16 v[76:79], v[32:35], v[152:159], v2
    s_waitcnt lgkmcnt(5)
    ds_read_b128 v[108:111], v3 offset:25600
    v_fma_f32 v48, v48, s77, -v0
    v_smfmac_f32_16x16x64_bf16 v[72:75], v[44:47], v[112:119], v2
    ds_read_b128 v[120:123], v3 offset:28672
    v_fma_f32 v49, v49, s77, -v0
    v_smfmac_f32_16x16x64_bf16 v[76:79], v[36:39], v[168:175], v2
    ds_read_b128 v[124:127], v3 offset:29696
    v_fma_f32 v50, v50, s77, -v0
    v_fma_f32 v51, v51, s77, -v0
    v_exp_f32 v48, v48
    v_exp_f32 v49, v49
    v_fma_f32 v16, v16, s77, -v0
    v_fma_f32 v17, v17, s77, -v0
    v_exp_f32 v50, v50
    v_cvt_pk_bf16_f32 v0, v48, v49
    v_exp_f32 v51, v51
    v_exp_f32 v16, v16
    v_cvt_pk_bf16_f32 v11, v50, v51
    v_exp_f32 v17, v17
    v_mov_b32_dpp v80, v0 quad_perm:[0,1,0,1] row_mask:0xf bank_mask:0xf
    v_mov_b32_dpp v82, v0 quad_perm:[2,3,2,3] row_mask:0xf bank_mask:0xf
    v_mov_b32_dpp v81, v11 quad_perm:[0,1,0,1] row_mask:0xf bank_mask:0xf
    v_mov_b32_dpp v83, v11 quad_perm:[2,3,2,3] row_mask:0xf bank_mask:0xf
    v_cvt_pk_bf16_f32 v84, v16, v17
    s_waitcnt lgkmcnt(6)
    v_mov_b32 v86, 0
    v_mfma_f32_16x16x32_bf16 v[20:23], v[12:15], v[80:83], 0
    ds_read_b128 v[32:35], v1 offset:8192
    v_add_f32 v72, v72, v74
    v_add_f32 v73, v73, v75
    v_mfma_f32_16x16x32_bf16 v[24:27], v[56:59], v[80:83], 0
    ds_read_b128 v[36:39], v1 offset:8192
    v_add_f32 v76, v76, v78
    v_add_f32 v77, v77, v79
    v_mfma_f32_16x16x32_bf16 v[28:31], v[60:63], v[80:83], 0
    ds_read_b128 v[40:43], v1 offset:8192
    v_cvt_pk_bf16_f32 v74, v72, v73
    v_cvt_pk_bf16_f32 v75, v76, v77
    v_mfma_f32_16x16x16_bf16 v[20:23], v[12:13], v[84:85], v[20:23]
    ds_read_b128 v[44:47], v1 offset:8192
    v_cvt_pk_bf16_f32 v87, v16, v17
    v_mfma_f32_16x16x16_bf16 v[24:27], v[74:75], v[84:85], v[24:27]
    ds_write_b64 v7, v[74:75] offset:2048
    v_mfma_f32_16x16x16_bf16 v[28:31], v[74:75], v[86:87], v[28:31]
    v_rcp_f32 v0, v22
    s_add_u32 s65, s65, 1
    s_xor_b32 s66, s66, 8192
    s_nop 0
    v_pk_mul_f32 v[24:25], v[24:25], v[0:1] op_sel_hi:[1,0]
    v_pk_mul_f32 v[26:27], v[26:27], v[0:1] op_sel_hi:[1,0]
    s_nop 1
    v_pk_mul_f32 v[28:29], v[28:29], v[0:1] op_sel_hi:[1,0]
    v_pk_mul_f32 v[30:31], v[30:31], v[0:1] op_sel_hi:[1,0]
    v_cvt_pk_bf16_f32 v52, v24, v28
    v_cvt_pk_bf16_f32 v53, v25, v29
    v_cvt_pk_bf16_f32 v54, v26, v30
    v_cvt_pk_bf16_f32 v55, v27, v31
    ds_write_b128 v3, v[52:55] offset:34816
    s_waitcnt lgkmcnt(2)
    v_smfmac_f32_16x16x64_bf16 v[32:35], v[52:55], v[176:183], v2
    buffer_load_dwordx4 v1, s[36:39], s71 offen offset:0 lds
    v_smfmac_f32_16x16x64_bf16 v[36:39], v[52:55], v[208:215], v2
    buffer_load_dwordx4 v1, s[36:39], s71 offen offset:1024 lds
    v_smfmac_f32_16x16x64_bf16 v[40:43], v[52:55], v[240:247], v2
    v_smfmac_f32_16x16x64_bf16 v[44:47], v[52:55], v[248:255], v2
    s_waitcnt lgkmcnt(0)
    s_barrier
    ds_read_b128 v[16:19], v64 offset:34816
    ds_read_b128 v[20:23], v65 offset:34816
    ds_read_b128 v[24:27], v66 offset:34816
    s_mov_b32 m0, s82
    s_add_u32 s59, s71, 8192
    buffer_load_dwordx4 v1, s[36:39], s59 offen offset:0 lds
    buffer_load_dwordx4 v1, s[36:39], s59 offen offset:1024 lds
    s_add_u32 s70, s70, 131072
    s_waitcnt lgkmcnt(2)
    v_smfmac_f32_16x16x64_bf16 v[32:35], v[16:19], v[184:191], v2
    s_waitcnt lgkmcnt(1)
    ds_read_b128 v[96:99], v3 offset:22528
    v_smfmac_f32_16x16x64_bf16 v[32:35], v[20:23], v[192:199], v2
    s_waitcnt lgkmcnt(1)
    ds_read_b128 v[100:103], v3 offset:23552
    v_smfmac_f32_16x16x64_bf16 v[32:35], v[24:27], v[200:207], v2
    ds_read_b128 v[112:115], v3 offset:26624
    v_smfmac_f32_16x16x64_bf16 v[36:39], v[16:19], v[216:223], v2
    ds_read_b128 v[116:119], v3 offset:27648
    v_smfmac_f32_16x16x64_bf16 v[36:39], v[20:23], v[224:231], v2
    ds_read_b128 v[72:75], v3 offset:30720
    v_cvt_pk_bf16_f32 v56, v32, v33
    v_smfmac_f32_16x16x64_bf16 v[36:39], v[24:27], v[232:239], v2
    ds_read_b128 v[76:79], v3 offset:31744
    v_cvt_pk_bf16_f32 v57, v34, v35
    v_smfmac_f32_16x16x64_bf16 v[40:43], v[16:19], v[88:95], v2
    v_and_or_b32 v56, v56, -2, s8
    v_smfmac_f32_16x16x64_bf16 v[40:43], v[20:23], v[104:111], v2
    v_cvt_pk_bf16_f32 v58, v36, v37
    v_smfmac_f32_16x16x64_bf16 v[40:43], v[24:27], v[120:127], v2
    s_waitcnt lgkmcnt(2)
    v_cvt_pk_bf16_f32 v59, v38, v39
    v_smfmac_f32_16x16x64_bf16 v[44:47], v[16:19], v[96:103], v2
    buffer_store_dwordx4 v[56:59], v8, s[36:39], s67 offen sc1
    v_smfmac_f32_16x16x64_bf16 v[44:47], v[20:23], v[112:119], v2
    s_waitcnt lgkmcnt(0)
    v_cvt_pk_bf16_f32 v60, v40, v41
    v_smfmac_f32_16x16x64_bf16 v[44:47], v[24:27], v[72:79], v2
    v_cvt_pk_bf16_f32 v61, v42, v43
    v_and_or_b32 v60, v60, -2, s8
    s_nop 5
    v_cvt_pk_bf16_f32 v62, v44, v45
    v_cvt_pk_bf16_f32 v63, v46, v47
    buffer_store_dwordx4 v[60:63], v8, s[36:39], s69 offen sc1
    s_add_u32 s71, s71, 524288
    s_xor_b32 s60, s76, 8192
    v_mov_b32 v16, -1
    ds_read_b128 v[96:99], v3 offset:0
    ds_read_b128 v[100:103], v3 offset:1024
    ds_read_b128 v[104:107], v3 offset:2048
    ds_read_b128 v[108:111], v3 offset:3072
    ds_read_b128 v[112:115], v3 offset:4096
    ds_read_b128 v[116:119], v3 offset:5120
    v_bfe_u32 v0, v1, 6, 3
    v_and_b32 v11, 48, v1
    v_mad_u32_u24 v0, v0, s10, v11
    v_lshrrev_b32 v11, 9, v1
    v_mad_u32_u24 v0, v11, s11, v0
    v_add_u32 v0, s9, v0
    ds_read_b128 v[68:71], v0
    ds_read_b128 v[120:123], v3 offset:6144
    ds_read_b128 v[124:127], v3 offset:7168
    ds_read_b128 v[80:83], v3 offset:8192
    ds_read_b128 v[84:87], v3 offset:9216
    ds_read_b128 v[88:91], v3 offset:10240
    ds_read_b128 v[92:95], v3 offset:11264
    v_mov_b64 v[48:49], 0
    v_mov_b64 v[50:51], 0
    v_mov_b64 v[52:53], 0
    v_mov_b64 v[54:55], 0
    v_mov_b64 v[56:57], 0
    v_mov_b64 v[58:59], 0
    v_mov_b64 v[60:61], 0
    v_mov_b64 v[62:63], 0
    s_waitcnt vmcnt(1)
    buffer_load_dwordx4 v[24:27], v1, s[36:39], s68 offen offset:0 sc1
    buffer_load_dwordx4 v[28:31], v1, s[36:39], s68 offen offset:1024 sc1
    s_waitcnt vmcnt(2)
    buffer_load_dwordx4 v[40:43], v1, s[36:39], s68 offen offset:0 sc1
    buffer_load_dwordx4 v[44:47], v1, s[36:39], s68 offen offset:1024 sc1
    s_mov_b32 s61, 0
PL_81:
    s_waitcnt vmcnt(3)
    v_mfma_f32_16x16x32_bf16 v[32:35], v[12:15], v[24:27], 0
    v_xor_b32 v0, s8, v24
    s_waitcnt vmcnt(2)
    v_mfma_f32_16x16x32_bf16 v[32:35], v[12:15], v[28:31], v[32:35]
    v_xor_b32 v11, s8, v28
    v_or_b32 v17, v0, v11
    v_and_b32 v17, 1, v17
    v_cmp_ne_u32 vcc, 0, v17
    s_cbranch_vccz PK_82
    v_and_b32 v11, 1, v11
    v_and_b32 v0, 1, v0
    v_cmp_ne_u32 s[62:63], 0, v11
    v_cmpx_ne_u32 vcc, 0, v0
    buffer_load_dwordx4 v[24:27], v1, s[36:39], s68 offen offset:0 sc1
    s_mov_b64 exec, s[62:63]
    buffer_load_dwordx4 v[28:31], v1, s[36:39], s68 offen offset:1024 sc1
    s_mov_b64 exec, -1
    s_waitcnt vmcnt(3)
    v_mfma_f32_16x16x32_bf16 v[32:35], v[12:15], v[40:43], 0
    v_xor_b32 v0, s8, v40
    s_waitcnt vmcnt(2)
    v_mfma_f32_16x16x32_bf16 v[32:35], v[12:15], v[44:47], v[32:35]
    v_xor_b32 v11, s8, v44
    v_or_b32 v17, v0, v11
    v_and_b32 v17, 1, v17
    v_cmp_ne_u32 vcc, 0, v17
    s_cbranch_vccz PK_82
    v_and_b32 v11, 1, v11
    v_and_b32 v0, 1, v0
    v_cmp_ne_u32 s[62:63], 0, v11
    v_cmpx_ne_u32 vcc, 0, v0
    buffer_load_dwordx4 v[40:43], v1, s[36:39], s68 offen offset:0 sc1
    s_mov_b64 exec, s[62:63]
    buffer_load_dwordx4 v[44:47], v1, s[36:39], s68 offen offset:1024 sc1
    s_mov_b64 exec, -1
    s_add_u32 s61, s61, 1
    s_cmp_lt_u32 s61, 200000
    s_cbranch_scc1 PL_81
    s_branch PLD_83
PK_82:
    s_nop 3
    v_add_f32_dpp v32, v32, v32 row_ror:4 row_mask:0xf bank_mask:0xf
    v_add_f32_dpp v33, v33, v33 row_ror:4 row_mask:0xf bank_mask:0xf
    s_nop 0
    v_add_f32_dpp v32, v32, v32 row_ror:8 row_mask:0xf bank_mask:0xf
    v_add_f32_dpp v33, v33, v33 row_ror:8 row_mask:0xf bank_mask:0xf
    v_cvt_pk_bf16_f32 v32, v32, v33
    buffer_store_dword v32, v9, s[36:39], s60 offen sc1
    buffer_store_dword v16, v9, s[36:39], s76 offen sc1
    s_mov_b32 s76, s60
    s_xor_b32 s8, s8, 1
    v_cmp_ne_u32 vcc, 1, v10
    s_mov_b32 s61, 0
    s_nop 3
    s_cmp_eq_u32 vcc_hi, 0
    s_cbranch_scc1 FWD_85
FW_84:
    v_bfe_u32 v11, v1, 2, 4
    buffer_load_dword v10, v11, s[36:39], s74 offen sc1
    s_waitcnt vmcnt(0)
    v_cmp_ne_u32 vcc, 1, v10
    s_cbranch_vccz FWD_85
    s_add_u32 s61, s61, 1
    s_cmp_lt_u32 s61, 200000
    s_cbranch_scc1 FW_84
    v_mov_b32 v1, 8
    v_mov_b32 v2, 224
    global_atomic_or v2, v1, s[32:33] sc1
    s_waitcnt vmcnt(0)
    s_endpgm
FWD_85:
    s_add_u32 s74, s74, 512
    s_min_u32 s74, s74, s83
    v_mov_b64 v[72:73], 0
    v_mov_b64 v[74:75], 0
    v_mov_b64 v[76:77], 0
    v_mov_b64 v[78:79], 0
    s_waitcnt vmcnt(1)
    buffer_load_dwordx4 v[16:19], v1, s[36:39], s66 offen offset:0 sc1
    buffer_load_dwordx4 v[20:23], v1, s[36:39], s66 offen offset:1024 sc1
    s_sub_u32 s12, s74, s71
    v_bfe_u32 v0, v1, 8, 1
    v_and_b32 v67, 0xf0, v1
    v_lshlrev_b32 v0, 13, v0
    v_lshl_add_u32 v67, v67, 3, v0
    s_mov_b32 exec_lo, 0
    v_bfe_u32 v67, v1, 2, 4
    v_add_u32 v67, s12, v67
    s_mov_b32 exec_lo, -1
    buffer_load_dwordx4 v[16:19], v1, s[36:39], s66 offen offset:0 sc1
    buffer_load_dwordx4 v[20:23], v1, s[36:39], s66 offen offset:1024 sc1
    s_waitcnt lgkmcnt(0)
    s_branch RT_73
PB_77:
    s_mov_b64 exec, vcc
    buffer_load_dwordx4 v[20:23], v1, s[36:39], s66 offen offset:1024 sc1
    s_mov_b64 exec, -1
    s_add_u32 s61, s61, 1
    s_cmp_lt_u32 s61, 200000
    s_cbranch_scc0 PAD_79
    s_waitcnt vmcnt(1)
    v_max3_u32 v0, v20, v21, v22
    v_max_u32 v0, v0, v23
    v_cmp_eq_u32 vcc, -1, v0
    ds_write_b128 v3, v[20:23] offset:35840
    s_cbranch_vccnz PB_77
    s_branch PBE_78
PAD_79:
    v_mov_b32 v1, 4
    v_mov_b32 v2, 224
    global_atomic_or v2, v1, s[32:33] sc1
    s_waitcnt vmcnt(0)
    s_endpgm
PLD_83:
    v_mov_b32 v1, 16
    v_mov_b32 v2, 224
    global_atomic_or v2, v1, s[32:33] sc1
    s_waitcnt vmcnt(0)
    s_endpgm
RL_80:
    s_waitcnt lgkmcnt(0)
    s_barrier
    ds_read_b128 v[24:27], v64 offset:34816
    ds_read_b128 v[28:31], v64 offset:35840
    v_smfmac_f32_16x16x64_bf16 v[56:59], v[20:23], a[96:103], v2
    ds_read_b128 v[32:35], v65 offset:34816
    ds_read_b128 v[36:39], v65 offset:35840
    v_smfmac_f32_16x16x64_bf16 v[60:63], v[20:23], a[104:111], v2
    ds_read_b128 v[40:43], v66 offset:34816
    ds_read_b128 v[44:47], v66 offset:35840
    v_smfmac_f32_16x16x64_bf16 v[72:75], v[16:19], a[208:215], v2
    buffer_store_dwordx4 v[68:71], v1, s[36:39], s70 offen sc1
    ds_read_b128 v[96:99], v3 offset:12288
    ds_read_b128 v[100:103], v3 offset:13312
    v_smfmac_f32_16x16x64_bf16 v[76:79], v[16:19], a[216:223], v2
    ds_read_b128 v[104:107], v3 offset:14336
    ds_read_b128 v[108:111], v3 offset:15360
    v_smfmac_f32_16x16x64_bf16 v[72:75], v[20:23], a[224:231], v2
    ds_read_b128 v[112:115], v3 offset:16384
    ds_read_b128 v[116:119], v3 offset:17408
    v_smfmac_f32_16x16x64_bf16 v[76:79], v[20:23], a[232:239], v2
    ds_read_b128 v[120:123], v3 offset:18432
    ds_read_b128 v[124:127], v3 offset:19456
    s_waitcnt lgkmcnt(13)
    v_smfmac_f32_16x16x64_bf16 v[56:59], v[24:27], a[112:119], v2
    v_smfmac_f32_16x16x64_bf16 v[60:63], v[24:27], a[120:127], v2
    v_smfmac_f32_16x16x64_bf16 v[72:75], v[24:27], a[240:247], v2
    v_smfmac_f32_16x16x64_bf16 v[76:79], v[24:27], a[248:255], v2
    s_waitcnt lgkmcnt(12)
    v_smfmac_f32_16x16x64_bf16 v[56:59], v[28:31], a[128:135], v2
    v_smfmac_f32_16x16x64_bf16 v[60:63], v[28:31], a[136:143], v2
    v_smfmac_f32_16x16x64_bf16 v[72:75], v[28:31], v[128:135], v2
    v_smfmac_f32_16x16x64_bf16 v[76:79], v[28:31], v[136:143], v2
    s_waitcnt lgkmcnt(11)
    v_smfmac_f32_16x16x64_bf16 v[56:59], v[32:35], a[144:151], v2
    v_smfmac_f32_16x16x64_bf16 v[60:63], v[32:35], a[152:159], v2
    v_smfmac_f32_16x16x64_bf16 v[72:75], v[32:35], v[144:151], v2
    v_smfmac_f32_16x16x64_bf16 v[76:79], v[32:35], v[152:159], v2
    s_waitcnt lgkmcnt(10)
    v_smfmac_f32_16x16x64_bf16 v[56:59], v[36:39], a[160:167], v2
    v_smfmac_f32_16x16x64_bf16 v[60:63], v[36:39], a[168:175], v2
    v_smfmac_f32_16x16x64_bf16 v[72:75], v[36:39], v[160:167], v2
    v_smfmac_f32_16x16x64_bf16 v[76:79], v[36:39], v[168:175], v2
    s_waitcnt lgkmcnt(0)
    v_smfmac_f32_16x16x64_bf16 v[56:59], v[40:43], a[176:183], v2
    v_smfmac_f32_16x16x64_bf16 v[56:59], v[44:47], a[192:199], v2
    v_smfmac_f32_16x16x64_bf16 v[60:63], v[40:43], a[184:191], v2
    v_smfmac_f32_16x16x64_bf16 v[60:63], v[44:47], a[200:207], v2
    v_smfmac_f32_16x16x64_bf16 v[72:75], v[40:43], v[96:103], v2
    v_add_f32 v56, v56, v58
    v_add_f32 v57, v57, v59
    v_smfmac_f32_16x16x64_bf16 v[72:75], v[44:47], v[112:119], v2
    v_smfmac_f32_16x16x64_bf16 v[76:79], v[40:43], v[104:111], v2
    v_add_f32 v60, v60, v62
    v_add_f32 v61, v61, v63
    v_cvt_pk_bf16_f32 v0, v56, v60
    v_cvt_pk_bf16_f32 v11, v57, v61
    v_smfmac_f32_16x16x64_bf16 v[76:79], v[44:47], v[120:127], v2
    ds_write_b32 v4, v0 offset:2304
    ds_write_b32 v4, v11 offset:2592
    v_add_f32 v72, v72, v74
    v_add_f32 v73, v73, v75
    v_cvt_pk_bf16_f32 v74, v72, v73
    s_nop 7
    v_add_f32 v76, v76, v78
    v_add_f32 v77, v77, v79
    v_cvt_pk_bf16_f32 v75, v76, v77
    ds_write_b64 v7, v[74:75] offset:2048
RF_74:
    s_waitcnt lgkmcnt(0)
    s_barrier
    s_add_u32 s70, s70, 131072
    v_bfe_u32 v0, v1, 6, 3
    v_and_b32 v11, 48, v1
    v_mad_u32_u24 v0, v0, s10, v11
    v_lshrrev_b32 v11, 9, v1
    v_mad_u32_u24 v0, v11, s11, v0
    v_add_u32 v0, s9, v0
    ds_read_b128 v[68:71], v0
    s_waitcnt lgkmcnt(0)
    buffer_store_dwordx4 v[68:71], v1, s[36:39], s70 offen sc1
    s_waitcnt vmcnt(0)
    s_waitcnt vmcnt(0)
K_EXIT:
s_endpgm
.section .rodata,"a"
.p2align 6
.amdhsa_kernel parallel_sum__memory_aug_recurrent_mem_tr__geglu_ffn__prompt_kernel
  .amdhsa_next_free_vgpr 512
  .amdhsa_next_free_sgpr 102
  .amdhsa_accum_offset 256
  .amdhsa_group_segment_fixed_size 0
  .amdhsa_kernarg_size 112
  .amdhsa_user_sgpr_count 2
  .amdhsa_user_sgpr_kernarg_segment_ptr 1
  .amdhsa_system_sgpr_workgroup_id_x 1
.end_amdhsa_kernel
```
